```python
import torch

def _softmax(x, axis=-1):
    return torch.softmax(x, dim=axis)

def _gelu(x):
    return torch.nn.functional.gelu(x, approximate='tanh')

def _silu(x):
    return torch.nn.functional.silu(x)

def _sigmoid(x):
    return torch.sigmoid(x)

def _layernorm(x, axis=-1, eps=1e-05):
    m = x.mean(dim=axis, keepdim=True)
    v = x.var(dim=axis, keepdim=True, unbiased=False)
    return (x - m) / torch.sqrt(v + eps)

def _scatter_add(tgt, idx, src, axis=0):
    return tgt.clone().index_add_(axis, idx, src)

def _segment_sum(src, seg, n):
    out = torch.zeros((n,) + src.shape[1:], dtype=src.dtype)
    return out.index_add_(0, seg, src)

def _pad(x, pw):
    flat = tuple((v for pair in reversed(pw) for v in pair))
    return torch.nn.functional.pad(x, flat)
kernel_name = 'standalone__pixart__diffusion'

def setup_inputs():

    _w = lambda a: (lambda t: t.to(torch.bfloat16) if t.is_floating_point() else t)(torch.as_tensor(a))
    B, N, D, M = (2, 256, 1152, 77)
    return {'x': _w((lambda *s: torch.randn(*s, dtype=torch.bfloat16) * 0.05)(B, N, D)), 'c': _w((lambda *s: torch.randn(*s, dtype=torch.bfloat16) * 0.05)(B, D)), 'y': _w((lambda *s: torch.randn(*s, dtype=torch.bfloat16) * 0.1)(B, M, D)), 'wqkv': _w((lambda *s: torch.randn(*s, dtype=torch.bfloat16) * 0.05)(D, 3 * D)), 'wo': _w((lambda *s: torch.randn(*s, dtype=torch.bfloat16) * 0.05)(D, D)), 'wq_c': _w((lambda *s: torch.randn(*s, dtype=torch.bfloat16) * 0.1)(D, D)), 'wkv_c': _w((lambda *s: torch.randn(*s, dtype=torch.bfloat16) * 0.1)(D, 2 * D)), 'wo_c': _w((lambda *s: torch.randn(*s, dtype=torch.bfloat16) * 0.05)(D, D)), 'w_mod': _w((lambda *s: torch.randn(*s, dtype=torch.bfloat16) * 0.05)(D, 6 * D))}

def reference(x, c, y, wqkv, wo, wq_c, wkv_c, wo_c, w_mod):
    B, N, D = x.shape
    mod = (_silu(c) @ w_mod).reshape(B, 6, 1, D)
    shift_a, scale_a, gate_a, shift_m, scale_m, gate_m = [mod[:, i] for i in range(6)]
    h = _layernorm(x, axis=-1) * (1 + scale_a) + shift_a
    qkv = h @ wqkv
    q, k, v = (qkv[..., :D].clone(), qkv[..., D:2 * D].clone(), qkv[..., 2 * D:].clone())
    p = _softmax(torch.einsum('bqd,bkd->bqk', q, k) * D ** (-0.5), axis=-1)
    x = x + gate_a * (torch.einsum('bqk,bkd->bqd', p, v) @ wo)
    hc = _layernorm(x, axis=-1)
    qc = hc @ wq_c
    kvc = y @ wkv_c
    kc, vc = (kvc[..., :D].clone(), kvc[..., D:].clone())
    pc = _softmax(torch.einsum('bqd,bkd->bqk', qc, kc) * D ** (-0.5), axis=-1)
    return x + torch.einsum('bqk,bkd->bqd', pc, vc) @ wo_c
```

```asm
; @launch grid=(256,1,1) block=(256,1,1) lds=163840
.amdgcn_target "amdgcn-amd-amdhsa--gfx950"
.text
.globl standalone__pixart__diffusion_kernel
.p2align 8
.type standalone__pixart__diffusion_kernel,@function
standalone__pixart__diffusion_kernel:
s_cmp_ge_u32 s2, 256
s_cbranch_scc1 L_end
s_load_dwordx16 s[36:51], s[0:1], 0
s_load_dwordx8 s[52:59], s[0:1], 64
v_lshrrev_b32 v2, 6, v0
v_and_b32 v1, 63, v0
v_readfirstlane_b32 s25, v2
s_and_b32 s26, s2, 7
s_lshr_b32 s27, s2, 3
s_mov_b32 s100, 0xffff0000
s_add_u32 s33, s27, 24
s_and_b32 s33, s33, 31
s_cmp_lt_u32 s26, 3
s_cselect_b32 s27, s27, s33
s_mul_i32 s31, s25, 36864
s_waitcnt lgkmcnt(0)
s_mov_b32 s4, s58
s_mov_b32 s5, s59
s_mov_b32 s6, 12582912
s_mov_b32 s7, 0x20000
v_mov_b32 v2, 114688
buffer_load_dword v3, v2, s[4:7], 0 offen sc1
s_cmp_lt_u32 s26, 3
s_cselect_b32 s33, 32, 24
s_cmp_ge_u32 s27, s33
s_cbranch_scc1 L_side
s_mul_i32 s28, s26, 24
s_add_u32 s28, s28, s27
s_lshl_b32 s33, s26, 3
s_add_u32 s33, s33, s27
s_add_u32 s33, s33, 168
s_cmp_lt_u32 s27, 24
s_cselect_b32 s28, s28, s33
s_lshr_b32 s29, s28, 3
s_and_b32 s30, s28, 7
s_mov_b32 s12, s52
s_mov_b32 s13, s53
s_mov_b32 s14, 15925248
s_mov_b32 s15, 0x20000
v_lshrrev_b32 v8, 3, v1
v_mul_u32_u24 v8, 13824, v8
v_lshrrev_b32 v9, 4, v1
v_lshlrev_b32 v9, 1, v9
v_and_b32 v4, 7, v1
v_xor_b32 v9, v9, v4
v_lshl_add_u32 v4, v9, 4, v8
v_add_u32 v5, 109568, v4
v_add_u32 v6, 219136, v4
v_add_u32 v7, 328704, v4
v_add_u32 v5, 441344, v4
v_add_u32 v6, 882688, v4
s_and_b32 s60, s28, 3
s_mul_i32 s61, s60, 36
s_add_u32 s61, s61, s25
s_mul_i32 s61, s61, 110592
s_lshr_b32 s62, s28, 2
s_lshl_b32 s33, s62, 7
s_add_u32 s61, s61, s33
s_add_u32 m0, s31, 18432
s_add_u32 s32, s61, 0
buffer_load_dwordx4 v4, s[12:15], s32 offen offset:0 nt lds
buffer_load_dwordx4 v5, s[12:15], s32 offen offset:1024 nt lds
buffer_load_dwordx4 v6, s[12:15], s32 offen offset:2048 nt lds
s_add_u32 m0, s31, 21504
s_add_u32 s32, s61, 1327104
buffer_load_dwordx4 v4, s[12:15], s32 offen offset:0 nt lds
buffer_load_dwordx4 v5, s[12:15], s32 offen offset:1024 nt lds
buffer_load_dwordx4 v6, s[12:15], s32 offen offset:2048 nt lds
s_add_u32 m0, s31, 24576
s_add_u32 s32, s61, 2654208
buffer_load_dwordx4 v4, s[12:15], s32 offen offset:0 nt lds
buffer_load_dwordx4 v5, s[12:15], s32 offen offset:1024 nt lds
buffer_load_dwordx4 v6, s[12:15], s32 offen offset:2048 nt lds
s_mov_b32 s8, s38
s_mov_b32 s9, s39
s_mov_b32 s10, 4608
s_mov_b32 s11, 0x20000
s_mov_b32 s16, s36
s_mov_b32 s17, s37
s_mov_b32 s18, 1179648
s_mov_b32 s19, 0x20000
s_and_b32 s33, s25, 1
s_mul_i32 s63, s33, 2304
s_mul_i32 s64, s33, 576
s_lshr_b32 s33, s25, 1
s_mul_i32 s33, s33, 288
s_add_u32 s64, s64, s33
s_add_u32 s63, s63, s33
s_mul_i32 s33, s60, 576
s_add_u32 s63, s63, s33
v_lshlrev_b32 v8, 3, v1
v_min_u32 v8, 280, v8
buffer_load_dwordx2 v[240:241], v8, s[8:11], s63 offen
s_add_u32 s64, s64, 158720
v_add_u32 v18, s64, v8
s_mov_b32 s20, s42
s_mov_b32 s21, s43
s_mov_b32 s22, 7962624
s_mov_b32 s23, 0x20000
s_lshl_b32 s77, s26, 1
s_and_b32 s33, s27, 1
s_add_u32 s77, s77, s33
s_lshr_b32 s78, s27, 1
s_cmp_ge_u32 s78, 9
s_cselect_b32 s33, 9, 0
s_cselect_b32 s79, 0x7f000000, 0
s_sub_u32 s78, s78, s33
s_mul_i32 s65, s77, 73728
s_lshl_b32 s33, s78, 8
s_lshl_b32 s32, s25, 6
s_add_u32 s33, s33, s32
s_add_u32 s33, s33, s65
v_and_b32 v9, 31, v1
v_mul_u32_u24 v9, 2304, v9
v_lshrrev_b32 v10, 5, v1
v_lshl_add_u32 v9, v10, 4, v9
buffer_load_dwordx4 v[208:211], v9, s[16:19], s33 offen offset:0
buffer_load_dwordx4 v[212:215], v9, s[16:19], s33 offen offset:32
v_lshrrev_b32 v9, 3, v1
v_mul_u32_u24 v9, 2304, v9
v_lshrrev_b32 v10, 4, v1
v_and_b32 v11, 7, v1
v_xor_b32 v4, v11, v10
v_xor_b32 v5, 4, v4
v_lshl_add_u32 v4, v4, 4, v9
v_lshl_add_u32 v5, v5, 4, v9
v_add_u32 v5, 17408, v5
v_add_u32 v6, 34816, v4
v_add_u32 v7, 34816, v5
s_mul_i32 s60, s25, 576
s_and_b32 s33, s25, 1
s_lshl_b32 s63, s33, 6
s_add_u32 s63, s63, s60
s_xor_b32 s33, s33, 1
s_lshl_b32 s64, s33, 9
s_add_u32 s64, s64, s60
s_add_u32 s66, s65, s64
s_add_u32 s65, s65, s63
v_lshrrev_b32 v9, 2, v1
v_mul_u32_u24 v9, 2304, v9
v_and_b32 v11, 3, v1
v_xor_b32 v8, v11, v10
v_lshl_add_u32 v8, v8, 4, v9
v_add_u32 v9, 35840, v8
s_lshr_b32 s33, s27, 3
s_mul_i32 s33, s33, 3
s_add_u32 s33, s33, s30
s_lshl_b32 s99, s33, 1
s_lshr_b32 s33, s30, 2
s_add_u32 s99, s99, s33
s_cmp_ge_u32 s99, 18
s_cselect_b32 s33, 18, 0
s_sub_u32 s99, s99, s33
s_mul_i32 s68, s25, 1990656
s_lshl_b32 s33, s29, 8
s_add_u32 s68, s68, s33
s_mul_i32 s67, s99, 110592
s_add_u32 s67, s67, s68
s_add_u32 s68, s68, 1990656
v_lshrrev_b32 v16, 4, v1
v_mul_u32_u24 v12, 6912, v16
v_lshlrev_b32 v16, 2, v16
v_and_b32 v17, 15, v1
v_xor_b32 v16, v16, v17
v_lshl_add_u32 v12, v16, 4, v12
v_add_u32 v13, 26624, v12
v_add_u32 v14, 53248, v12
v_add_u32 v15, 79872, v12
s_add_u32 m0, s31, 28672
s_nop 0
buffer_load_dwordx4 v12, s[20:23], s67 offen offset:0 nt lds
buffer_load_dwordx4 v13, s[20:23], s67 offen offset:1024 nt lds
buffer_load_dwordx4 v14, s[20:23], s67 offen offset:2048 nt lds
buffer_load_dwordx4 v15, s[20:23], s67 offen offset:3072 nt lds
s_add_u32 s67, s67, 110592
s_cmp_ge_u32 s67, s68
s_cselect_b32 s33, 1990656, 0
s_sub_u32 s67, s67, s33
s_add_u32 m0, s31, 32768
s_nop 0
buffer_load_dwordx4 v12, s[20:23], s67 offen offset:0 nt lds
buffer_load_dwordx4 v13, s[20:23], s67 offen offset:1024 nt lds
buffer_load_dwordx4 v14, s[20:23], s67 offen offset:2048 nt lds
buffer_load_dwordx4 v15, s[20:23], s67 offen offset:3072 nt lds
s_add_u32 s67, s67, 110592
s_cmp_ge_u32 s67, s68
s_cselect_b32 s33, 1990656, 0
s_sub_u32 s67, s67, s33
s_mov_b32 s72, 0x0c04000c
s_mov_b32 s73, 0x04020100
s_mov_b32 s74, 0x07060501
s_mov_b32 s75, 0x07060502
s_mov_b32 s76, 0x07060503
s_waitcnt vmcnt(10)
v_lshlrev_b32 v244, 16, v240
v_and_b32 v245, s100, v240
v_mul_f32 v246, 0xbfb8aa3b, v244
v_mul_f32 v247, 0xbfb8aa3b, v245
v_exp_f32 v246, v246
v_exp_f32 v247, v247
v_add_f32 v246, 1.0, v246
v_add_f32 v247, 1.0, v247
v_rcp_f32 v246, v246
v_rcp_f32 v247, v247
v_mul_f32 v244, v244, v246
v_mul_f32 v245, v245, v247
v_cvt_pk_bf16_f32 v240, v244, v245
v_lshlrev_b32 v248, 16, v241
v_and_b32 v249, s100, v241
v_mul_f32 v250, 0xbfb8aa3b, v248
v_mul_f32 v251, 0xbfb8aa3b, v249
v_exp_f32 v250, v250
v_exp_f32 v251, v251
v_add_f32 v250, 1.0, v250
v_add_f32 v251, 1.0, v251
v_rcp_f32 v250, v250
v_rcp_f32 v251, v251
v_mul_f32 v248, v248, v250
v_mul_f32 v249, v249, v251
v_cvt_pk_bf16_f32 v241, v248, v249
ds_write_b64 v18, v[240:241]
v_and_b32 v16, 1, v1
v_mul_u32_u24 v16, 576, v16
v_lshrrev_b32 v19, 4, v1
v_lshl_add_u32 v16, v19, 3, v16
v_add_u32 v16, 158720, v16
v_lshrrev_b32 v18, 5, v1
v_mul_u32_u24 v17, 36864, v18
v_bfe_u32 v18, v1, 2, 3
v_lshl_add_u32 v17, v18, 7, v17
v_lshrrev_b32 v20, 1, v18
v_and_b32 v18, 3, v1
v_lshl_add_u32 v17, v18, 3, v17
v_xor_b32 v20, s25, v20
v_lshl_add_u32 v17, v20, 5, v17
v_add_u32 v18, 73728, v17
v_and_b32 v20, 15, v1
v_mul_u32_u24 v21, 13824, v20
v_lshl_add_u32 v21, v19, 4, v21
v_cmp_gt_u32 vcc, 2, v20
v_mov_b32 v19, 0x7fffffff
s_nop 0
v_cndmask_b32 v19, v19, v21, vcc
s_and_b32 s60, s28, 3
s_mul_i32 s60, s60, 27648
s_lshl_b32 s62, s62, 8
s_add_u32 s60, s60, s62
s_lshl_b32 s33, s25, 6
s_add_u32 s60, s60, s33
s_waitcnt vmcnt(20)
v_readfirstlane_b32 s24, v3
s_nop 0
s_mul_i32 s24, s24, 0x9E3779B1
s_add_u32 s24, s24, 0x7F4A7C15
s_waitcnt vmcnt(11)
s_waitcnt lgkmcnt(0)
s_barrier
ds_read_b64_tr_b16 v[112:113], v17 offset:18432
ds_read_b64_tr_b16 v[114:115], v18 offset:18432
ds_read_b64 v[64:65], v16 offset:0
ds_read_b64 v[66:67], v16 offset:32
ds_read_b64_tr_b16 v[116:117], v17 offset:19456
ds_read_b64_tr_b16 v[118:119], v18 offset:19456
ds_read_b64 v[68:69], v16 offset:64
ds_read_b64 v[70:71], v16 offset:96
ds_read_b64_tr_b16 v[120:121], v17 offset:20480
ds_read_b64_tr_b16 v[122:123], v18 offset:20480
ds_read_b64 v[72:73], v16 offset:128
ds_read_b64 v[74:75], v16 offset:160
s_waitcnt lgkmcnt(8)
v_mfma_f32_16x16x32_bf16 v[240:243], v[112:115], v[64:67], 0
ds_read_b64_tr_b16 v[124:125], v17 offset:21504
ds_read_b64_tr_b16 v[126:127], v18 offset:21504
ds_read_b64 v[76:77], v16 offset:192
ds_read_b64 v[78:79], v16 offset:224
s_waitcnt lgkmcnt(8)
v_mfma_f32_16x16x32_bf16 v[240:243], v[116:119], v[68:71], v[240:243]
ds_read_b64_tr_b16 v[128:129], v17 offset:22528
ds_read_b64_tr_b16 v[130:131], v18 offset:22528
ds_read_b64 v[80:81], v16 offset:256
ds_read_b64 v[82:83], v16 offset:288
s_waitcnt lgkmcnt(8)
v_mfma_f32_16x16x32_bf16 v[240:243], v[120:123], v[72:75], v[240:243]
ds_read_b64_tr_b16 v[132:133], v17 offset:23552
ds_read_b64_tr_b16 v[134:135], v18 offset:23552
ds_read_b64 v[84:85], v16 offset:320
ds_read_b64 v[86:87], v16 offset:352
s_waitcnt lgkmcnt(8)
v_mfma_f32_16x16x32_bf16 v[240:243], v[124:127], v[76:79], v[240:243]
ds_read_b64_tr_b16 v[136:137], v17 offset:24576
ds_read_b64_tr_b16 v[138:139], v18 offset:24576
ds_read_b64 v[88:89], v16 offset:384
ds_read_b64 v[90:91], v16 offset:416
s_waitcnt lgkmcnt(8)
v_mfma_f32_16x16x32_bf16 v[240:243], v[128:131], v[80:83], v[240:243]
ds_read_b64_tr_b16 v[140:141], v17 offset:25600
ds_read_b64_tr_b16 v[142:143], v18 offset:25600
ds_read_b64 v[92:93], v16 offset:448
ds_read_b64 v[94:95], v16 offset:480
s_waitcnt lgkmcnt(8)
v_mfma_f32_16x16x32_bf16 v[240:243], v[132:135], v[84:87], v[240:243]
ds_read_b64_tr_b16 v[144:145], v17 offset:26624
ds_read_b64_tr_b16 v[146:147], v18 offset:26624
ds_read_b64 v[96:97], v16 offset:512
ds_read_b64 v[98:99], v16 offset:544
s_waitcnt lgkmcnt(8)
v_mfma_f32_16x16x32_bf16 v[240:243], v[136:139], v[88:91], v[240:243]
s_waitcnt lgkmcnt(0)
s_barrier
v_mfma_f32_16x16x32_bf16 v[240:243], v[140:143], v[92:95], v[240:243]
v_mfma_f32_16x16x32_bf16 v[240:243], v[144:147], v[96:99], v[240:243]
s_nop 7
v_perm_b32 v240, v240, v243, s74
v_perm_b32 v241, v241, v243, s75
v_perm_b32 v242, v242, v243, s76
v_mov_b32 v243, s24
buffer_store_dwordx4 v[240:243], v19, s[4:7], s60 offen sc1
s_add_u32 s33, s78, 0
s_and_b32 s33, s33, 3
s_lshl_b32 s33, s33, 7
s_add_u32 s96, s65, s33
s_add_u32 m0, s31, 0
s_add_u32 s32, s96, 0
buffer_load_dwordx4 v4, s[16:19], s32 offen offset:0  lds
buffer_load_dwordx4 v5, s[16:19], s32 offen offset:1024  lds
buffer_load_dwordx4 v6, s[16:19], s32 offen offset:2048  lds
buffer_load_dwordx4 v7, s[16:19], s32 offen offset:3072  lds
s_add_u32 s33, s78, 1
s_and_b32 s33, s33, 3
s_lshl_b32 s33, s33, 7
s_add_u32 s96, s65, s33
s_add_u32 m0, s31, 4096
s_add_u32 s32, s96, 0
buffer_load_dwordx4 v4, s[16:19], s32 offen offset:0  lds
buffer_load_dwordx4 v5, s[16:19], s32 offen offset:1024  lds
buffer_load_dwordx4 v6, s[16:19], s32 offen offset:2048  lds
buffer_load_dwordx4 v7, s[16:19], s32 offen offset:3072  lds
s_add_u32 s33, s78, 2
s_and_b32 s33, s33, 3
s_lshl_b32 s33, s33, 7
s_add_u32 s96, s65, s33
s_add_u32 m0, s31, 8192
s_add_u32 s32, s96, 0
buffer_load_dwordx4 v4, s[16:19], s32 offen offset:0  lds
buffer_load_dwordx4 v5, s[16:19], s32 offen offset:1024  lds
buffer_load_dwordx4 v6, s[16:19], s32 offen offset:2048  lds
buffer_load_dwordx4 v7, s[16:19], s32 offen offset:3072  lds
s_add_u32 s33, s78, 3
s_and_b32 s33, s33, 3
s_lshl_b32 s33, s33, 7
s_add_u32 s96, s65, s33
s_add_u32 m0, s31, 12288
s_add_u32 s32, s96, 0
buffer_load_dwordx4 v4, s[16:19], s32 offen offset:0  lds
buffer_load_dwordx4 v5, s[16:19], s32 offen offset:1024  lds
buffer_load_dwordx4 v6, s[16:19], s32 offen offset:2048  lds
buffer_load_dwordx4 v7, s[16:19], s32 offen offset:3072  lds
s_add_u32 m0, s31, 16384
s_add_u32 s32, s66, 0
buffer_load_dwordx4 v8, s[16:19], s32 offen offset:0  lds
buffer_load_dwordx4 v9, s[16:19], s32 offen offset:1024  lds
s_add_u32 m0, s31, 20480
s_nop 0
buffer_load_dwordx4 v12, s[20:23], s67 offen offset:0  lds
buffer_load_dwordx4 v13, s[20:23], s67 offen offset:1024  lds
buffer_load_dwordx4 v14, s[20:23], s67 offen offset:2048  lds
buffer_load_dwordx4 v15, s[20:23], s67 offen offset:3072  lds
s_add_u32 s67, s67, 110592
s_cmp_ge_u32 s67, s68
s_cselect_b32 s33, 1990656, 0
s_sub_u32 s67, s67, s33
s_add_u32 m0, s31, 24576
s_nop 0
buffer_load_dwordx4 v12, s[20:23], s67 offen offset:0  lds
buffer_load_dwordx4 v13, s[20:23], s67 offen offset:1024  lds
buffer_load_dwordx4 v14, s[20:23], s67 offen offset:2048  lds
buffer_load_dwordx4 v15, s[20:23], s67 offen offset:3072  lds
s_add_u32 s67, s67, 110592
s_cmp_ge_u32 s67, s68
s_cselect_b32 s33, 1990656, 0
s_sub_u32 s67, s67, s33
v_and_b32 v16, 31, v1
v_lshrrev_b32 v17, 5, v1
v_lshrrev_b32 v18, 3, v16
v_lshlrev_b32 v18, 10, v18
v_and_b32 v19, 7, v16
v_lshl_add_u32 v18, v19, 7, v18
v_add_u32 v18, s31, v18
v_bfe_u32 v19, v16, 1, 3
v_xor_b32 v19, v19, v17
v_xor_b32 v20, 0, v19
v_lshl_add_u32 v248, v20, 4, v18
v_xor_b32 v20, 2, v19
v_lshl_add_u32 v249, v20, 4, v18
v_xor_b32 v20, 4, v19
v_lshl_add_u32 v250, v20, 4, v18
v_xor_b32 v20, 6, v19
v_lshl_add_u32 v251, v20, 4, v18
v_lshrrev_b32 v18, 4, v16
v_lshlrev_b32 v18, 10, v18
v_and_b32 v19, 15, v16
v_lshl_add_u32 v18, v19, 6, v18
v_add_u32 v18, s31, v18
v_bfe_u32 v19, v16, 2, 2
v_xor_b32 v19, v19, v17
v_xor_b32 v20, 0, v19
v_lshl_add_u32 v252, v20, 4, v18
v_xor_b32 v20, 2, v19
v_lshl_add_u32 v253, v20, 4, v18
v_lshrrev_b32 v16, 5, v1
v_bfe_u32 v17, v1, 2, 2
v_lshlrev_b32 v18, 11, v16
v_lshl_add_u32 v18, v17, 8, v18
v_and_b32 v19, 1, v1
v_lshl_add_u32 v18, v19, 3, v18
v_add_u32 v18, s31, v18
v_bfe_u32 v19, v1, 4, 1
v_lshlrev_b32 v19, 1, v19
v_bfe_u32 v30, v1, 1, 1
v_add_u32 v19, v19, v30
v_lshlrev_b32 v17, 2, v17
v_xor_b32 v19, v19, v17
s_add_u32 s33, s25, 1
s_and_b32 s33, s33, 3
s_lshl_b32 s33, s33, 2
v_xor_b32 v30, s33, v19
v_lshl_add_u32 v24, v30, 4, v18
s_add_u32 s33, s25, 2
s_and_b32 s33, s33, 3
s_lshl_b32 s33, s33, 2
v_xor_b32 v30, s33, v19
v_lshl_add_u32 v25, v30, 4, v18
s_add_u32 s33, s25, 3
s_and_b32 s33, s33, 3
s_lshl_b32 s33, s33, 2
v_xor_b32 v30, s33, v19
v_lshl_add_u32 v26, v30, 4, v18
s_add_u32 s33, s25, 4
s_and_b32 s33, s33, 3
s_lshl_b32 s33, s33, 2
v_xor_b32 v30, s33, v19
v_lshl_add_u32 v27, v30, 4, v18
s_lshr_b32 s33, s77, 3
s_mul_i32 s71, s33, 13824
s_lshl_b32 s33, s78, 9
s_add_u32 s71, s71, s33
s_lshl_b32 s33, s25, 7
s_add_u32 s71, s71, s33
v_lshrrev_b32 v16, 4, v1
v_mul_u32_u24 v16, 27648, v16
v_bfe_u32 v31, v1, 3, 1
v_mul_u32_u24 v17, 4608, v31
v_and_b32 v18, 7, v1
v_lshl_add_u32 v17, v18, 4, v17
v_add_u32 v16, v16, v17
v_cvt_f32_u32 v31, v31
s_lshl_b32 s33, s25, 10
s_add_u32 s33, s33, 147456
v_lshlrev_b32 v19, 4, v1
v_add_u32 v17, s33, v19
v_lshrrev_b32 v18, 5, v1
v_lshlrev_b32 v18, 5, v18
v_add_u32 v18, s33, v18
v_mov_b32 v28, v19
v_add_u32 v29, 73728, v19
v_add_u32 v19, s79, v19
s_mul_i32 s70, s77, 72
s_lshl_b32 s33, s78, 3
s_add_u32 s70, s70, s33
s_lshl_b32 s33, s25, 1
s_add_u32 s70, s70, s33
s_lshl_b32 s64, s70, 6
s_add_u32 s64, s64, 200704
s_lshl_b32 s70, s70, 10
s_add_u32 s70, s70, 10485760
v_mov_b32 v20, 0
v_mov_b32 v21, 0
v_mov_b32 v22, 0
v_mov_b32 v23, 0
s_mov_b32 s69, 0x3f803f80
s_waitcnt vmcnt(22)
ds_read_b128 v[64:67], v248 offset:0
ds_read_b128 v[68:71], v249 offset:0
ds_read_b128 v[72:75], v250 offset:0
ds_read_b128 v[76:79], v251 offset:0
s_waitcnt lgkmcnt(0)
v_dot2_f32_bf16 v20, v64, s69, v20
v_dot2_f32_bf16 v22, v64, v64, v22
v_dot2_f32_bf16 v21, v65, s69, v21
v_dot2_f32_bf16 v23, v65, v65, v23
v_dot2_f32_bf16 v20, v66, s69, v20
v_dot2_f32_bf16 v22, v66, v66, v22
v_dot2_f32_bf16 v21, v67, s69, v21
v_dot2_f32_bf16 v23, v67, v67, v23
v_dot2_f32_bf16 v20, v68, s69, v20
v_dot2_f32_bf16 v22, v68, v68, v22
v_dot2_f32_bf16 v21, v69, s69, v21
v_dot2_f32_bf16 v23, v69, v69, v23
v_dot2_f32_bf16 v20, v70, s69, v20
v_dot2_f32_bf16 v22, v70, v70, v22
v_dot2_f32_bf16 v21, v71, s69, v21
v_dot2_f32_bf16 v23, v71, v71, v23
v_dot2_f32_bf16 v20, v72, s69, v20
v_dot2_f32_bf16 v22, v72, v72, v22
v_dot2_f32_bf16 v21, v73, s69, v21
v_dot2_f32_bf16 v23, v73, v73, v23
v_dot2_f32_bf16 v20, v74, s69, v20
v_dot2_f32_bf16 v22, v74, v74, v22
v_dot2_f32_bf16 v21, v75, s69, v21
v_dot2_f32_bf16 v23, v75, v75, v23
v_dot2_f32_bf16 v20, v76, s69, v20
v_dot2_f32_bf16 v22, v76, v76, v22
v_dot2_f32_bf16 v21, v77, s69, v21
v_dot2_f32_bf16 v23, v77, v77, v23
v_dot2_f32_bf16 v20, v78, s69, v20
v_dot2_f32_bf16 v22, v78, v78, v22
v_dot2_f32_bf16 v21, v79, s69, v21
v_dot2_f32_bf16 v23, v79, v79, v23
s_waitcnt vmcnt(18)
ds_read_b128 v[80:83], v248 offset:4096
ds_read_b128 v[84:87], v249 offset:4096
ds_read_b128 v[88:91], v250 offset:4096
ds_read_b128 v[92:95], v251 offset:4096
s_waitcnt lgkmcnt(0)
v_dot2_f32_bf16 v20, v80, s69, v20
v_dot2_f32_bf16 v22, v80, v80, v22
v_dot2_f32_bf16 v21, v81, s69, v21
v_dot2_f32_bf16 v23, v81, v81, v23
v_dot2_f32_bf16 v20, v82, s69, v20
v_dot2_f32_bf16 v22, v82, v82, v22
v_dot2_f32_bf16 v21, v83, s69, v21
v_dot2_f32_bf16 v23, v83, v83, v23
v_dot2_f32_bf16 v20, v84, s69, v20
v_dot2_f32_bf16 v22, v84, v84, v22
v_dot2_f32_bf16 v21, v85, s69, v21
v_dot2_f32_bf16 v23, v85, v85, v23
v_dot2_f32_bf16 v20, v86, s69, v20
v_dot2_f32_bf16 v22, v86, v86, v22
v_dot2_f32_bf16 v21, v87, s69, v21
v_dot2_f32_bf16 v23, v87, v87, v23
v_dot2_f32_bf16 v20, v88, s69, v20
v_dot2_f32_bf16 v22, v88, v88, v22
v_dot2_f32_bf16 v21, v89, s69, v21
v_dot2_f32_bf16 v23, v89, v89, v23
v_dot2_f32_bf16 v20, v90, s69, v20
v_dot2_f32_bf16 v22, v90, v90, v22
v_dot2_f32_bf16 v21, v91, s69, v21
v_dot2_f32_bf16 v23, v91, v91, v23
v_dot2_f32_bf16 v20, v92, s69, v20
v_dot2_f32_bf16 v22, v92, v92, v22
v_dot2_f32_bf16 v21, v93, s69, v21
v_dot2_f32_bf16 v23, v93, v93, v23
v_dot2_f32_bf16 v20, v94, s69, v20
v_dot2_f32_bf16 v22, v94, v94, v22
v_dot2_f32_bf16 v21, v95, s69, v21
v_dot2_f32_bf16 v23, v95, v95, v23
s_waitcnt vmcnt(14)
ds_read_b128 v[96:99], v248 offset:8192
ds_read_b128 v[100:103], v249 offset:8192
ds_read_b128 v[104:107], v250 offset:8192
ds_read_b128 v[108:111], v251 offset:8192
s_waitcnt lgkmcnt(0)
v_dot2_f32_bf16 v20, v96, s69, v20
v_dot2_f32_bf16 v22, v96, v96, v22
v_dot2_f32_bf16 v21, v97, s69, v21
v_dot2_f32_bf16 v23, v97, v97, v23
v_dot2_f32_bf16 v20, v98, s69, v20
v_dot2_f32_bf16 v22, v98, v98, v22
v_dot2_f32_bf16 v21, v99, s69, v21
v_dot2_f32_bf16 v23, v99, v99, v23
v_dot2_f32_bf16 v20, v100, s69, v20
v_dot2_f32_bf16 v22, v100, v100, v22
v_dot2_f32_bf16 v21, v101, s69, v21
v_dot2_f32_bf16 v23, v101, v101, v23
v_dot2_f32_bf16 v20, v102, s69, v20
v_dot2_f32_bf16 v22, v102, v102, v22
v_dot2_f32_bf16 v21, v103, s69, v21
v_dot2_f32_bf16 v23, v103, v103, v23
v_dot2_f32_bf16 v20, v104, s69, v20
v_dot2_f32_bf16 v22, v104, v104, v22
v_dot2_f32_bf16 v21, v105, s69, v21
v_dot2_f32_bf16 v23, v105, v105, v23
v_dot2_f32_bf16 v20, v106, s69, v20
v_dot2_f32_bf16 v22, v106, v106, v22
v_dot2_f32_bf16 v21, v107, s69, v21
v_dot2_f32_bf16 v23, v107, v107, v23
v_dot2_f32_bf16 v20, v108, s69, v20
v_dot2_f32_bf16 v22, v108, v108, v22
v_dot2_f32_bf16 v21, v109, s69, v21
v_dot2_f32_bf16 v23, v109, v109, v23
v_dot2_f32_bf16 v20, v110, s69, v20
v_dot2_f32_bf16 v22, v110, v110, v22
v_dot2_f32_bf16 v21, v111, s69, v21
v_dot2_f32_bf16 v23, v111, v111, v23
s_waitcnt vmcnt(10)
ds_read_b128 v[112:115], v248 offset:12288
ds_read_b128 v[116:119], v249 offset:12288
ds_read_b128 v[120:123], v250 offset:12288
ds_read_b128 v[124:127], v251 offset:12288
s_waitcnt lgkmcnt(0)
s_waitcnt vmcnt(31)
ds_read_b64_tr_b16 a[96:97], v24 offset:28672
ds_read_b64_tr_b16 a[98:99], v24 offset:29696
ds_read_b64_tr_b16 a[100:101], v25 offset:28672
ds_read_b64_tr_b16 a[102:103], v25 offset:29696
ds_read_b64_tr_b16 a[104:105], v26 offset:28672
ds_read_b64_tr_b16 a[106:107], v26 offset:29696
ds_read_b64_tr_b16 a[108:109], v27 offset:28672
ds_read_b64_tr_b16 a[110:111], v27 offset:29696
s_waitcnt lgkmcnt(0)
s_add_u32 m0, s31, 0
s_nop 0
buffer_load_dwordx4 v12, s[20:23], s67 offen offset:0  lds
buffer_load_dwordx4 v13, s[20:23], s67 offen offset:1024  lds
buffer_load_dwordx4 v14, s[20:23], s67 offen offset:2048  lds
buffer_load_dwordx4 v15, s[20:23], s67 offen offset:3072  lds
s_add_u32 s67, s67, 110592
s_cmp_ge_u32 s67, s68
s_cselect_b32 s33, 1990656, 0
s_sub_u32 s67, s67, s33
s_waitcnt vmcnt(31)
ds_read_b64_tr_b16 a[112:113], v24 offset:32768
ds_read_b64_tr_b16 a[114:115], v24 offset:33792
ds_read_b64_tr_b16 a[116:117], v25 offset:32768
ds_read_b64_tr_b16 a[118:119], v25 offset:33792
ds_read_b64_tr_b16 a[120:121], v26 offset:32768
ds_read_b64_tr_b16 a[122:123], v26 offset:33792
ds_read_b64_tr_b16 a[124:125], v27 offset:32768
ds_read_b64_tr_b16 a[126:127], v27 offset:33792
s_waitcnt lgkmcnt(0)
s_add_u32 m0, s31, 4096
s_nop 0
buffer_load_dwordx4 v12, s[20:23], s67 offen offset:0  lds
buffer_load_dwordx4 v13, s[20:23], s67 offen offset:1024  lds
buffer_load_dwordx4 v14, s[20:23], s67 offen offset:2048  lds
buffer_load_dwordx4 v15, s[20:23], s67 offen offset:3072  lds
s_add_u32 s67, s67, 110592
s_cmp_ge_u32 s67, s68
s_cselect_b32 s33, 1990656, 0
s_sub_u32 s67, s67, s33
v_dot2_f32_bf16 v20, v112, s69, v20
v_dot2_f32_bf16 v22, v112, v112, v22
v_dot2_f32_bf16 v21, v113, s69, v21
v_dot2_f32_bf16 v23, v113, v113, v23
v_dot2_f32_bf16 v20, v114, s69, v20
v_dot2_f32_bf16 v22, v114, v114, v22
v_dot2_f32_bf16 v21, v115, s69, v21
v_dot2_f32_bf16 v23, v115, v115, v23
v_dot2_f32_bf16 v20, v116, s69, v20
v_dot2_f32_bf16 v22, v116, v116, v22
v_dot2_f32_bf16 v21, v117, s69, v21
v_dot2_f32_bf16 v23, v117, v117, v23
v_dot2_f32_bf16 v20, v118, s69, v20
v_dot2_f32_bf16 v22, v118, v118, v22
v_dot2_f32_bf16 v21, v119, s69, v21
v_dot2_f32_bf16 v23, v119, v119, v23
v_dot2_f32_bf16 v20, v120, s69, v20
v_dot2_f32_bf16 v22, v120, v120, v22
v_dot2_f32_bf16 v21, v121, s69, v21
v_dot2_f32_bf16 v23, v121, v121, v23
v_dot2_f32_bf16 v20, v122, s69, v20
v_dot2_f32_bf16 v22, v122, v122, v22
v_dot2_f32_bf16 v21, v123, s69, v21
v_dot2_f32_bf16 v23, v123, v123, v23
v_dot2_f32_bf16 v20, v124, s69, v20
v_dot2_f32_bf16 v22, v124, v124, v22
v_dot2_f32_bf16 v21, v125, s69, v21
v_dot2_f32_bf16 v23, v125, v125, v23
v_dot2_f32_bf16 v20, v126, s69, v20
v_dot2_f32_bf16 v22, v126, v126, v22
v_dot2_f32_bf16 v21, v127, s69, v21
v_dot2_f32_bf16 v23, v127, v127, v23
s_waitcnt vmcnt(16)
ds_read_b128 v[128:131], v252 offset:16384
ds_read_b128 v[132:135], v253 offset:16384
s_waitcnt lgkmcnt(0)
v_dot2_f32_bf16 v20, v128, s69, v20
v_dot2_f32_bf16 v22, v128, v128, v22
v_dot2_f32_bf16 v21, v129, s69, v21
v_dot2_f32_bf16 v23, v129, v129, v23
v_dot2_f32_bf16 v20, v130, s69, v20
v_dot2_f32_bf16 v22, v130, v130, v22
v_dot2_f32_bf16 v21, v131, s69, v21
v_dot2_f32_bf16 v23, v131, v131, v23
v_dot2_f32_bf16 v20, v132, s69, v20
v_dot2_f32_bf16 v22, v132, v132, v22
v_dot2_f32_bf16 v21, v133, s69, v21
v_dot2_f32_bf16 v23, v133, v133, v23
v_dot2_f32_bf16 v20, v134, s69, v20
v_dot2_f32_bf16 v22, v134, v134, v22
v_dot2_f32_bf16 v21, v135, s69, v21
v_dot2_f32_bf16 v23, v135, v135, v23
buffer_load_dwordx4 v[32:35], v16, s[4:7], s71 offen sc1
s_nop 0
v_add_f32 v20, v20, v21
v_add_f32 v22, v22, v23
s_nop 1
v_permlane32_swap_b32 v20, v22
v_add_f32 v20, v20, v22
s_lshl_b32 s33, s25, 8
s_add_u32 s33, s33, 156672
v_lshlrev_b32 v5, 2, v1
v_add_u32 v5, s33, v5
v_and_b32 v4, 31, v1
v_lshlrev_b32 v4, 2, v4
v_add_u32 v4, 156672, v4
ds_write_b32 v5, v20
s_waitcnt lgkmcnt(0)
s_barrier
ds_read2_b32 v[240:241], v4 offset0:0 offset1:32
ds_read2_b32 v[242:243], v4 offset0:64 offset1:96
ds_read2_b32 v[244:245], v4 offset0:128 offset1:160
ds_read2_b32 v[246:247], v4 offset0:192 offset1:224
v_lshlrev_b32 v40, 16, v208
v_and_b32 v41, s100, v208
v_lshlrev_b32 v42, 16, v209
v_and_b32 v43, s100, v209
v_lshlrev_b32 v44, 16, v210
v_and_b32 v45, s100, v210
v_lshlrev_b32 v46, 16, v211
v_and_b32 v47, s100, v211
v_lshlrev_b32 v48, 16, v212
v_and_b32 v49, s100, v212
v_lshlrev_b32 v50, 16, v213
v_and_b32 v51, s100, v213
v_lshlrev_b32 v52, 16, v214
v_and_b32 v53, s100, v214
v_lshlrev_b32 v54, 16, v215
v_and_b32 v55, s100, v215
s_waitcnt lgkmcnt(0)
v_add_f32 v240, v240, v242
v_add_f32 v241, v241, v243
v_add_f32 v244, v244, v246
v_add_f32 v245, v245, v247
v_add_f32 v240, v240, v244
v_add_f32 v241, v241, v245
v_mul_f32 v240, 0x3a638e39, v240
v_mul_f32 v241, 0x3a638e39, v241
v_fma_f32 v241, -v240, v240, v241
v_max_f32 v241, 0, v241
v_add_f32 v241, 0x3727c5ac, v241
v_rsq_f32 v4, v241
s_nop 0
v_mul_f32 v5, v240, v4
v_sub_f32 v5, 0, v5
v_pk_fma_f32 v[40:41], v[40:41], v[4:5], v[4:5] op_sel:[0,0,1] op_sel_hi:[1,0,1]
v_pk_fma_f32 v[42:43], v[42:43], v[4:5], v[4:5] op_sel:[0,0,1] op_sel_hi:[1,0,1]
v_pk_fma_f32 v[44:45], v[44:45], v[4:5], v[4:5] op_sel:[0,0,1] op_sel_hi:[1,0,1]
v_pk_fma_f32 v[46:47], v[46:47], v[4:5], v[4:5] op_sel:[0,0,1] op_sel_hi:[1,0,1]
v_pk_fma_f32 v[48:49], v[48:49], v[4:5], v[4:5] op_sel:[0,0,1] op_sel_hi:[1,0,1]
v_pk_fma_f32 v[50:51], v[50:51], v[4:5], v[4:5] op_sel:[0,0,1] op_sel_hi:[1,0,1]
v_pk_fma_f32 v[52:53], v[52:53], v[4:5], v[4:5] op_sel:[0,0,1] op_sel_hi:[1,0,1]
v_pk_fma_f32 v[54:55], v[54:55], v[4:5], v[4:5] op_sel:[0,0,1] op_sel_hi:[1,0,1]
s_mov_b32 s33, 20000
s_waitcnt vmcnt(0)
s_branch mc_3
mp_1:
buffer_load_dwordx4 v[32:35], v16, s[4:7], s71 offen sc1
s_waitcnt vmcnt(0)
mc_3:
v_cmp_ne_u32 vcc, s24, v35
s_sub_u32 s33, s33, 1
s_cmp_eq_u32 s33, 0
s_cbranch_scc1 me_2
s_nop 1
s_cbranch_vccnz mp_1
me_2:
v_perm_b32 v240, v33, v32, s72
v_perm_b32 v35, v34, v240, s73
v_permlane32_swap_b32 v32, v33
s_nop 0
v_permlane32_swap_b32 v34, v35
v_add_f32 v32, v32, v33
v_add_f32 v34, v34, v35
s_nop 1
v_permlane16_swap_b32 v32, v34
v_add_f32 v32, v32, v34
v_cvt_pk_bf16_f32 v32, v32, v32
v_and_b32 v32, s100, v32
v_add_f32 v32, v31, v32
v_cvt_pk_bf16_f32 v32, v32, v32
v_and_b32 v32, s100, v32
v_and_b32 v6, 15, v1
v_lshlrev_b32 v6, 4, v6
v_bfe_u32 v7, v1, 4, 1
v_lshl_add_u32 v6, v7, 3, v6
v_lshrrev_b32 v7, 5, v1
v_lshl_add_u32 v6, v7, 2, v6
s_lshl_b32 s33, s25, 10
s_add_u32 s33, s33, 147456
v_add_u32 v6, s33, v6
ds_write_b32 v6, v32
ds_read_b128 v[216:219], v18 offset:0
ds_read_b128 v[220:223], v18 offset:16
ds_read_b128 v[224:227], v18 offset:128
ds_read_b128 v[228:231], v18 offset:144
ds_read_b128 v[232:235], v18 offset:64
ds_read_b128 v[236:239], v18 offset:80
ds_read_b128 v[240:243], v18 offset:192
ds_read_b128 v[244:247], v18 offset:208
s_waitcnt lgkmcnt(4)
v_pk_fma_f32 v[40:41], v[40:41], v[224:225], v[216:217]
v_pk_fma_f32 v[42:43], v[42:43], v[226:227], v[218:219]
v_pk_fma_f32 v[44:45], v[44:45], v[228:229], v[220:221]
v_pk_fma_f32 v[46:47], v[46:47], v[230:231], v[222:223]
v_cvt_pk_bf16_f32 v208, v40, v41
v_cvt_pk_bf16_f32 v209, v42, v43
v_cvt_pk_bf16_f32 v210, v44, v45
v_cvt_pk_bf16_f32 v211, v46, v47
buffer_store_dwordx4 v[208:211], v19, s[4:7], s70 offen offset:0 sc1
s_waitcnt lgkmcnt(0)
v_pk_fma_f32 v[48:49], v[48:49], v[240:241], v[232:233]
v_pk_fma_f32 v[50:51], v[50:51], v[242:243], v[234:235]
v_pk_fma_f32 v[52:53], v[52:53], v[244:245], v[236:237]
v_pk_fma_f32 v[54:55], v[54:55], v[246:247], v[238:239]
v_cvt_pk_bf16_f32 v212, v48, v49
v_cvt_pk_bf16_f32 v213, v50, v51
v_cvt_pk_bf16_f32 v214, v52, v53
v_cvt_pk_bf16_f32 v215, v54, v55
buffer_store_dwordx4 v[212:215], v19, s[4:7], s70 offen offset:1024 sc1
v_cmp_eq_u32 vcc, 0, v1
v_mov_b32 v6, 0x7fffffff
v_mov_b32 v7, s79
v_cndmask_b32 v6, v6, v7, vcc
v_mov_b32 v7, s24
s_add_u32 m0, s31, 8192
s_nop 0
buffer_load_dwordx4 v12, s[20:23], s67 offen offset:0  lds
buffer_load_dwordx4 v13, s[20:23], s67 offen offset:1024  lds
buffer_load_dwordx4 v14, s[20:23], s67 offen offset:2048  lds
buffer_load_dwordx4 v15, s[20:23], s67 offen offset:3072  lds
s_add_u32 s67, s67, 110592
s_cmp_ge_u32 s67, s68
s_cselect_b32 s33, 1990656, 0
s_sub_u32 s67, s67, s33
s_add_u32 m0, s31, 28672
s_nop 0
buffer_load_dwordx4 v12, s[20:23], s67 offen offset:0  lds
buffer_load_dwordx4 v13, s[20:23], s67 offen offset:1024  lds
buffer_load_dwordx4 v14, s[20:23], s67 offen offset:2048  lds
buffer_load_dwordx4 v15, s[20:23], s67 offen offset:3072  lds
s_add_u32 s67, s67, 110592
s_cmp_ge_u32 s67, s68
s_cselect_b32 s33, 1990656, 0
s_sub_u32 s67, s67, s33
s_waitcnt vmcnt(8)
buffer_store_dword v7, v6, s[4:7], s64 offen sc1
s_mul_i32 s33, s30, 72
s_mul_i32 s32, s25, 9
s_add_u32 s33, s33, s32
s_add_u32 s33, s33, 1568
v_min_u32 v8, 17, v1
v_and_b32 v9, 1, v8
v_mul_u32_u24 v9, 36, v9
v_lshrrev_b32 v8, 1, v8
v_add3_u32 v8, v8, v9, s33
v_lshlrev_b32 v8, 7, v8
s_mul_i32 s98, s30, 147456
s_mul_i32 s33, s25, 18432
s_add_u32 s98, s98, s33
s_add_u32 s98, s98, 10485760
s_lshl_b32 s97, s99, 10
s_add_u32 s97, s97, s98
s_add_u32 s98, s98, 18432
s_lshr_b32 s60, s26, 1
s_lshl_b32 s60, s60, 1
s_and_b32 s33, s27, 1
s_add_u32 s60, s60, s33
s_and_b32 s61, s26, 1
s_mul_i32 s61, s61, 9
s_lshr_b32 s63, s27, 1
s_min_u32 s63, s63, 8
s_add_u32 s61, s61, s63
s_mov_b32 s8, s44
s_mov_b32 s9, s45
s_mov_b32 s10, 2654208
s_mov_b32 s11, 0x20000
v_lshrrev_b32 v30, 3, v1
v_mul_u32_u24 v30, 2304, v30
v_lshrrev_b32 v31, 4, v1
v_lshlrev_b32 v31, 1, v31
v_and_b32 v20, 7, v1
v_xor_b32 v31, v31, v20
v_lshl_add_u32 v20, v31, 4, v30
v_add_u32 v21, 17408, v20
v_add_u32 v22, 34816, v20
v_add_u32 v23, 52224, v20
s_mul_i32 s62, s25, 663552
s_lshl_b32 s33, s61, 7
s_add_u32 s62, s62, s33
s_lshl_b32 s33, s26, 5
s_add_u32 s33, s33, s27
s_mul_i32 s65, s33, 27648
s_mul_i32 s33, s26, 24
s_add_u32 s33, s33, s27
s_sub_u32 s33, s33, 72
s_mul_i32 s33, s33, 24576
s_cmp_lt_u32 s26, 3
s_cselect_b32 s65, s65, s33
s_cselect_b32 s12, s50, s46
s_cselect_b32 s13, s51, s47
s_cselect_b32 s33, 24, 0
s_add_u32 s33, s33, 191
v_min_u32 v4, s33, v0
v_lshlrev_b32 v4, 7, v4
v_add_u32 v4, s65, v4
s_mov_b32 s14, 2654208
s_add_u32 m0, s31, 32768
s_nop 0
buffer_load_dwordx4 v12, s[20:23], s67 offen offset:0  lds
buffer_load_dwordx4 v13, s[20:23], s67 offen offset:1024  lds
buffer_load_dwordx4 v14, s[20:23], s67 offen offset:2048  lds
buffer_load_dwordx4 v15, s[20:23], s67 offen offset:3072  lds
s_add_u32 s67, s67, 110592
s_cmp_ge_u32 s67, s68
s_cselect_b32 s33, 1990656, 0
s_sub_u32 s67, s67, s33
s_add_u32 m0, s31, 12288
s_nop 0
buffer_load_dwordx4 v12, s[20:23], s67 offen offset:0  lds
buffer_load_dwordx4 v13, s[20:23], s67 offen offset:1024  lds
buffer_load_dwordx4 v14, s[20:23], s67 offen offset:2048  lds
buffer_load_dwordx4 v15, s[20:23], s67 offen offset:3072  lds
s_add_u32 s67, s67, 110592
s_cmp_ge_u32 s67, s68
s_cselect_b32 s33, 1990656, 0
s_sub_u32 s67, s67, s33
s_add_u32 m0, s31, 16384
s_nop 0
buffer_load_dwordx4 v12, s[20:23], s67 offen offset:0  lds
buffer_load_dwordx4 v13, s[20:23], s67 offen offset:1024  lds
buffer_load_dwordx4 v14, s[20:23], s67 offen offset:2048  lds
buffer_load_dwordx4 v15, s[20:23], s67 offen offset:3072  lds
s_add_u32 s67, s67, 110592
s_cmp_ge_u32 s67, s68
s_cselect_b32 s33, 1990656, 0
s_sub_u32 s67, s67, s33
s_waitcnt vmcnt(36)
ds_read_b64_tr_b16 a[128:129], v24 offset:20480
ds_read_b64_tr_b16 a[130:131], v24 offset:21504
ds_read_b64_tr_b16 a[132:133], v25 offset:20480
ds_read_b64_tr_b16 a[134:135], v25 offset:21504
ds_read_b64_tr_b16 a[136:137], v26 offset:20480
ds_read_b64_tr_b16 a[138:139], v26 offset:21504
ds_read_b64_tr_b16 a[140:141], v27 offset:20480
ds_read_b64_tr_b16 a[142:143], v27 offset:21504
s_waitcnt lgkmcnt(0)
s_add_u32 m0, s31, 20480
s_nop 0
buffer_load_dwordx4 v12, s[20:23], s67 offen offset:0  lds
buffer_load_dwordx4 v13, s[20:23], s67 offen offset:1024  lds
buffer_load_dwordx4 v14, s[20:23], s67 offen offset:2048  lds
buffer_load_dwordx4 v15, s[20:23], s67 offen offset:3072  lds
s_add_u32 s67, s67, 110592
s_cmp_ge_u32 s67, s68
s_cselect_b32 s33, 1990656, 0
s_sub_u32 s67, s67, s33
s_waitcnt vmcnt(36)
ds_read_b64_tr_b16 a[144:145], v24 offset:24576
ds_read_b64_tr_b16 a[146:147], v24 offset:25600
ds_read_b64_tr_b16 a[148:149], v25 offset:24576
ds_read_b64_tr_b16 a[150:151], v25 offset:25600
ds_read_b64_tr_b16 a[152:153], v26 offset:24576
ds_read_b64_tr_b16 a[154:155], v26 offset:25600
ds_read_b64_tr_b16 a[156:157], v27 offset:24576
ds_read_b64_tr_b16 a[158:159], v27 offset:25600
s_waitcnt lgkmcnt(0)
s_add_u32 m0, s31, 24576
s_nop 0
buffer_load_dwordx4 v12, s[20:23], s67 offen offset:0  lds
buffer_load_dwordx4 v13, s[20:23], s67 offen offset:1024  lds
buffer_load_dwordx4 v14, s[20:23], s67 offen offset:2048  lds
buffer_load_dwordx4 v15, s[20:23], s67 offen offset:3072  lds
s_add_u32 s67, s67, 110592
s_cmp_ge_u32 s67, s68
s_cselect_b32 s33, 1990656, 0
s_sub_u32 s67, s67, s33
s_waitcnt vmcnt(36)
ds_read_b64_tr_b16 a[160:161], v24 offset:0
ds_read_b64_tr_b16 a[162:163], v24 offset:1024
ds_read_b64_tr_b16 a[164:165], v25 offset:0
ds_read_b64_tr_b16 a[166:167], v25 offset:1024
ds_read_b64_tr_b16 a[168:169], v26 offset:0
ds_read_b64_tr_b16 a[170:171], v26 offset:1024
ds_read_b64_tr_b16 a[172:173], v27 offset:0
ds_read_b64_tr_b16 a[174:175], v27 offset:1024
s_waitcnt lgkmcnt(0)
s_add_u32 m0, s31, 0
s_nop 0
buffer_load_dwordx4 v12, s[20:23], s67 offen offset:0  lds
buffer_load_dwordx4 v13, s[20:23], s67 offen offset:1024  lds
buffer_load_dwordx4 v14, s[20:23], s67 offen offset:2048  lds
buffer_load_dwordx4 v15, s[20:23], s67 offen offset:3072  lds
s_add_u32 s67, s67, 110592
s_cmp_ge_u32 s67, s68
s_cselect_b32 s33, 1990656, 0
s_sub_u32 s67, s67, s33
s_waitcnt vmcnt(36)
ds_read_b64_tr_b16 a[176:177], v24 offset:4096
ds_read_b64_tr_b16 a[178:179], v24 offset:5120
ds_read_b64_tr_b16 a[180:181], v25 offset:4096
ds_read_b64_tr_b16 a[182:183], v25 offset:5120
ds_read_b64_tr_b16 a[184:185], v26 offset:4096
ds_read_b64_tr_b16 a[186:187], v26 offset:5120
ds_read_b64_tr_b16 a[188:189], v27 offset:4096
ds_read_b64_tr_b16 a[190:191], v27 offset:5120
s_waitcnt lgkmcnt(0)
s_add_u32 m0, s31, 4096
s_nop 0
buffer_load_dwordx4 v12, s[20:23], s67 offen offset:0  lds
buffer_load_dwordx4 v13, s[20:23], s67 offen offset:1024  lds
buffer_load_dwordx4 v14, s[20:23], s67 offen offset:2048  lds
buffer_load_dwordx4 v15, s[20:23], s67 offen offset:3072  lds
s_add_u32 s67, s67, 110592
s_cmp_ge_u32 s67, s68
s_cselect_b32 s33, 1990656, 0
s_sub_u32 s67, s67, s33
s_waitcnt vmcnt(33)
ds_read_b64_tr_b16 a[192:193], v24 offset:8192
ds_read_b64_tr_b16 a[194:195], v24 offset:9216
ds_read_b64_tr_b16 a[196:197], v25 offset:8192
ds_read_b64_tr_b16 a[198:199], v25 offset:9216
ds_read_b64_tr_b16 a[200:201], v26 offset:8192
ds_read_b64_tr_b16 a[202:203], v26 offset:9216
ds_read_b64_tr_b16 a[204:205], v27 offset:8192
ds_read_b64_tr_b16 a[206:207], v27 offset:9216
s_waitcnt lgkmcnt(0)
s_add_u32 m0, s31, 8192
s_nop 0
buffer_load_dwordx4 v12, s[20:23], s67 offen offset:0  lds
buffer_load_dwordx4 v13, s[20:23], s67 offen offset:1024  lds
buffer_load_dwordx4 v14, s[20:23], s67 offen offset:2048  lds
buffer_load_dwordx4 v15, s[20:23], s67 offen offset:3072  lds
s_add_u32 s67, s67, 110592
s_cmp_ge_u32 s67, s68
s_cselect_b32 s33, 1990656, 0
s_sub_u32 s67, s67, s33
s_waitcnt vmcnt(33)
ds_read_b64_tr_b16 a[208:209], v24 offset:28672
ds_read_b64_tr_b16 a[210:211], v24 offset:29696
ds_read_b64_tr_b16 a[212:213], v25 offset:28672
ds_read_b64_tr_b16 a[214:215], v25 offset:29696
ds_read_b64_tr_b16 a[216:217], v26 offset:28672
ds_read_b64_tr_b16 a[218:219], v26 offset:29696
ds_read_b64_tr_b16 a[220:221], v27 offset:28672
ds_read_b64_tr_b16 a[222:223], v27 offset:29696
s_waitcnt lgkmcnt(0)
s_add_u32 m0, s31, 28672
s_nop 0
buffer_load_dwordx4 v12, s[20:23], s67 offen offset:0  lds
buffer_load_dwordx4 v13, s[20:23], s67 offen offset:1024  lds
buffer_load_dwordx4 v14, s[20:23], s67 offen offset:2048  lds
buffer_load_dwordx4 v15, s[20:23], s67 offen offset:3072  lds
s_add_u32 s67, s67, 110592
s_cmp_ge_u32 s67, s68
s_cselect_b32 s33, 1990656, 0
s_sub_u32 s67, s67, s33
s_waitcnt vmcnt(32)
ds_read_b64_tr_b16 a[224:225], v24 offset:32768
ds_read_b64_tr_b16 a[226:227], v24 offset:33792
ds_read_b64_tr_b16 a[228:229], v25 offset:32768
ds_read_b64_tr_b16 a[230:231], v25 offset:33792
ds_read_b64_tr_b16 a[232:233], v26 offset:32768
ds_read_b64_tr_b16 a[234:235], v26 offset:33792
ds_read_b64_tr_b16 a[236:237], v27 offset:32768
ds_read_b64_tr_b16 a[238:239], v27 offset:33792
s_waitcnt lgkmcnt(0)
s_add_u32 m0, s31, 32768
s_nop 0
buffer_load_dwordx4 v12, s[20:23], s67 offen offset:0  lds
buffer_load_dwordx4 v13, s[20:23], s67 offen offset:1024  lds
buffer_load_dwordx4 v14, s[20:23], s67 offen offset:2048  lds
buffer_load_dwordx4 v15, s[20:23], s67 offen offset:3072  lds
s_add_u32 s67, s67, 110592
s_cmp_ge_u32 s67, s68
s_cselect_b32 s33, 1990656, 0
s_sub_u32 s67, s67, s33
s_mov_b32 s33, 20000
poll_4:
buffer_load_dword v9, v8, s[4:7], 0 offen sc1
s_waitcnt vmcnt(0)
v_cmp_ne_u32 vcc, s24, v9
s_sub_u32 s33, s33, 1
s_cmp_eq_u32 s33, 0
s_cbranch_scc1 pe_5
s_nop 1
s_cbranch_vccnz poll_4
pe_5:
buffer_load_dwordx4 v[64:67], v28, s[4:7], s97 offen sc1
buffer_load_dwordx4 v[68:71], v29, s[4:7], s97 offen sc1
s_add_u32 s97, s97, 1024
s_cmp_ge_u32 s97, s98
s_cselect_b32 s33, 18432, 0
s_sub_u32 s97, s97, s33
buffer_load_dwordx4 v[72:75], v28, s[4:7], s97 offen sc1
buffer_load_dwordx4 v[76:79], v29, s[4:7], s97 offen sc1
s_add_u32 s97, s97, 1024
s_cmp_ge_u32 s97, s98
s_cselect_b32 s33, 18432, 0
s_sub_u32 s97, s97, s33
buffer_load_dwordx4 v[80:83], v28, s[4:7], s97 offen sc1
buffer_load_dwordx4 v[84:87], v29, s[4:7], s97 offen sc1
s_add_u32 s97, s97, 1024
s_cmp_ge_u32 s97, s98
s_cselect_b32 s33, 18432, 0
s_sub_u32 s97, s97, s33
buffer_load_dwordx4 v[88:91], v28, s[4:7], s97 offen sc1
buffer_load_dwordx4 v[92:95], v29, s[4:7], s97 offen sc1
s_add_u32 s97, s97, 1024
s_cmp_ge_u32 s97, s98
s_cselect_b32 s33, 18432, 0
s_sub_u32 s97, s97, s33
buffer_load_dwordx4 v[96:99], v28, s[4:7], s97 offen sc1
buffer_load_dwordx4 v[100:103], v29, s[4:7], s97 offen sc1
s_add_u32 s97, s97, 1024
s_cmp_ge_u32 s97, s98
s_cselect_b32 s33, 18432, 0
s_sub_u32 s97, s97, s33
buffer_load_dwordx4 v[104:107], v28, s[4:7], s97 offen sc1
buffer_load_dwordx4 v[108:111], v29, s[4:7], s97 offen sc1
s_add_u32 s97, s97, 1024
s_cmp_ge_u32 s97, s98
s_cselect_b32 s33, 18432, 0
s_sub_u32 s97, s97, s33
s_waitcnt vmcnt(10)
v_mfma_f32_32x32x16_bf16 a[0:15], a[96:99], v[64:67], 0
v_mfma_f32_32x32x16_bf16 a[16:31], a[96:99], v[68:71], 0
v_mfma_f32_32x32x16_bf16 a[32:47], a[100:103], v[64:67], 0
v_mfma_f32_32x32x16_bf16 a[48:63], a[100:103], v[68:71], 0
v_mfma_f32_32x32x16_bf16 a[64:79], a[104:107], v[64:67], 0
buffer_load_dwordx4 v[112:115], v28, s[4:7], s97 offen sc1
v_mfma_f32_32x32x16_bf16 a[80:95], a[104:107], v[68:71], 0
v_mfma_f32_32x32x16_bf16 v[32:47], a[108:111], v[64:67], 0
buffer_load_dwordx4 v[116:119], v29, s[4:7], s97 offen sc1
s_add_u32 s97, s97, 1024
s_cmp_ge_u32 s97, s98
s_cselect_b32 s33, 18432, 0
s_sub_u32 s97, s97, s33
v_mfma_f32_32x32x16_bf16 v[48:63], a[108:111], v[68:71], 0
s_waitcnt vmcnt(10)
v_mfma_f32_32x32x16_bf16 a[0:15], a[112:115], v[72:75], a[0:15]
ds_read_b64_tr_b16 a[96:97], v24 offset:12288
ds_read_b64_tr_b16 a[98:99], v24 offset:13312
v_mfma_f32_32x32x16_bf16 a[16:31], a[112:115], v[76:79], a[16:31]
ds_read_b64_tr_b16 a[100:101], v25 offset:12288
ds_read_b64_tr_b16 a[102:103], v25 offset:13312
v_mfma_f32_32x32x16_bf16 a[32:47], a[116:119], v[72:75], a[32:47]
ds_read_b64_tr_b16 a[104:105], v26 offset:12288
ds_read_b64_tr_b16 a[106:107], v26 offset:13312
v_mfma_f32_32x32x16_bf16 a[48:63], a[116:119], v[76:79], a[48:63]
ds_read_b64_tr_b16 a[108:109], v27 offset:12288
ds_read_b64_tr_b16 a[110:111], v27 offset:13312
v_mfma_f32_32x32x16_bf16 a[64:79], a[120:123], v[72:75], a[64:79]
buffer_load_dwordx4 v[120:123], v28, s[4:7], s97 offen sc1
v_mfma_f32_32x32x16_bf16 a[80:95], a[120:123], v[76:79], a[80:95]
v_mfma_f32_32x32x16_bf16 v[32:47], a[124:127], v[72:75], v[32:47]
buffer_load_dwordx4 v[124:127], v29, s[4:7], s97 offen sc1
s_add_u32 s97, s97, 1024
s_cmp_ge_u32 s97, s98
s_cselect_b32 s33, 18432, 0
s_sub_u32 s97, s97, s33
v_mfma_f32_32x32x16_bf16 v[48:63], a[124:127], v[76:79], v[48:63]
s_waitcnt vmcnt(10)
v_mfma_f32_32x32x16_bf16 a[0:15], a[128:131], v[80:83], a[0:15]
ds_read_b64_tr_b16 a[112:113], v24 offset:16384
ds_read_b64_tr_b16 a[114:115], v24 offset:17408
v_mfma_f32_32x32x16_bf16 a[16:31], a[128:131], v[84:87], a[16:31]
ds_read_b64_tr_b16 a[116:117], v25 offset:16384
ds_read_b64_tr_b16 a[118:119], v25 offset:17408
v_mfma_f32_32x32x16_bf16 a[32:47], a[132:135], v[80:83], a[32:47]
ds_read_b64_tr_b16 a[120:121], v26 offset:16384
ds_read_b64_tr_b16 a[122:123], v26 offset:17408
v_mfma_f32_32x32x16_bf16 a[48:63], a[132:135], v[84:87], a[48:63]
ds_read_b64_tr_b16 a[124:125], v27 offset:16384
ds_read_b64_tr_b16 a[126:127], v27 offset:17408
v_mfma_f32_32x32x16_bf16 a[64:79], a[136:139], v[80:83], a[64:79]
buffer_load_dwordx4 v[128:131], v28, s[4:7], s97 offen sc1
v_mfma_f32_32x32x16_bf16 a[80:95], a[136:139], v[84:87], a[80:95]
v_mfma_f32_32x32x16_bf16 v[32:47], a[140:143], v[80:83], v[32:47]
buffer_load_dwordx4 v[132:135], v29, s[4:7], s97 offen sc1
s_add_u32 s97, s97, 1024
s_cmp_ge_u32 s97, s98
s_cselect_b32 s33, 18432, 0
s_sub_u32 s97, s97, s33
v_mfma_f32_32x32x16_bf16 v[48:63], a[140:143], v[84:87], v[48:63]
s_waitcnt vmcnt(10)
v_mfma_f32_32x32x16_bf16 a[0:15], a[144:147], v[88:91], a[0:15]
ds_read_b64_tr_b16 a[128:129], v24 offset:20480
ds_read_b64_tr_b16 a[130:131], v24 offset:21504
v_mfma_f32_32x32x16_bf16 a[16:31], a[144:147], v[92:95], a[16:31]
ds_read_b64_tr_b16 a[132:133], v25 offset:20480
ds_read_b64_tr_b16 a[134:135], v25 offset:21504
v_mfma_f32_32x32x16_bf16 a[32:47], a[148:151], v[88:91], a[32:47]
ds_read_b64_tr_b16 a[136:137], v26 offset:20480
ds_read_b64_tr_b16 a[138:139], v26 offset:21504
v_mfma_f32_32x32x16_bf16 a[48:63], a[148:151], v[92:95], a[48:63]
ds_read_b64_tr_b16 a[140:141], v27 offset:20480
ds_read_b64_tr_b16 a[142:143], v27 offset:21504
v_mfma_f32_32x32x16_bf16 a[64:79], a[152:155], v[88:91], a[64:79]
buffer_load_dwordx4 v[136:139], v28, s[4:7], s97 offen sc1
v_mfma_f32_32x32x16_bf16 a[80:95], a[152:155], v[92:95], a[80:95]
v_mfma_f32_32x32x16_bf16 v[32:47], a[156:159], v[88:91], v[32:47]
buffer_load_dwordx4 v[140:143], v29, s[4:7], s97 offen sc1
s_add_u32 s97, s97, 1024
s_cmp_ge_u32 s97, s98
s_cselect_b32 s33, 18432, 0
s_sub_u32 s97, s97, s33
v_mfma_f32_32x32x16_bf16 v[48:63], a[156:159], v[92:95], v[48:63]
s_waitcnt vmcnt(10)
v_mfma_f32_32x32x16_bf16 a[0:15], a[160:163], v[96:99], a[0:15]
ds_read_b64_tr_b16 a[144:145], v24 offset:24576
ds_read_b64_tr_b16 a[146:147], v24 offset:25600
v_mfma_f32_32x32x16_bf16 a[16:31], a[160:163], v[100:103], a[16:31]
ds_read_b64_tr_b16 a[148:149], v25 offset:24576
ds_read_b64_tr_b16 a[150:151], v25 offset:25600
v_mfma_f32_32x32x16_bf16 a[32:47], a[164:167], v[96:99], a[32:47]
ds_read_b64_tr_b16 a[152:153], v26 offset:24576
ds_read_b64_tr_b16 a[154:155], v26 offset:25600
v_mfma_f32_32x32x16_bf16 a[48:63], a[164:167], v[100:103], a[48:63]
ds_read_b64_tr_b16 a[156:157], v27 offset:24576
ds_read_b64_tr_b16 a[158:159], v27 offset:25600
v_mfma_f32_32x32x16_bf16 a[64:79], a[168:171], v[96:99], a[64:79]
buffer_load_dwordx4 v[144:147], v28, s[4:7], s97 offen sc1
v_mfma_f32_32x32x16_bf16 a[80:95], a[168:171], v[100:103], a[80:95]
v_mfma_f32_32x32x16_bf16 v[32:47], a[172:175], v[96:99], v[32:47]
buffer_load_dwordx4 v[148:151], v29, s[4:7], s97 offen sc1
s_add_u32 s97, s97, 1024
s_cmp_ge_u32 s97, s98
s_cselect_b32 s33, 18432, 0
s_sub_u32 s97, s97, s33
v_mfma_f32_32x32x16_bf16 v[48:63], a[172:175], v[100:103], v[48:63]
buffer_load_dword v6, v4, s[12:15], 0 offen
s_waitcnt vmcnt(11)
v_mfma_f32_32x32x16_bf16 a[0:15], a[176:179], v[104:107], a[0:15]
ds_read_b64_tr_b16 a[160:161], v24 offset:0
ds_read_b64_tr_b16 a[162:163], v24 offset:1024
v_mfma_f32_32x32x16_bf16 a[16:31], a[176:179], v[108:111], a[16:31]
ds_read_b64_tr_b16 a[164:165], v25 offset:0
ds_read_b64_tr_b16 a[166:167], v25 offset:1024
v_mfma_f32_32x32x16_bf16 a[32:47], a[180:183], v[104:107], a[32:47]
ds_read_b64_tr_b16 a[168:169], v26 offset:0
ds_read_b64_tr_b16 a[170:171], v26 offset:1024
v_mfma_f32_32x32x16_bf16 a[48:63], a[180:183], v[108:111], a[48:63]
ds_read_b64_tr_b16 a[172:173], v27 offset:0
ds_read_b64_tr_b16 a[174:175], v27 offset:1024
v_mfma_f32_32x32x16_bf16 a[64:79], a[184:187], v[104:107], a[64:79]
buffer_load_dwordx4 v[152:155], v28, s[4:7], s97 offen sc1
v_mfma_f32_32x32x16_bf16 a[80:95], a[184:187], v[108:111], a[80:95]
v_mfma_f32_32x32x16_bf16 v[32:47], a[188:191], v[104:107], v[32:47]
buffer_load_dwordx4 v[156:159], v29, s[4:7], s97 offen sc1
s_add_u32 s97, s97, 1024
s_cmp_ge_u32 s97, s98
s_cselect_b32 s33, 18432, 0
s_sub_u32 s97, s97, s33
v_mfma_f32_32x32x16_bf16 v[48:63], a[188:191], v[108:111], v[48:63]
s_waitcnt vmcnt(11)
v_mfma_f32_32x32x16_bf16 a[0:15], a[192:195], v[112:115], a[0:15]
ds_read_b64_tr_b16 a[176:177], v24 offset:4096
ds_read_b64_tr_b16 a[178:179], v24 offset:5120
v_mfma_f32_32x32x16_bf16 a[16:31], a[192:195], v[116:119], a[16:31]
ds_read_b64_tr_b16 a[180:181], v25 offset:4096
ds_read_b64_tr_b16 a[182:183], v25 offset:5120
v_mfma_f32_32x32x16_bf16 a[32:47], a[196:199], v[112:115], a[32:47]
ds_read_b64_tr_b16 a[184:185], v26 offset:4096
ds_read_b64_tr_b16 a[186:187], v26 offset:5120
v_mfma_f32_32x32x16_bf16 a[48:63], a[196:199], v[116:119], a[48:63]
ds_read_b64_tr_b16 a[188:189], v27 offset:4096
ds_read_b64_tr_b16 a[190:191], v27 offset:5120
v_mfma_f32_32x32x16_bf16 a[64:79], a[200:203], v[112:115], a[64:79]
buffer_load_dwordx4 v[160:163], v28, s[4:7], s97 offen sc1
v_mfma_f32_32x32x16_bf16 a[80:95], a[200:203], v[116:119], a[80:95]
v_mfma_f32_32x32x16_bf16 v[32:47], a[204:207], v[112:115], v[32:47]
buffer_load_dwordx4 v[164:167], v29, s[4:7], s97 offen sc1
s_add_u32 s97, s97, 1024
s_cmp_ge_u32 s97, s98
s_cselect_b32 s33, 18432, 0
s_sub_u32 s97, s97, s33
v_mfma_f32_32x32x16_bf16 v[48:63], a[204:207], v[116:119], v[48:63]
s_waitcnt vmcnt(11)
v_mfma_f32_32x32x16_bf16 a[0:15], a[208:211], v[120:123], a[0:15]
ds_read_b64_tr_b16 a[192:193], v24 offset:8192
ds_read_b64_tr_b16 a[194:195], v24 offset:9216
v_mfma_f32_32x32x16_bf16 a[16:31], a[208:211], v[124:127], a[16:31]
ds_read_b64_tr_b16 a[196:197], v25 offset:8192
ds_read_b64_tr_b16 a[198:199], v25 offset:9216
v_mfma_f32_32x32x16_bf16 a[32:47], a[212:215], v[120:123], a[32:47]
ds_read_b64_tr_b16 a[200:201], v26 offset:8192
ds_read_b64_tr_b16 a[202:203], v26 offset:9216
v_mfma_f32_32x32x16_bf16 a[48:63], a[212:215], v[124:127], a[48:63]
ds_read_b64_tr_b16 a[204:205], v27 offset:8192
ds_read_b64_tr_b16 a[206:207], v27 offset:9216
v_mfma_f32_32x32x16_bf16 a[64:79], a[216:219], v[120:123], a[64:79]
buffer_load_dwordx4 v[168:171], v28, s[4:7], s97 offen sc1
v_mfma_f32_32x32x16_bf16 a[80:95], a[216:219], v[124:127], a[80:95]
v_mfma_f32_32x32x16_bf16 v[32:47], a[220:223], v[120:123], v[32:47]
buffer_load_dwordx4 v[172:175], v29, s[4:7], s97 offen sc1
s_add_u32 s97, s97, 1024
s_cmp_ge_u32 s97, s98
s_cselect_b32 s33, 18432, 0
s_sub_u32 s97, s97, s33
v_mfma_f32_32x32x16_bf16 v[48:63], a[220:223], v[124:127], v[48:63]
s_waitcnt vmcnt(11)
v_mfma_f32_32x32x16_bf16 a[0:15], a[224:227], v[128:131], a[0:15]
ds_read_b64_tr_b16 a[208:209], v24 offset:28672
ds_read_b64_tr_b16 a[210:211], v24 offset:29696
v_mfma_f32_32x32x16_bf16 a[16:31], a[224:227], v[132:135], a[16:31]
ds_read_b64_tr_b16 a[212:213], v25 offset:28672
ds_read_b64_tr_b16 a[214:215], v25 offset:29696
v_mfma_f32_32x32x16_bf16 a[32:47], a[228:231], v[128:131], a[32:47]
ds_read_b64_tr_b16 a[216:217], v26 offset:28672
ds_read_b64_tr_b16 a[218:219], v26 offset:29696
v_mfma_f32_32x32x16_bf16 a[48:63], a[228:231], v[132:135], a[48:63]
ds_read_b64_tr_b16 a[220:221], v27 offset:28672
ds_read_b64_tr_b16 a[222:223], v27 offset:29696
v_mfma_f32_32x32x16_bf16 a[64:79], a[232:235], v[128:131], a[64:79]
buffer_load_dwordx4 v[176:179], v28, s[4:7], s97 offen sc1
v_mfma_f32_32x32x16_bf16 a[80:95], a[232:235], v[132:135], a[80:95]
v_mfma_f32_32x32x16_bf16 v[32:47], a[236:239], v[128:131], v[32:47]
buffer_load_dwordx4 v[180:183], v29, s[4:7], s97 offen sc1
s_add_u32 s97, s97, 1024
s_cmp_ge_u32 s97, s98
s_cselect_b32 s33, 18432, 0
s_sub_u32 s97, s97, s33
v_mfma_f32_32x32x16_bf16 v[48:63], a[236:239], v[132:135], v[48:63]
s_waitcnt vmcnt(11)
s_waitcnt lgkmcnt(0)
v_mfma_f32_32x32x16_bf16 a[0:15], a[96:99], v[136:139], a[0:15]
ds_read_b64_tr_b16 a[224:225], v24 offset:32768
ds_read_b64_tr_b16 a[226:227], v24 offset:33792
v_mfma_f32_32x32x16_bf16 a[16:31], a[96:99], v[140:143], a[16:31]
ds_read_b64_tr_b16 a[228:229], v25 offset:32768
ds_read_b64_tr_b16 a[230:231], v25 offset:33792
v_mfma_f32_32x32x16_bf16 a[32:47], a[100:103], v[136:139], a[32:47]
ds_read_b64_tr_b16 a[232:233], v26 offset:32768
ds_read_b64_tr_b16 a[234:235], v26 offset:33792
v_mfma_f32_32x32x16_bf16 a[48:63], a[100:103], v[140:143], a[48:63]
ds_read_b64_tr_b16 a[236:237], v27 offset:32768
ds_read_b64_tr_b16 a[238:239], v27 offset:33792
v_mfma_f32_32x32x16_bf16 a[64:79], a[104:107], v[136:139], a[64:79]
buffer_load_dwordx4 v[184:187], v28, s[4:7], s97 offen sc1
v_mfma_f32_32x32x16_bf16 a[80:95], a[104:107], v[140:143], a[80:95]
v_mfma_f32_32x32x16_bf16 v[32:47], a[108:111], v[136:139], v[32:47]
buffer_load_dwordx4 v[188:191], v29, s[4:7], s97 offen sc1
s_add_u32 s97, s97, 1024
s_cmp_ge_u32 s97, s98
s_cselect_b32 s33, 18432, 0
s_sub_u32 s97, s97, s33
v_mfma_f32_32x32x16_bf16 v[48:63], a[108:111], v[140:143], v[48:63]
s_waitcnt vmcnt(11)
s_waitcnt lgkmcnt(0)
v_mfma_f32_32x32x16_bf16 a[0:15], a[112:115], v[144:147], a[0:15]
v_mfma_f32_32x32x16_bf16 a[16:31], a[112:115], v[148:151], a[16:31]
v_mfma_f32_32x32x16_bf16 a[32:47], a[116:119], v[144:147], a[32:47]
v_mfma_f32_32x32x16_bf16 a[48:63], a[116:119], v[148:151], a[48:63]
v_mfma_f32_32x32x16_bf16 a[64:79], a[120:123], v[144:147], a[64:79]
buffer_load_dwordx4 v[192:195], v28, s[4:7], s97 offen sc1
v_mfma_f32_32x32x16_bf16 a[80:95], a[120:123], v[148:151], a[80:95]
v_mfma_f32_32x32x16_bf16 v[32:47], a[124:127], v[144:147], v[32:47]
buffer_load_dwordx4 v[196:199], v29, s[4:7], s97 offen sc1
s_add_u32 s97, s97, 1024
s_cmp_ge_u32 s97, s98
s_cselect_b32 s33, 18432, 0
s_sub_u32 s97, s97, s33
v_mfma_f32_32x32x16_bf16 v[48:63], a[124:127], v[148:151], v[48:63]
s_waitcnt vmcnt(10)
v_mfma_f32_32x32x16_bf16 a[0:15], a[128:131], v[152:155], a[0:15]
v_mfma_f32_32x32x16_bf16 a[16:31], a[128:131], v[156:159], a[16:31]
v_mfma_f32_32x32x16_bf16 a[32:47], a[132:135], v[152:155], a[32:47]
v_mfma_f32_32x32x16_bf16 a[48:63], a[132:135], v[156:159], a[48:63]
v_mfma_f32_32x32x16_bf16 a[64:79], a[136:139], v[152:155], a[64:79]
buffer_load_dwordx4 v[200:203], v28, s[4:7], s97 offen sc1
v_mfma_f32_32x32x16_bf16 a[80:95], a[136:139], v[156:159], a[80:95]
v_mfma_f32_32x32x16_bf16 v[32:47], a[140:143], v[152:155], v[32:47]
buffer_load_dwordx4 v[204:207], v29, s[4:7], s97 offen sc1
s_add_u32 s97, s97, 1024
s_cmp_ge_u32 s97, s98
s_cselect_b32 s33, 18432, 0
s_sub_u32 s97, s97, s33
v_mfma_f32_32x32x16_bf16 v[48:63], a[140:143], v[156:159], v[48:63]
s_waitcnt vmcnt(10)
v_mfma_f32_32x32x16_bf16 a[0:15], a[144:147], v[160:163], a[0:15]
v_mfma_f32_32x32x16_bf16 a[16:31], a[144:147], v[164:167], a[16:31]
s_add_u32 s64, s63, 0
s_cmp_ge_u32 s64, 9
s_cselect_b32 s33, 9, 0
s_sub_u32 s64, s64, s33
s_mul_i32 s64, s64, 73728
s_add_u32 s64, s64, s62
s_add_u32 m0, s31, 24576
s_add_u32 s32, s64, 0
buffer_load_dwordx4 v20, s[8:11], s32 offen offset:0  lds
buffer_load_dwordx4 v21, s[8:11], s32 offen offset:1024  lds
buffer_load_dwordx4 v22, s[8:11], s32 offen offset:2048  lds
buffer_load_dwordx4 v23, s[8:11], s32 offen offset:3072  lds
v_mfma_f32_32x32x16_bf16 a[32:47], a[148:151], v[160:163], a[32:47]
v_mfma_f32_32x32x16_bf16 a[48:63], a[148:151], v[164:167], a[48:63]
v_mfma_f32_32x32x16_bf16 a[64:79], a[152:155], v[160:163], a[64:79]
v_mfma_f32_32x32x16_bf16 a[80:95], a[152:155], v[164:167], a[80:95]
v_mfma_f32_32x32x16_bf16 v[32:47], a[156:159], v[160:163], v[32:47]
v_mfma_f32_32x32x16_bf16 v[48:63], a[156:159], v[164:167], v[48:63]
s_waitcnt vmcnt(12)
v_mfma_f32_32x32x16_bf16 a[0:15], a[160:163], v[168:171], a[0:15]
v_mfma_f32_32x32x16_bf16 a[16:31], a[160:163], v[172:175], a[16:31]
s_add_u32 s64, s63, 1
s_cmp_ge_u32 s64, 9
s_cselect_b32 s33, 9, 0
s_sub_u32 s64, s64, s33
s_mul_i32 s64, s64, 73728
s_add_u32 s64, s64, s62
s_add_u32 m0, s31, 28672
s_add_u32 s32, s64, 0
buffer_load_dwordx4 v20, s[8:11], s32 offen offset:0  lds
buffer_load_dwordx4 v21, s[8:11], s32 offen offset:1024  lds
buffer_load_dwordx4 v22, s[8:11], s32 offen offset:2048  lds
buffer_load_dwordx4 v23, s[8:11], s32 offen offset:3072  lds
v_mfma_f32_32x32x16_bf16 a[32:47], a[164:167], v[168:171], a[32:47]
v_mfma_f32_32x32x16_bf16 a[48:63], a[164:167], v[172:175], a[48:63]
v_mfma_f32_32x32x16_bf16 a[64:79], a[168:171], v[168:171], a[64:79]
v_mfma_f32_32x32x16_bf16 a[80:95], a[168:171], v[172:175], a[80:95]
v_mfma_f32_32x32x16_bf16 v[32:47], a[172:175], v[168:171], v[32:47]
v_mfma_f32_32x32x16_bf16 v[48:63], a[172:175], v[172:175], v[48:63]
s_waitcnt vmcnt(14)
v_mfma_f32_32x32x16_bf16 a[0:15], a[176:179], v[176:179], a[0:15]
v_mfma_f32_32x32x16_bf16 a[16:31], a[176:179], v[180:183], a[16:31]
s_add_u32 s64, s63, 2
s_cmp_ge_u32 s64, 9
s_cselect_b32 s33, 9, 0
s_sub_u32 s64, s64, s33
s_mul_i32 s64, s64, 73728
s_add_u32 s64, s64, s62
s_add_u32 m0, s31, 32768
s_add_u32 s32, s64, 0
buffer_load_dwordx4 v20, s[8:11], s32 offen offset:0  lds
buffer_load_dwordx4 v21, s[8:11], s32 offen offset:1024  lds
buffer_load_dwordx4 v22, s[8:11], s32 offen offset:2048  lds
buffer_load_dwordx4 v23, s[8:11], s32 offen offset:3072  lds
v_mfma_f32_32x32x16_bf16 a[32:47], a[180:183], v[176:179], a[32:47]
v_mfma_f32_32x32x16_bf16 a[48:63], a[180:183], v[180:183], a[48:63]
v_mfma_f32_32x32x16_bf16 a[64:79], a[184:187], v[176:179], a[64:79]
v_mfma_f32_32x32x16_bf16 a[80:95], a[184:187], v[180:183], a[80:95]
v_mfma_f32_32x32x16_bf16 v[32:47], a[188:191], v[176:179], v[32:47]
v_mfma_f32_32x32x16_bf16 v[48:63], a[188:191], v[180:183], v[48:63]
s_waitcnt vmcnt(16)
v_mfma_f32_32x32x16_bf16 a[0:15], a[192:195], v[184:187], a[0:15]
v_mfma_f32_32x32x16_bf16 a[16:31], a[192:195], v[188:191], a[16:31]
v_mfma_f32_32x32x16_bf16 a[32:47], a[196:199], v[184:187], a[32:47]
v_mfma_f32_32x32x16_bf16 a[48:63], a[196:199], v[188:191], a[48:63]
v_mfma_f32_32x32x16_bf16 a[64:79], a[200:203], v[184:187], a[64:79]
v_mfma_f32_32x32x16_bf16 a[80:95], a[200:203], v[188:191], a[80:95]
v_mfma_f32_32x32x16_bf16 v[32:47], a[204:207], v[184:187], v[32:47]
v_mfma_f32_32x32x16_bf16 v[48:63], a[204:207], v[188:191], v[48:63]
s_waitcnt vmcnt(14)
v_mfma_f32_32x32x16_bf16 a[0:15], a[208:211], v[192:195], a[0:15]
v_mfma_f32_32x32x16_bf16 a[16:31], a[208:211], v[196:199], a[16:31]
v_mfma_f32_32x32x16_bf16 a[32:47], a[212:215], v[192:195], a[32:47]
v_mfma_f32_32x32x16_bf16 a[48:63], a[212:215], v[196:199], a[48:63]
v_mfma_f32_32x32x16_bf16 a[64:79], a[216:219], v[192:195], a[64:79]
v_mfma_f32_32x32x16_bf16 a[80:95], a[216:219], v[196:199], a[80:95]
v_mfma_f32_32x32x16_bf16 v[32:47], a[220:223], v[192:195], v[32:47]
v_mfma_f32_32x32x16_bf16 v[48:63], a[220:223], v[196:199], v[48:63]
s_waitcnt vmcnt(12)
v_mfma_f32_32x32x16_bf16 a[0:15], a[224:227], v[200:203], a[0:15]
v_mfma_f32_32x32x16_bf16 a[16:31], a[224:227], v[204:207], a[16:31]
v_mfma_f32_32x32x16_bf16 a[32:47], a[228:231], v[200:203], a[32:47]
v_mfma_f32_32x32x16_bf16 a[48:63], a[228:231], v[204:207], a[48:63]
v_mfma_f32_32x32x16_bf16 a[64:79], a[232:235], v[200:203], a[64:79]
v_mfma_f32_32x32x16_bf16 a[80:95], a[232:235], v[204:207], a[80:95]
v_mfma_f32_32x32x16_bf16 v[32:47], a[236:239], v[200:203], v[32:47]
v_mfma_f32_32x32x16_bf16 v[48:63], a[236:239], v[204:207], v[48:63]
v_lshlrev_b32 v10, 4, v1
v_add_u32 v11, s31, v10
s_nop 2
ds_write_b128 v11, a[0:3] offset:0
ds_write_b128 v11, a[4:7] offset:1024
ds_write_b128 v11, a[8:11] offset:2048
ds_write_b128 v11, a[12:15] offset:3072
ds_write_b128 v11, a[16:19] offset:4096
ds_write_b128 v11, a[20:23] offset:5120
ds_write_b128 v11, a[24:27] offset:6144
ds_write_b128 v11, a[28:31] offset:7168
ds_write_b128 v11, a[32:35] offset:8192
ds_write_b128 v11, a[36:39] offset:9216
ds_write_b128 v11, a[40:43] offset:10240
ds_write_b128 v11, a[44:47] offset:11264
ds_write_b128 v11, a[48:51] offset:12288
ds_write_b128 v11, a[52:55] offset:13312
ds_write_b128 v11, a[56:59] offset:14336
ds_write_b128 v11, a[60:63] offset:15360
ds_write_b128 v11, a[64:67] offset:16384
ds_write_b128 v11, a[68:71] offset:17408
ds_write_b128 v11, a[72:75] offset:18432
ds_write_b128 v11, a[76:79] offset:19456
ds_write_b128 v11, a[80:83] offset:20480
ds_write_b128 v11, a[84:87] offset:21504
ds_write_b128 v11, a[88:91] offset:22528
ds_write_b128 v11, a[92:95] offset:23552
s_add_u32 s33, s25, 3
s_and_b32 s33, s33, 3
s_mul_i32 s33, s33, 36864
v_add_u32 v12, s33, v10
s_add_u32 s33, s25, 2
s_and_b32 s33, s33, 3
s_mul_i32 s33, s33, 36864
v_add_u32 v13, s33, v10
s_add_u32 s33, s25, 1
s_and_b32 s33, s33, 3
s_mul_i32 s33, s33, 36864
v_add_u32 v14, s33, v10
v_bfe_u32 v16, v1, 4, 1
v_mul_u32_u24 v16, 36864, v16
v_and_b32 v17, 15, v1
v_lshl_add_u32 v16, v17, 4, v16
v_lshrrev_b32 v17, 5, v1
v_lshl_add_u32 v16, v17, 8, v16
s_mul_i32 s33, s29, 57
s_lshr_b32 s33, s33, 9
s_mul_i32 s70, s33, 9
s_sub_u32 s70, s29, s70
s_lshl_b32 s70, s70, 2
s_add_u32 s70, s70, s25
s_mul_i32 s71, s30, 144
s_add_u32 s70, s70, s71
s_lshl_b32 s70, s70, 10
s_mul_i32 s33, s33, 0x120000
s_add_u32 s70, s70, s33
s_add_u32 s70, s70, 1048576
s_add_u32 s71, s70, 73728
s_lshr_b32 s47, s26, 1
s_lshl_b32 s47, s47, 3
s_and_b32 s33, s27, 7
s_add_u32 s47, s47, s33
s_and_b32 s48, s26, 1
s_mul_i32 s48, s48, 3
s_lshr_b32 s33, s27, 3
s_add_u32 s48, s48, s33
s_lshr_b32 s49, s26, 2
s_mul_i32 s50, s48, 12
s_mul_i32 s33, s25, 3
s_add_u32 s50, s50, s33
v_and_b32 v6, 15, v1
v_mul_u32_u24 v4, 2304, v6
v_lshrrev_b32 v7, 4, v1
v_lshl_add_u32 v4, v7, 3, v4
v_lshlrev_b32 v5, 4, v7
v_min_u32 v2, 11, v6
v_and_b32 v3, 3, v2
v_mul_u32_u24 v3, 27648, v3
v_lshrrev_b32 v2, 2, v2
v_lshl_add_u32 v5, v2, 6, v5
v_add_u32 v5, v3, v5
s_mul_i32 s38, s47, 36864
s_lshl_b32 s33, s50, 5
s_add_u32 s38, s38, s33
s_mul_i32 s51, s49, 13824
s_lshl_b32 s33, s50, 6
s_add_u32 s51, s51, s33
s_add_u32 s51, s51, 9216
buffer_load_dwordx2 v[228:229], v4, s[16:19], s38 offen offset:0
buffer_load_dwordx2 v[230:231], v4, s[16:19], s38 offen offset:32
buffer_load_dwordx2 v[232:233], v4, s[16:19], s38 offen offset:64
buffer_load_dwordx4 v[208:211], v5, s[4:7], s51 offen sc1
s_waitcnt lgkmcnt(0)
s_barrier
ds_read_b128 v[64:67], v12 offset:0
ds_read_b128 v[68:71], v12 offset:1024
ds_read_b128 v[72:75], v12 offset:2048
ds_read_b128 v[76:79], v12 offset:3072
ds_read_b128 v[80:83], v13 offset:8192
ds_read_b128 v[84:87], v13 offset:9216
ds_read_b128 v[88:91], v13 offset:10240
ds_read_b128 v[92:95], v13 offset:11264
ds_read_b128 v[96:99], v14 offset:16384
ds_read_b128 v[100:103], v14 offset:17408
ds_read_b128 v[104:107], v14 offset:18432
ds_read_b128 v[108:111], v14 offset:19456
s_waitcnt lgkmcnt(8)
v_pk_add_f32 v[32:33], v[32:33], v[64:65]
v_pk_add_f32 v[34:35], v[34:35], v[66:67]
v_pk_add_f32 v[36:37], v[36:37], v[68:69]
v_pk_add_f32 v[38:39], v[38:39], v[70:71]
v_pk_add_f32 v[40:41], v[40:41], v[72:73]
v_pk_add_f32 v[42:43], v[42:43], v[74:75]
v_pk_add_f32 v[44:45], v[44:45], v[76:77]
v_pk_add_f32 v[46:47], v[46:47], v[78:79]
s_waitcnt lgkmcnt(4)
v_pk_add_f32 v[32:33], v[32:33], v[80:81]
v_pk_add_f32 v[34:35], v[34:35], v[82:83]
v_pk_add_f32 v[36:37], v[36:37], v[84:85]
v_pk_add_f32 v[38:39], v[38:39], v[86:87]
v_pk_add_f32 v[40:41], v[40:41], v[88:89]
v_pk_add_f32 v[42:43], v[42:43], v[90:91]
v_pk_add_f32 v[44:45], v[44:45], v[92:93]
v_pk_add_f32 v[46:47], v[46:47], v[94:95]
s_waitcnt lgkmcnt(0)
v_pk_add_f32 v[32:33], v[32:33], v[96:97]
v_pk_add_f32 v[34:35], v[34:35], v[98:99]
v_pk_add_f32 v[36:37], v[36:37], v[100:101]
v_pk_add_f32 v[38:39], v[38:39], v[102:103]
v_pk_add_f32 v[40:41], v[40:41], v[104:105]
v_pk_add_f32 v[42:43], v[42:43], v[106:107]
v_pk_add_f32 v[44:45], v[44:45], v[108:109]
v_pk_add_f32 v[46:47], v[46:47], v[110:111]
ds_read_b128 v[112:115], v12 offset:4096
ds_read_b128 v[116:119], v12 offset:5120
ds_read_b128 v[120:123], v12 offset:6144
ds_read_b128 v[124:127], v12 offset:7168
ds_read_b128 v[128:131], v13 offset:12288
ds_read_b128 v[132:135], v13 offset:13312
ds_read_b128 v[136:139], v13 offset:14336
ds_read_b128 v[140:143], v13 offset:15360
ds_read_b128 v[144:147], v14 offset:20480
ds_read_b128 v[148:151], v14 offset:21504
ds_read_b128 v[152:155], v14 offset:22528
ds_read_b128 v[156:159], v14 offset:23552
v_cvt_pk_bf16_f32 v160, v32, v33
v_cvt_pk_bf16_f32 v161, v34, v35
v_cvt_pk_bf16_f32 v162, v40, v41
v_cvt_pk_bf16_f32 v163, v42, v43
buffer_store_dwordx4 v[160:163], v16, s[4:7], s70 offen offset:0 sc1
v_cvt_pk_bf16_f32 v164, v36, v37
v_cvt_pk_bf16_f32 v165, v38, v39
v_cvt_pk_bf16_f32 v166, v44, v45
v_cvt_pk_bf16_f32 v167, v46, v47
buffer_store_dwordx4 v[164:167], v16, s[4:7], s70 offen offset:512 sc1
s_waitcnt lgkmcnt(8)
v_pk_add_f32 v[48:49], v[48:49], v[112:113]
v_pk_add_f32 v[50:51], v[50:51], v[114:115]
v_pk_add_f32 v[52:53], v[52:53], v[116:117]
v_pk_add_f32 v[54:55], v[54:55], v[118:119]
v_pk_add_f32 v[56:57], v[56:57], v[120:121]
v_pk_add_f32 v[58:59], v[58:59], v[122:123]
v_pk_add_f32 v[60:61], v[60:61], v[124:125]
v_pk_add_f32 v[62:63], v[62:63], v[126:127]
s_waitcnt lgkmcnt(4)
v_pk_add_f32 v[48:49], v[48:49], v[128:129]
v_pk_add_f32 v[50:51], v[50:51], v[130:131]
v_pk_add_f32 v[52:53], v[52:53], v[132:133]
v_pk_add_f32 v[54:55], v[54:55], v[134:135]
v_pk_add_f32 v[56:57], v[56:57], v[136:137]
v_pk_add_f32 v[58:59], v[58:59], v[138:139]
v_pk_add_f32 v[60:61], v[60:61], v[140:141]
v_pk_add_f32 v[62:63], v[62:63], v[142:143]
s_waitcnt lgkmcnt(0)
v_pk_add_f32 v[48:49], v[48:49], v[144:145]
v_pk_add_f32 v[50:51], v[50:51], v[146:147]
v_pk_add_f32 v[52:53], v[52:53], v[148:149]
v_pk_add_f32 v[54:55], v[54:55], v[150:151]
v_pk_add_f32 v[56:57], v[56:57], v[152:153]
v_pk_add_f32 v[58:59], v[58:59], v[154:155]
v_pk_add_f32 v[60:61], v[60:61], v[156:157]
v_pk_add_f32 v[62:63], v[62:63], v[158:159]
v_cvt_pk_bf16_f32 v168, v48, v49
v_cvt_pk_bf16_f32 v169, v50, v51
v_cvt_pk_bf16_f32 v170, v56, v57
v_cvt_pk_bf16_f32 v171, v58, v59
buffer_store_dwordx4 v[168:171], v16, s[4:7], s71 offen offset:0 sc1
v_cvt_pk_bf16_f32 v172, v52, v53
v_cvt_pk_bf16_f32 v173, v54, v55
v_cvt_pk_bf16_f32 v174, v60, v61
v_cvt_pk_bf16_f32 v175, v62, v63
buffer_store_dwordx4 v[172:175], v16, s[4:7], s71 offen offset:512 sc1
s_barrier
s_cmp_ge_u32 s27, 18
s_cbranch_scc1 L_nw
s_add_u32 s64, s63, 3
s_cmp_ge_u32 s64, 9
s_cselect_b32 s33, 9, 0
s_sub_u32 s64, s64, s33
s_mul_i32 s64, s64, 73728
s_add_u32 s64, s64, s62
s_add_u32 m0, s31, 0
s_add_u32 s32, s64, 0
buffer_load_dwordx4 v20, s[8:11], s32 offen offset:0  lds
buffer_load_dwordx4 v21, s[8:11], s32 offen offset:1024  lds
buffer_load_dwordx4 v22, s[8:11], s32 offen offset:2048  lds
buffer_load_dwordx4 v23, s[8:11], s32 offen offset:3072  lds
s_add_u32 s64, s63, 4
s_cmp_ge_u32 s64, 9
s_cselect_b32 s33, 9, 0
s_sub_u32 s64, s64, s33
s_mul_i32 s64, s64, 73728
s_add_u32 s64, s64, s62
s_add_u32 m0, s31, 4096
s_add_u32 s32, s64, 0
buffer_load_dwordx4 v20, s[8:11], s32 offen offset:0  lds
buffer_load_dwordx4 v21, s[8:11], s32 offen offset:1024  lds
buffer_load_dwordx4 v22, s[8:11], s32 offen offset:2048  lds
buffer_load_dwordx4 v23, s[8:11], s32 offen offset:3072  lds
s_waitcnt vmcnt(8)
s_branch L_nw2
L_nw:
s_waitcnt vmcnt(0)
L_nw2:
s_barrier
s_lshl_b32 s32, s28, 7
s_add_u32 s32, s32, 131072
v_cmp_eq_u32 vcc, 0, v0
v_mov_b32 v10, 0x7fffffff
s_nop 0
v_cndmask_b32 v10, v10, 0, vcc
v_mov_b32 v11, s24
buffer_store_dword v11, v10, s[4:7], s32 offen sc1
s_cmp_ge_u32 s27, 26
s_cbranch_scc1 L_idle
s_cmp_ge_u32 s27, 18
s_cbranch_scc1 L_s3s
s_add_u32 s64, s63, 5
s_cmp_ge_u32 s64, 9
s_cselect_b32 s33, 9, 0
s_sub_u32 s64, s64, s33
s_mul_i32 s64, s64, 73728
s_add_u32 s64, s64, s62
s_add_u32 m0, s31, 8192
s_add_u32 s32, s64, 0
buffer_load_dwordx4 v20, s[8:11], s32 offen offset:0  lds
buffer_load_dwordx4 v21, s[8:11], s32 offen offset:1024  lds
buffer_load_dwordx4 v22, s[8:11], s32 offen offset:2048  lds
buffer_load_dwordx4 v23, s[8:11], s32 offen offset:3072  lds
s_add_u32 s64, s63, 6
s_cmp_ge_u32 s64, 9
s_cselect_b32 s33, 9, 0
s_sub_u32 s64, s64, s33
s_mul_i32 s64, s64, 73728
s_add_u32 s64, s64, s62
s_add_u32 m0, s31, 12288
s_add_u32 s32, s64, 0
buffer_load_dwordx4 v20, s[8:11], s32 offen offset:0  lds
buffer_load_dwordx4 v21, s[8:11], s32 offen offset:1024  lds
buffer_load_dwordx4 v22, s[8:11], s32 offen offset:2048  lds
buffer_load_dwordx4 v23, s[8:11], s32 offen offset:3072  lds
s_add_u32 s64, s63, 7
s_cmp_ge_u32 s64, 9
s_cselect_b32 s33, 9, 0
s_sub_u32 s64, s64, s33
s_mul_i32 s64, s64, 73728
s_add_u32 s64, s64, s62
s_add_u32 m0, s31, 16384
s_add_u32 s32, s64, 0
buffer_load_dwordx4 v20, s[8:11], s32 offen offset:0  lds
buffer_load_dwordx4 v21, s[8:11], s32 offen offset:1024  lds
buffer_load_dwordx4 v22, s[8:11], s32 offen offset:2048  lds
buffer_load_dwordx4 v23, s[8:11], s32 offen offset:3072  lds
s_add_u32 s64, s63, 8
s_cmp_ge_u32 s64, 9
s_cselect_b32 s33, 9, 0
s_sub_u32 s64, s64, s33
s_mul_i32 s64, s64, 73728
s_add_u32 s64, s64, s62
s_add_u32 m0, s31, 20480
s_add_u32 s32, s64, 0
buffer_load_dwordx4 v20, s[8:11], s32 offen offset:0  lds
buffer_load_dwordx4 v21, s[8:11], s32 offen offset:1024  lds
buffer_load_dwordx4 v22, s[8:11], s32 offen offset:2048  lds
buffer_load_dwordx4 v23, s[8:11], s32 offen offset:3072  lds
v_lshrrev_b32 v17, 5, v1
v_mul_u32_u24 v31, 1024, v17
v_bfe_u32 v17, v1, 2, 3
v_lshl_add_u32 v31, v17, 7, v31
v_lshrrev_b32 v16, 1, v17
v_and_b32 v17, 3, v1
v_lshl_add_u32 v31, v17, 3, v31
v_add_u32 v31, s31, v31
v_xor_b32 v16, s25, v16
v_xor_b32 v17, 0, v16
v_lshl_add_u32 v249, v17, 5, v31
v_xor_b32 v17, 1, v16
v_lshl_add_u32 v250, v17, 5, v31
v_xor_b32 v17, 2, v16
v_lshl_add_u32 v251, v17, 5, v31
v_xor_b32 v17, 3, v16
v_lshl_add_u32 v252, v17, 5, v31
ds_read_b64_tr_b16 a[96:97], v249 offset:24576
ds_read_b64_tr_b16 a[98:99], v249 offset:26624
ds_read_b64_tr_b16 a[100:101], v250 offset:24576
ds_read_b64_tr_b16 a[102:103], v250 offset:26624
ds_read_b64_tr_b16 a[104:105], v251 offset:24576
ds_read_b64_tr_b16 a[106:107], v251 offset:26624
ds_read_b64_tr_b16 a[108:109], v252 offset:24576
ds_read_b64_tr_b16 a[110:111], v252 offset:26624
ds_read_b64_tr_b16 a[112:113], v249 offset:28672
ds_read_b64_tr_b16 a[114:115], v249 offset:30720
ds_read_b64_tr_b16 a[116:117], v250 offset:28672
ds_read_b64_tr_b16 a[118:119], v250 offset:30720
ds_read_b64_tr_b16 a[120:121], v251 offset:28672
ds_read_b64_tr_b16 a[122:123], v251 offset:30720
ds_read_b64_tr_b16 a[124:125], v252 offset:28672
ds_read_b64_tr_b16 a[126:127], v252 offset:30720
ds_read_b64_tr_b16 a[128:129], v249 offset:32768
ds_read_b64_tr_b16 a[130:131], v249 offset:34816
ds_read_b64_tr_b16 a[132:133], v250 offset:32768
ds_read_b64_tr_b16 a[134:135], v250 offset:34816
ds_read_b64_tr_b16 a[136:137], v251 offset:32768
ds_read_b64_tr_b16 a[138:139], v251 offset:34816
ds_read_b64_tr_b16 a[140:141], v252 offset:32768
ds_read_b64_tr_b16 a[142:143], v252 offset:34816
v_lshlrev_b32 v11, 3, v1
s_mov_b32 s12, s54
s_mov_b32 s13, s55
s_mov_b32 s14, 1179648
s_mov_b32 s15, 0x20000
v_lshlrev_b32 v28, 4, v1
v_add_u32 v29, 4096, v28
v_add_u32 v30, 8192, v28
s_lshr_b32 s33, s47, 2
s_lshl_b32 s33, s33, 3
s_add_u32 s33, s33, 1420
v_add_u32 v16, s33, v1
s_mul_i32 s52, s48, 3
s_mul_i32 s33, s49, 72
s_add_u32 s33, s33, s52
s_add_u32 s33, s33, 1276
v_min_u32 v17, 19, v1
v_subrev_u32 v17, 8, v17
v_and_b32 v18, 3, v17
v_mul_u32_u24 v18, 18, v18
v_lshrrev_b32 v17, 2, v17
v_add3_u32 v17, v17, v18, s33
v_cmp_gt_u32 vcc, 8, v1
s_nop 1
v_cndmask_b32 v16, v17, v16, vcc
v_lshlrev_b32 v23, 7, v16
s_lshl_b32 s33, s52, 1
s_add_u32 s33, s33, s49
s_add_u32 s33, s33, 1484
v_min_u32 v17, 2, v1
v_lshl_add_u32 v17, v17, 1, s33
v_lshlrev_b32 v62, 7, v17
v_add_u32 v63, 4608, v62
v_cmp_eq_u32 vcc, 0, v6
v_mov_b32 v53, 0x3f803f80
s_nop 0
v_cndmask_b32 v52, 0, v53, vcc
v_mov_b32 v53, v52
v_cmp_eq_u32 vcc, 1, v6
v_mov_b32 v55, 0x3f803f80
s_nop 0
v_cndmask_b32 v54, 0, v55, vcc
v_mov_b32 v55, v54
v_cmp_eq_u32 vcc, 2, v6
v_mov_b32 v57, 0x3f803f80
s_nop 0
v_cndmask_b32 v56, 0, v57, vcc
v_mov_b32 v57, v56
v_cmp_eq_u32 vcc, 3, v6
v_mov_b32 v59, 0x3f803f80
s_nop 0
v_cndmask_b32 v58, 0, v59, vcc
v_mov_b32 v59, v58
v_cmp_eq_u32 vcc, 4, v6
v_mov_b32 v61, 0x3f803f80
s_nop 0
v_cndmask_b32 v60, 0, v61, vcc
v_mov_b32 v61, v60
s_lshl_b32 s39, s47, 13
s_lshl_b32 s33, s25, 11
s_add_u32 s39, s39, s33
s_add_u32 s39, s39, 7602176
s_mul_i32 s33, s49, 72
s_add_u32 s33, s33, s50
s_lshl_b32 s40, s33, 13
s_add_u32 s40, s40, 6291456
s_mul_i32 s41, s33, 2560
s_add_u32 s41, s41, 7864320
s_add_u32 s42, s41, 0x5A000
s_mul_i32 s46, s47, 36864
s_add_u32 s46, s46, 8650752
s_mul_i32 s43, s48, 6144
s_add_u32 s43, s43, s46
s_lshl_b32 s33, s25, 11
v_add_u32 v8, s33, v28
s_lshl_b32 s33, s25, 9
v_add_u32 v9, s33, v11
s_mul_i32 s33, s25, 6144
v_add_u32 v12, s33, v28
v_lshrrev_b32 v13, 2, v6
v_lshlrev_b32 v13, 8, v13
v_and_b32 v14, 3, v1
v_lshl_add_u32 v13, v14, 2, v13
v_add_u32 v13, 5248, v13
v_lshrrev_b32 v14, 5, v1
v_lshl_add_u32 v14, v14, 4, v13
v_add_u32 v14, s33, v14
s_lshl_b32 s52, s25, 10
s_add_u32 s33, s25, 4
s_min_u32 s53, s33, 5
s_lshl_b32 s53, s53, 10
v_add_u32 v18, s52, v28
v_add_u32 v19, s53, v28
v_add_u32 v15, 4096, v18
s_cmp_lt_u32 s25, 2
s_cselect_b32 s33, 0, 0x7f000000
v_add_u32 v10, s33, v19
v_lshlrev_b32 v26, 8, v7
v_cmp_eq_u32 vcc, 3, v7
v_mov_b32 v27, 0xff800000
s_nop 0
v_cndmask_b32 v27, 0, v27, vcc
s_mov_b32 s33, 20000
s_waitcnt vmcnt(16)
s_branch gc_17
gp_15:
buffer_load_dwordx4 v[208:211], v5, s[4:7], s51 offen sc1
s_waitcnt vmcnt(0)
gc_17:
v_xor_b32 v240, s24, v211
v_xor_b32 v241, s24, v211
v_or_b32 v240, v240, v241
v_cmp_ne_u32 vcc, 0, v240
s_sub_u32 s33, s33, 1
s_cmp_eq_u32 s33, 0
s_cbranch_scc1 ge_16
s_nop 1
s_cbranch_vccnz gp_15
ge_16:
v_perm_b32 v240, v209, v208, s72
v_perm_b32 v211, v210, v240, s73
v_lshlrev_b32 v216, 16, v228
v_and_b32 v217, s100, v228
v_lshlrev_b32 v218, 16, v229
v_and_b32 v219, s100, v229
v_lshlrev_b32 v220, 16, v230
v_and_b32 v221, s100, v230
v_lshlrev_b32 v222, 16, v231
v_and_b32 v223, s100, v231
v_lshlrev_b32 v224, 16, v232
v_and_b32 v225, s100, v232
v_lshlrev_b32 v226, 16, v233
v_and_b32 v227, s100, v233
v_add_f32_dpp v208, v208, v208 quad_perm:[1,0,3,2] row_mask:0xf bank_mask:0xf
v_add_f32_dpp v209, v209, v209 quad_perm:[1,0,3,2] row_mask:0xf bank_mask:0xf
v_add_f32_dpp v210, v210, v210 quad_perm:[1,0,3,2] row_mask:0xf bank_mask:0xf
v_add_f32_dpp v211, v211, v211 quad_perm:[1,0,3,2] row_mask:0xf bank_mask:0xf
v_add_f32_dpp v208, v208, v208 quad_perm:[2,3,0,1] row_mask:0xf bank_mask:0xf
v_add_f32_dpp v209, v209, v209 quad_perm:[2,3,0,1] row_mask:0xf bank_mask:0xf
v_add_f32_dpp v210, v210, v210 quad_perm:[2,3,0,1] row_mask:0xf bank_mask:0xf
v_add_f32_dpp v211, v211, v211 quad_perm:[2,3,0,1] row_mask:0xf bank_mask:0xf
v_cvt_pk_bf16_f32 v208, v208, v209
v_cvt_pk_bf16_f32 v210, v210, v211
v_and_b32 v209, s100, v208
v_lshlrev_b32 v208, 16, v208
v_and_b32 v211, s100, v210
v_lshlrev_b32 v210, 16, v210
v_mov_b32_dpp v228, v208 row_newbcast:0 row_mask:0xf bank_mask:0xf
v_mov_b32_dpp v229, v209 row_newbcast:0 row_mask:0xf bank_mask:0xf
v_mov_b32_dpp v230, v210 row_newbcast:0 row_mask:0xf bank_mask:0xf
v_mov_b32_dpp v231, v211 row_newbcast:0 row_mask:0xf bank_mask:0xf
v_mov_b32_dpp v48, v208 row_newbcast:4 row_mask:0xf bank_mask:0xf
v_mov_b32_dpp v49, v209 row_newbcast:4 row_mask:0xf bank_mask:0xf
v_mov_b32_dpp v50, v210 row_newbcast:4 row_mask:0xf bank_mask:0xf
v_mov_b32_dpp v51, v211 row_newbcast:4 row_mask:0xf bank_mask:0xf
v_mov_b32_dpp v232, v208 row_newbcast:8 row_mask:0xf bank_mask:0xf
v_mov_b32_dpp v233, v209 row_newbcast:8 row_mask:0xf bank_mask:0xf
v_mov_b32_dpp v254, v210 row_newbcast:8 row_mask:0xf bank_mask:0xf
v_mov_b32_dpp v255, v211 row_newbcast:8 row_mask:0xf bank_mask:0xf
s_add_u32 s64, s63, 0
s_cmp_ge_u32 s64, 9
s_cselect_b32 s33, 9, 0
s_sub_u32 s64, s64, s33
s_lshl_b32 s64, s64, 10
v_add_u32 v240, s64, v28
s_add_u32 s64, s63, 1
s_cmp_ge_u32 s64, 9
s_cselect_b32 s33, 9, 0
s_sub_u32 s64, s64, s33
s_lshl_b32 s64, s64, 10
v_add_u32 v241, s64, v28
s_add_u32 s64, s63, 2
s_cmp_ge_u32 s64, 9
s_cselect_b32 s33, 9, 0
s_sub_u32 s64, s64, s33
s_lshl_b32 s64, s64, 10
v_add_u32 v242, s64, v28
s_add_u32 s64, s63, 3
s_cmp_ge_u32 s64, 9
s_cselect_b32 s33, 9, 0
s_sub_u32 s64, s64, s33
s_lshl_b32 s64, s64, 10
v_add_u32 v243, s64, v28
s_add_u32 s64, s63, 4
s_cmp_ge_u32 s64, 9
s_cselect_b32 s33, 9, 0
s_sub_u32 s64, s64, s33
s_lshl_b32 s64, s64, 10
v_add_u32 v244, s64, v28
s_add_u32 s64, s63, 5
s_cmp_ge_u32 s64, 9
s_cselect_b32 s33, 9, 0
s_sub_u32 s64, s64, s33
s_lshl_b32 s64, s64, 10
v_add_u32 v245, s64, v28
s_add_u32 s64, s63, 6
s_cmp_ge_u32 s64, 9
s_cselect_b32 s33, 9, 0
s_sub_u32 s64, s64, s33
s_lshl_b32 s64, s64, 10
v_add_u32 v246, s64, v28
s_add_u32 s64, s63, 7
s_cmp_ge_u32 s64, 9
s_cselect_b32 s33, 9, 0
s_sub_u32 s64, s64, s33
s_lshl_b32 s64, s64, 10
v_add_u32 v247, s64, v28
s_add_u32 s64, s63, 8
s_cmp_ge_u32 s64, 9
s_cselect_b32 s33, 9, 0
s_sub_u32 s64, s64, s33
s_lshl_b32 s64, s64, 10
v_add_u32 v248, s64, v28
s_mul_i32 s64, s60, 147456
s_mul_i32 s33, s25, 9216
s_add_u32 s64, s64, s33
s_add_u32 s64, s64, 3407872
s_add_u32 s65, s64, 36864
s_add_u32 s66, s64, 73728
s_add_u32 s67, s64, 110592
v_min_u32 v16, 8, v1
v_lshlrev_b32 v16, 3, v16
v_add_u32 v16, s60, v16
v_lshlrev_b32 v16, 7, v16
v_add_u32 v16, 149504, v16
s_lshr_b32 s33, s60, 2
s_mul_i32 s70, s33, 72
s_lshl_b32 s33, s61, 2
s_add_u32 s70, s70, s33
s_add_u32 s70, s70, s25
s_lshl_b32 s70, s70, 3
s_and_b32 s33, s60, 3
s_lshl_b32 s33, s33, 1
s_add_u32 s70, s70, s33
s_lshl_b32 s70, s70, 10
s_add_u32 s70, s70, 6291456
s_mul_i32 s71, s60, 18
s_add_u32 s71, s71, s61
s_add_u32 s71, s71, 252
s_waitcnt vmcnt(16)
ds_read_b64_tr_b16 a[144:145], v249 offset:0
ds_read_b64_tr_b16 a[146:147], v249 offset:2048
ds_read_b64_tr_b16 a[148:149], v250 offset:0
ds_read_b64_tr_b16 a[150:151], v250 offset:2048
ds_read_b64_tr_b16 a[152:153], v251 offset:0
ds_read_b64_tr_b16 a[154:155], v251 offset:2048
ds_read_b64_tr_b16 a[156:157], v252 offset:0
ds_read_b64_tr_b16 a[158:159], v252 offset:2048
s_waitcnt vmcnt(16)
ds_read_b64_tr_b16 a[160:161], v249 offset:4096
ds_read_b64_tr_b16 a[162:163], v249 offset:6144
ds_read_b64_tr_b16 a[164:165], v250 offset:4096
ds_read_b64_tr_b16 a[166:167], v250 offset:6144
ds_read_b64_tr_b16 a[168:169], v251 offset:4096
ds_read_b64_tr_b16 a[170:171], v251 offset:6144
ds_read_b64_tr_b16 a[172:173], v252 offset:4096
ds_read_b64_tr_b16 a[174:175], v252 offset:6144
s_waitcnt vmcnt(12)
ds_read_b64_tr_b16 a[176:177], v249 offset:8192
ds_read_b64_tr_b16 a[178:179], v249 offset:10240
ds_read_b64_tr_b16 a[180:181], v250 offset:8192
ds_read_b64_tr_b16 a[182:183], v250 offset:10240
ds_read_b64_tr_b16 a[184:185], v251 offset:8192
ds_read_b64_tr_b16 a[186:187], v251 offset:10240
ds_read_b64_tr_b16 a[188:189], v252 offset:8192
ds_read_b64_tr_b16 a[190:191], v252 offset:10240
s_waitcnt vmcnt(8)
ds_read_b64_tr_b16 a[192:193], v249 offset:12288
ds_read_b64_tr_b16 a[194:195], v249 offset:14336
ds_read_b64_tr_b16 a[196:197], v250 offset:12288
ds_read_b64_tr_b16 a[198:199], v250 offset:14336
ds_read_b64_tr_b16 a[200:201], v251 offset:12288
ds_read_b64_tr_b16 a[202:203], v251 offset:14336
ds_read_b64_tr_b16 a[204:205], v252 offset:12288
ds_read_b64_tr_b16 a[206:207], v252 offset:14336
s_waitcnt vmcnt(4)
ds_read_b64_tr_b16 a[208:209], v249 offset:16384
ds_read_b64_tr_b16 a[210:211], v249 offset:18432
ds_read_b64_tr_b16 a[212:213], v250 offset:16384
ds_read_b64_tr_b16 a[214:215], v250 offset:18432
ds_read_b64_tr_b16 a[216:217], v251 offset:16384
ds_read_b64_tr_b16 a[218:219], v251 offset:18432
ds_read_b64_tr_b16 a[220:221], v252 offset:16384
ds_read_b64_tr_b16 a[222:223], v252 offset:18432
s_waitcnt vmcnt(0)
ds_read_b64_tr_b16 a[224:225], v249 offset:20480
ds_read_b64_tr_b16 a[226:227], v249 offset:22528
ds_read_b64_tr_b16 a[228:229], v250 offset:20480
ds_read_b64_tr_b16 a[230:231], v250 offset:22528
ds_read_b64_tr_b16 a[232:233], v251 offset:20480
ds_read_b64_tr_b16 a[234:235], v251 offset:22528
ds_read_b64_tr_b16 a[236:237], v252 offset:20480
ds_read_b64_tr_b16 a[238:239], v252 offset:22528
s_waitcnt vmcnt(0)
s_cmp_lg_u32 s25, 0
s_cbranch_scc1 pe_19
s_mov_b32 s33, 20000
poll_18:
buffer_load_dword v17, v16, s[4:7], 0 offen sc1
s_waitcnt vmcnt(0)
v_cmp_ne_u32 vcc, s24, v17
s_sub_u32 s33, s33, 1
s_cmp_eq_u32 s33, 0
s_cbranch_scc1 pe_19
s_nop 1
s_cbranch_vccnz poll_18
pe_19:
s_barrier
buffer_load_dwordx4 v[64:67], v240, s[4:7], s64 offen offset:0 sc1
buffer_load_dwordx4 v[68:71], v240, s[4:7], s65 offen offset:0 sc1
buffer_load_dwordx4 v[72:75], v240, s[4:7], s66 offen offset:0 sc1
buffer_load_dwordx4 v[76:79], v240, s[4:7], s67 offen offset:0 sc1
buffer_load_dwordx4 v[80:83], v241, s[4:7], s64 offen offset:0 sc1
buffer_load_dwordx4 v[84:87], v241, s[4:7], s65 offen offset:0 sc1
buffer_load_dwordx4 v[88:91], v241, s[4:7], s66 offen offset:0 sc1
buffer_load_dwordx4 v[92:95], v241, s[4:7], s67 offen offset:0 sc1
buffer_load_dwordx4 v[96:99], v242, s[4:7], s64 offen offset:0 sc1
buffer_load_dwordx4 v[100:103], v242, s[4:7], s65 offen offset:0 sc1
buffer_load_dwordx4 v[104:107], v242, s[4:7], s66 offen offset:0 sc1
buffer_load_dwordx4 v[108:111], v242, s[4:7], s67 offen offset:0 sc1
buffer_load_dwordx4 v[112:115], v243, s[4:7], s64 offen offset:0 sc1
buffer_load_dwordx4 v[116:119], v243, s[4:7], s65 offen offset:0 sc1
buffer_load_dwordx4 v[120:123], v243, s[4:7], s66 offen offset:0 sc1
buffer_load_dwordx4 v[124:127], v243, s[4:7], s67 offen offset:0 sc1
s_waitcnt lgkmcnt(0)
s_waitcnt vmcnt(12)
v_mfma_f32_16x16x32_bf16 v[32:35], v[64:67], a[96:99], 0
buffer_load_dwordx4 v[128:131], v244, s[4:7], s64 offen offset:0 sc1
v_mfma_f32_16x16x32_bf16 a[0:3], v[64:67], a[100:103], 0
v_mfma_f32_16x16x32_bf16 a[16:19], v[64:67], a[104:107], 0
v_mfma_f32_16x16x32_bf16 a[32:35], v[64:67], a[108:111], 0
buffer_load_dwordx4 v[132:135], v244, s[4:7], s65 offen offset:0 sc1
v_mfma_f32_16x16x32_bf16 v[36:39], v[68:71], a[96:99], 0
v_mfma_f32_16x16x32_bf16 a[4:7], v[68:71], a[100:103], 0
v_mfma_f32_16x16x32_bf16 a[20:23], v[68:71], a[104:107], 0
buffer_load_dwordx4 v[136:139], v244, s[4:7], s66 offen offset:0 sc1
v_mfma_f32_16x16x32_bf16 a[36:39], v[68:71], a[108:111], 0
v_mfma_f32_16x16x32_bf16 v[40:43], v[72:75], a[96:99], 0
v_mfma_f32_16x16x32_bf16 a[8:11], v[72:75], a[100:103], 0
buffer_load_dwordx4 v[140:143], v244, s[4:7], s67 offen offset:0 sc1
v_mfma_f32_16x16x32_bf16 a[24:27], v[72:75], a[104:107], 0
v_mfma_f32_16x16x32_bf16 a[40:43], v[72:75], a[108:111], 0
v_mfma_f32_16x16x32_bf16 v[44:47], v[76:79], a[96:99], 0
v_mfma_f32_16x16x32_bf16 a[12:15], v[76:79], a[100:103], 0
v_mfma_f32_16x16x32_bf16 a[28:31], v[76:79], a[104:107], 0
v_mfma_f32_16x16x32_bf16 a[44:47], v[76:79], a[108:111], 0
s_waitcnt vmcnt(12)
v_mfma_f32_16x16x32_bf16 v[32:35], v[80:83], a[112:115], v[32:35]
buffer_load_dwordx4 v[144:147], v245, s[4:7], s64 offen offset:0 sc1
v_mfma_f32_16x16x32_bf16 a[0:3], v[80:83], a[116:119], a[0:3]
v_mfma_f32_16x16x32_bf16 a[16:19], v[80:83], a[120:123], a[16:19]
v_mfma_f32_16x16x32_bf16 a[32:35], v[80:83], a[124:127], a[32:35]
buffer_load_dwordx4 v[148:151], v245, s[4:7], s65 offen offset:0 sc1
v_mfma_f32_16x16x32_bf16 v[36:39], v[84:87], a[112:115], v[36:39]
v_mfma_f32_16x16x32_bf16 a[4:7], v[84:87], a[116:119], a[4:7]
v_mfma_f32_16x16x32_bf16 a[20:23], v[84:87], a[120:123], a[20:23]
buffer_load_dwordx4 v[152:155], v245, s[4:7], s66 offen offset:0 sc1
v_mfma_f32_16x16x32_bf16 a[36:39], v[84:87], a[124:127], a[36:39]
v_mfma_f32_16x16x32_bf16 v[40:43], v[88:91], a[112:115], v[40:43]
v_mfma_f32_16x16x32_bf16 a[8:11], v[88:91], a[116:119], a[8:11]
buffer_load_dwordx4 v[156:159], v245, s[4:7], s67 offen offset:0 sc1
v_mfma_f32_16x16x32_bf16 a[24:27], v[88:91], a[120:123], a[24:27]
v_mfma_f32_16x16x32_bf16 a[40:43], v[88:91], a[124:127], a[40:43]
v_mfma_f32_16x16x32_bf16 v[44:47], v[92:95], a[112:115], v[44:47]
v_mfma_f32_16x16x32_bf16 a[12:15], v[92:95], a[116:119], a[12:15]
v_mfma_f32_16x16x32_bf16 a[28:31], v[92:95], a[120:123], a[28:31]
v_mfma_f32_16x16x32_bf16 a[44:47], v[92:95], a[124:127], a[44:47]
s_waitcnt vmcnt(12)
v_mfma_f32_16x16x32_bf16 v[32:35], v[96:99], a[128:131], v[32:35]
buffer_load_dwordx4 v[160:163], v246, s[4:7], s64 offen offset:0 sc1
v_mfma_f32_16x16x32_bf16 a[0:3], v[96:99], a[132:135], a[0:3]
v_mfma_f32_16x16x32_bf16 a[16:19], v[96:99], a[136:139], a[16:19]
v_mfma_f32_16x16x32_bf16 a[32:35], v[96:99], a[140:143], a[32:35]
buffer_load_dwordx4 v[164:167], v246, s[4:7], s65 offen offset:0 sc1
v_mfma_f32_16x16x32_bf16 v[36:39], v[100:103], a[128:131], v[36:39]
v_mfma_f32_16x16x32_bf16 a[4:7], v[100:103], a[132:135], a[4:7]
v_mfma_f32_16x16x32_bf16 a[20:23], v[100:103], a[136:139], a[20:23]
buffer_load_dwordx4 v[168:171], v246, s[4:7], s66 offen offset:0 sc1
v_mfma_f32_16x16x32_bf16 a[36:39], v[100:103], a[140:143], a[36:39]
v_mfma_f32_16x16x32_bf16 v[40:43], v[104:107], a[128:131], v[40:43]
v_mfma_f32_16x16x32_bf16 a[8:11], v[104:107], a[132:135], a[8:11]
buffer_load_dwordx4 v[172:175], v246, s[4:7], s67 offen offset:0 sc1
v_mfma_f32_16x16x32_bf16 a[24:27], v[104:107], a[136:139], a[24:27]
v_mfma_f32_16x16x32_bf16 a[40:43], v[104:107], a[140:143], a[40:43]
v_mfma_f32_16x16x32_bf16 v[44:47], v[108:111], a[128:131], v[44:47]
v_mfma_f32_16x16x32_bf16 a[12:15], v[108:111], a[132:135], a[12:15]
v_mfma_f32_16x16x32_bf16 a[28:31], v[108:111], a[136:139], a[28:31]
v_mfma_f32_16x16x32_bf16 a[44:47], v[108:111], a[140:143], a[44:47]
s_waitcnt vmcnt(12)
v_mfma_f32_16x16x32_bf16 v[32:35], v[112:115], a[144:147], v[32:35]
buffer_load_dwordx4 v[176:179], v247, s[4:7], s64 offen offset:0 sc1
v_mfma_f32_16x16x32_bf16 a[0:3], v[112:115], a[148:151], a[0:3]
v_mfma_f32_16x16x32_bf16 a[16:19], v[112:115], a[152:155], a[16:19]
v_mfma_f32_16x16x32_bf16 a[32:35], v[112:115], a[156:159], a[32:35]
buffer_load_dwordx4 v[180:183], v247, s[4:7], s65 offen offset:0 sc1
v_mfma_f32_16x16x32_bf16 v[36:39], v[116:119], a[144:147], v[36:39]
v_mfma_f32_16x16x32_bf16 a[4:7], v[116:119], a[148:151], a[4:7]
v_mfma_f32_16x16x32_bf16 a[20:23], v[116:119], a[152:155], a[20:23]
buffer_load_dwordx4 v[184:187], v247, s[4:7], s66 offen offset:0 sc1
v_mfma_f32_16x16x32_bf16 a[36:39], v[116:119], a[156:159], a[36:39]
v_mfma_f32_16x16x32_bf16 v[40:43], v[120:123], a[144:147], v[40:43]
v_mfma_f32_16x16x32_bf16 a[8:11], v[120:123], a[148:151], a[8:11]
buffer_load_dwordx4 v[188:191], v247, s[4:7], s67 offen offset:0 sc1
v_mfma_f32_16x16x32_bf16 a[24:27], v[120:123], a[152:155], a[24:27]
v_mfma_f32_16x16x32_bf16 a[40:43], v[120:123], a[156:159], a[40:43]
v_mfma_f32_16x16x32_bf16 v[44:47], v[124:127], a[144:147], v[44:47]
v_mfma_f32_16x16x32_bf16 a[12:15], v[124:127], a[148:151], a[12:15]
v_mfma_f32_16x16x32_bf16 a[28:31], v[124:127], a[152:155], a[28:31]
v_mfma_f32_16x16x32_bf16 a[44:47], v[124:127], a[156:159], a[44:47]
s_waitcnt vmcnt(12)
v_mfma_f32_16x16x32_bf16 v[32:35], v[128:131], a[160:163], v[32:35]
buffer_load_dwordx4 v[192:195], v248, s[4:7], s64 offen offset:0 sc1
v_mfma_f32_16x16x32_bf16 a[0:3], v[128:131], a[164:167], a[0:3]
v_mfma_f32_16x16x32_bf16 a[16:19], v[128:131], a[168:171], a[16:19]
v_mfma_f32_16x16x32_bf16 a[32:35], v[128:131], a[172:175], a[32:35]
buffer_load_dwordx4 v[196:199], v248, s[4:7], s65 offen offset:0 sc1
v_mfma_f32_16x16x32_bf16 v[36:39], v[132:135], a[160:163], v[36:39]
v_mfma_f32_16x16x32_bf16 a[4:7], v[132:135], a[164:167], a[4:7]
v_mfma_f32_16x16x32_bf16 a[20:23], v[132:135], a[168:171], a[20:23]
buffer_load_dwordx4 v[200:203], v248, s[4:7], s66 offen offset:0 sc1
v_mfma_f32_16x16x32_bf16 a[36:39], v[132:135], a[172:175], a[36:39]
v_mfma_f32_16x16x32_bf16 v[40:43], v[136:139], a[160:163], v[40:43]
v_mfma_f32_16x16x32_bf16 a[8:11], v[136:139], a[164:167], a[8:11]
buffer_load_dwordx4 v[204:207], v248, s[4:7], s67 offen offset:0 sc1
v_mfma_f32_16x16x32_bf16 a[24:27], v[136:139], a[168:171], a[24:27]
v_mfma_f32_16x16x32_bf16 a[40:43], v[136:139], a[172:175], a[40:43]
v_mfma_f32_16x16x32_bf16 v[44:47], v[140:143], a[160:163], v[44:47]
v_mfma_f32_16x16x32_bf16 a[12:15], v[140:143], a[164:167], a[12:15]
v_mfma_f32_16x16x32_bf16 a[28:31], v[140:143], a[168:171], a[28:31]
v_mfma_f32_16x16x32_bf16 a[44:47], v[140:143], a[172:175], a[44:47]
s_waitcnt vmcnt(12)
v_mfma_f32_16x16x32_bf16 v[32:35], v[144:147], a[176:179], v[32:35]
v_mfma_f32_16x16x32_bf16 a[0:3], v[144:147], a[180:183], a[0:3]
v_mfma_f32_16x16x32_bf16 a[16:19], v[144:147], a[184:187], a[16:19]
v_mfma_f32_16x16x32_bf16 a[32:35], v[144:147], a[188:191], a[32:35]
v_mfma_f32_16x16x32_bf16 v[36:39], v[148:151], a[176:179], v[36:39]
v_mfma_f32_16x16x32_bf16 a[4:7], v[148:151], a[180:183], a[4:7]
v_mfma_f32_16x16x32_bf16 a[20:23], v[148:151], a[184:187], a[20:23]
v_mfma_f32_16x16x32_bf16 a[36:39], v[148:151], a[188:191], a[36:39]
v_mfma_f32_16x16x32_bf16 v[40:43], v[152:155], a[176:179], v[40:43]
v_mfma_f32_16x16x32_bf16 a[8:11], v[152:155], a[180:183], a[8:11]
v_mfma_f32_16x16x32_bf16 a[24:27], v[152:155], a[184:187], a[24:27]
v_mfma_f32_16x16x32_bf16 a[40:43], v[152:155], a[188:191], a[40:43]
v_mfma_f32_16x16x32_bf16 v[44:47], v[156:159], a[176:179], v[44:47]
v_mfma_f32_16x16x32_bf16 a[12:15], v[156:159], a[180:183], a[12:15]
v_mfma_f32_16x16x32_bf16 a[28:31], v[156:159], a[184:187], a[28:31]
v_mfma_f32_16x16x32_bf16 a[44:47], v[156:159], a[188:191], a[44:47]
s_waitcnt vmcnt(8)
v_mfma_f32_16x16x32_bf16 v[32:35], v[160:163], a[192:195], v[32:35]
v_mfma_f32_16x16x32_bf16 a[0:3], v[160:163], a[196:199], a[0:3]
v_mfma_f32_16x16x32_bf16 a[16:19], v[160:163], a[200:203], a[16:19]
v_mfma_f32_16x16x32_bf16 a[32:35], v[160:163], a[204:207], a[32:35]
v_mfma_f32_16x16x32_bf16 v[36:39], v[164:167], a[192:195], v[36:39]
v_mfma_f32_16x16x32_bf16 a[4:7], v[164:167], a[196:199], a[4:7]
v_mfma_f32_16x16x32_bf16 a[20:23], v[164:167], a[200:203], a[20:23]
v_mfma_f32_16x16x32_bf16 a[36:39], v[164:167], a[204:207], a[36:39]
v_mfma_f32_16x16x32_bf16 v[40:43], v[168:171], a[192:195], v[40:43]
v_mfma_f32_16x16x32_bf16 a[8:11], v[168:171], a[196:199], a[8:11]
v_mfma_f32_16x16x32_bf16 a[24:27], v[168:171], a[200:203], a[24:27]
v_mfma_f32_16x16x32_bf16 a[40:43], v[168:171], a[204:207], a[40:43]
v_mfma_f32_16x16x32_bf16 v[44:47], v[172:175], a[192:195], v[44:47]
v_mfma_f32_16x16x32_bf16 a[12:15], v[172:175], a[196:199], a[12:15]
v_mfma_f32_16x16x32_bf16 a[28:31], v[172:175], a[200:203], a[28:31]
v_mfma_f32_16x16x32_bf16 a[44:47], v[172:175], a[204:207], a[44:47]
s_waitcnt vmcnt(4)
v_mfma_f32_16x16x32_bf16 v[32:35], v[176:179], a[208:211], v[32:35]
v_mfma_f32_16x16x32_bf16 a[0:3], v[176:179], a[212:215], a[0:3]
v_mfma_f32_16x16x32_bf16 a[16:19], v[176:179], a[216:219], a[16:19]
v_mfma_f32_16x16x32_bf16 a[32:35], v[176:179], a[220:223], a[32:35]
v_mfma_f32_16x16x32_bf16 v[36:39], v[180:183], a[208:211], v[36:39]
v_mfma_f32_16x16x32_bf16 a[4:7], v[180:183], a[212:215], a[4:7]
v_mfma_f32_16x16x32_bf16 a[20:23], v[180:183], a[216:219], a[20:23]
v_mfma_f32_16x16x32_bf16 a[36:39], v[180:183], a[220:223], a[36:39]
v_mfma_f32_16x16x32_bf16 v[40:43], v[184:187], a[208:211], v[40:43]
v_mfma_f32_16x16x32_bf16 a[8:11], v[184:187], a[212:215], a[8:11]
v_mfma_f32_16x16x32_bf16 a[24:27], v[184:187], a[216:219], a[24:27]
v_mfma_f32_16x16x32_bf16 a[40:43], v[184:187], a[220:223], a[40:43]
v_mfma_f32_16x16x32_bf16 v[44:47], v[188:191], a[208:211], v[44:47]
v_mfma_f32_16x16x32_bf16 a[12:15], v[188:191], a[212:215], a[12:15]
v_mfma_f32_16x16x32_bf16 a[28:31], v[188:191], a[216:219], a[28:31]
v_mfma_f32_16x16x32_bf16 a[44:47], v[188:191], a[220:223], a[44:47]
s_waitcnt vmcnt(0)
v_mfma_f32_16x16x32_bf16 v[32:35], v[192:195], a[224:227], v[32:35]
v_mfma_f32_16x16x32_bf16 a[0:3], v[192:195], a[228:231], a[0:3]
v_mfma_f32_16x16x32_bf16 a[16:19], v[192:195], a[232:235], a[16:19]
v_mfma_f32_16x16x32_bf16 a[32:35], v[192:195], a[236:239], a[32:35]
v_mfma_f32_16x16x32_bf16 v[36:39], v[196:199], a[224:227], v[36:39]
v_mfma_f32_16x16x32_bf16 a[4:7], v[196:199], a[228:231], a[4:7]
v_mfma_f32_16x16x32_bf16 a[20:23], v[196:199], a[232:235], a[20:23]
v_mfma_f32_16x16x32_bf16 a[36:39], v[196:199], a[236:239], a[36:39]
v_mfma_f32_16x16x32_bf16 v[40:43], v[200:203], a[224:227], v[40:43]
v_mfma_f32_16x16x32_bf16 a[8:11], v[200:203], a[228:231], a[8:11]
v_mfma_f32_16x16x32_bf16 a[24:27], v[200:203], a[232:235], a[24:27]
v_mfma_f32_16x16x32_bf16 a[40:43], v[200:203], a[236:239], a[40:43]
v_mfma_f32_16x16x32_bf16 v[44:47], v[204:207], a[224:227], v[44:47]
v_mfma_f32_16x16x32_bf16 a[12:15], v[204:207], a[228:231], a[12:15]
v_mfma_f32_16x16x32_bf16 a[28:31], v[204:207], a[232:235], a[28:31]
v_mfma_f32_16x16x32_bf16 a[44:47], v[204:207], a[236:239], a[44:47]
v_lshlrev_b32 v249, 4, v1
v_add_u32 v250, s31, v249
ds_write_b128 v250, a[0:3] offset:0
ds_write_b128 v250, a[4:7] offset:1024
ds_write_b128 v250, a[8:11] offset:2048
s_nop 0
ds_write_b128 v250, a[12:15] offset:3072
ds_write_b128 v250, a[16:19] offset:4096
ds_write_b128 v250, a[20:23] offset:5120
ds_write_b128 v250, a[24:27] offset:6144
ds_write_b128 v250, a[28:31] offset:7168
ds_write_b128 v250, a[32:35] offset:8192
ds_write_b128 v250, a[36:39] offset:9216
ds_write_b128 v250, a[40:43] offset:10240
ds_write_b128 v250, a[44:47] offset:11264
s_xor_b32 s33, s25, 1
s_mul_i32 s33, s33, 36864
s_add_u32 s33, s33, 0
v_add_u32 v251, s33, v249
s_xor_b32 s33, s25, 2
s_mul_i32 s33, s33, 36864
s_add_u32 s33, s33, 0
v_add_u32 v252, s33, v249
s_xor_b32 s33, s25, 3
s_mul_i32 s33, s33, 36864
s_add_u32 s33, s33, 0
v_add_u32 v253, s33, v249
s_waitcnt lgkmcnt(0)
s_barrier
ds_read_b128 v[64:67], v251 offset:0
ds_read_b128 v[68:71], v251 offset:1024
ds_read_b128 v[72:75], v251 offset:2048
ds_read_b128 v[76:79], v251 offset:3072
ds_read_b128 v[80:83], v252 offset:4096
ds_read_b128 v[84:87], v252 offset:5120
ds_read_b128 v[88:91], v252 offset:6144
ds_read_b128 v[92:95], v252 offset:7168
ds_read_b128 v[96:99], v253 offset:8192
ds_read_b128 v[100:103], v253 offset:9216
ds_read_b128 v[104:107], v253 offset:10240
ds_read_b128 v[108:111], v253 offset:11264
s_waitcnt lgkmcnt(8)
v_pk_add_f32 v[32:33], v[32:33], v[64:65]
v_pk_add_f32 v[34:35], v[34:35], v[66:67]
v_pk_add_f32 v[36:37], v[36:37], v[68:69]
v_pk_add_f32 v[38:39], v[38:39], v[70:71]
v_pk_add_f32 v[40:41], v[40:41], v[72:73]
v_pk_add_f32 v[42:43], v[42:43], v[74:75]
v_pk_add_f32 v[44:45], v[44:45], v[76:77]
v_pk_add_f32 v[46:47], v[46:47], v[78:79]
s_waitcnt lgkmcnt(4)
v_pk_add_f32 v[32:33], v[32:33], v[80:81]
v_pk_add_f32 v[34:35], v[34:35], v[82:83]
v_pk_add_f32 v[36:37], v[36:37], v[84:85]
v_pk_add_f32 v[38:39], v[38:39], v[86:87]
v_pk_add_f32 v[40:41], v[40:41], v[88:89]
v_pk_add_f32 v[42:43], v[42:43], v[90:91]
v_pk_add_f32 v[44:45], v[44:45], v[92:93]
v_pk_add_f32 v[46:47], v[46:47], v[94:95]
s_waitcnt lgkmcnt(0)
v_pk_add_f32 v[32:33], v[32:33], v[96:97]
v_pk_add_f32 v[34:35], v[34:35], v[98:99]
v_pk_add_f32 v[36:37], v[36:37], v[100:101]
v_pk_add_f32 v[38:39], v[38:39], v[102:103]
v_pk_add_f32 v[40:41], v[40:41], v[104:105]
v_pk_add_f32 v[42:43], v[42:43], v[106:107]
v_pk_add_f32 v[44:45], v[44:45], v[108:109]
v_pk_add_f32 v[46:47], v[46:47], v[110:111]
v_cvt_pk_bf16_f32 v120, v32, v33
v_cvt_pk_bf16_f32 v121, v34, v35
v_cvt_pk_bf16_f32 v122, v36, v37
v_cvt_pk_bf16_f32 v123, v38, v39
buffer_store_dwordx4 v[120:123], v249, s[4:7], s70 offen offset:0 sc1
v_cvt_pk_bf16_f32 v124, v40, v41
v_cvt_pk_bf16_f32 v125, v42, v43
v_cvt_pk_bf16_f32 v126, v44, v45
v_cvt_pk_bf16_f32 v127, v46, v47
buffer_store_dwordx4 v[124:127], v249, s[4:7], s70 offen offset:1024 sc1
s_branch L_s3e
L_s3s:
s_cmp_ge_u32 s27, 24
s_cbranch_scc1 L_nop4
v_lshlrev_b32 v11, 3, v1
s_mov_b32 s12, s54
s_mov_b32 s13, s55
s_mov_b32 s14, 1179648
s_mov_b32 s15, 0x20000
v_lshlrev_b32 v28, 4, v1
v_add_u32 v29, 4096, v28
v_add_u32 v30, 8192, v28
s_lshr_b32 s33, s47, 2
s_lshl_b32 s33, s33, 3
s_add_u32 s33, s33, 1420
v_add_u32 v16, s33, v1
s_mul_i32 s52, s48, 3
s_mul_i32 s33, s49, 72
s_add_u32 s33, s33, s52
s_add_u32 s33, s33, 1276
v_min_u32 v17, 19, v1
v_subrev_u32 v17, 8, v17
v_and_b32 v18, 3, v17
v_mul_u32_u24 v18, 18, v18
v_lshrrev_b32 v17, 2, v17
v_add3_u32 v17, v17, v18, s33
v_cmp_gt_u32 vcc, 8, v1
s_nop 1
v_cndmask_b32 v16, v17, v16, vcc
v_lshlrev_b32 v23, 7, v16
s_lshl_b32 s33, s52, 1
s_add_u32 s33, s33, s49
s_add_u32 s33, s33, 1484
v_min_u32 v17, 2, v1
v_lshl_add_u32 v17, v17, 1, s33
v_lshlrev_b32 v62, 7, v17
v_add_u32 v63, 4608, v62
v_cmp_eq_u32 vcc, 0, v6
v_mov_b32 v53, 0x3f803f80
s_nop 0
v_cndmask_b32 v52, 0, v53, vcc
v_mov_b32 v53, v52
v_cmp_eq_u32 vcc, 1, v6
v_mov_b32 v55, 0x3f803f80
s_nop 0
v_cndmask_b32 v54, 0, v55, vcc
v_mov_b32 v55, v54
v_cmp_eq_u32 vcc, 2, v6
v_mov_b32 v57, 0x3f803f80
s_nop 0
v_cndmask_b32 v56, 0, v57, vcc
v_mov_b32 v57, v56
v_cmp_eq_u32 vcc, 3, v6
v_mov_b32 v59, 0x3f803f80
s_nop 0
v_cndmask_b32 v58, 0, v59, vcc
v_mov_b32 v59, v58
v_cmp_eq_u32 vcc, 4, v6
v_mov_b32 v61, 0x3f803f80
s_nop 0
v_cndmask_b32 v60, 0, v61, vcc
v_mov_b32 v61, v60
s_lshl_b32 s39, s47, 13
s_lshl_b32 s33, s25, 11
s_add_u32 s39, s39, s33
s_add_u32 s39, s39, 7602176
s_mul_i32 s33, s49, 72
s_add_u32 s33, s33, s50
s_lshl_b32 s40, s33, 13
s_add_u32 s40, s40, 6291456
s_mul_i32 s41, s33, 2560
s_add_u32 s41, s41, 7864320
s_add_u32 s42, s41, 0x5A000
s_mul_i32 s46, s47, 36864
s_add_u32 s46, s46, 8650752
s_mul_i32 s43, s48, 6144
s_add_u32 s43, s43, s46
s_lshl_b32 s33, s25, 11
v_add_u32 v8, s33, v28
s_lshl_b32 s33, s25, 9
v_add_u32 v9, s33, v11
s_mul_i32 s33, s25, 6144
v_add_u32 v12, s33, v28
v_lshrrev_b32 v13, 2, v6
v_lshlrev_b32 v13, 8, v13
v_and_b32 v14, 3, v1
v_lshl_add_u32 v13, v14, 2, v13
v_add_u32 v13, 5248, v13
v_lshrrev_b32 v14, 5, v1
v_lshl_add_u32 v14, v14, 4, v13
v_add_u32 v14, s33, v14
s_lshl_b32 s52, s25, 10
s_add_u32 s33, s25, 4
s_min_u32 s53, s33, 5
s_lshl_b32 s53, s53, 10
v_add_u32 v18, s52, v28
v_add_u32 v19, s53, v28
v_add_u32 v15, 4096, v18
s_cmp_lt_u32 s25, 2
s_cselect_b32 s33, 0, 0x7f000000
v_add_u32 v10, s33, v19
v_lshlrev_b32 v26, 8, v7
v_cmp_eq_u32 vcc, 3, v7
v_mov_b32 v27, 0xff800000
s_nop 0
v_cndmask_b32 v27, 0, v27, vcc
s_mov_b32 s33, 20000
s_waitcnt vmcnt(0)
s_branch gc_22
gp_20:
buffer_load_dwordx4 v[208:211], v5, s[4:7], s51 offen sc1
s_waitcnt vmcnt(0)
gc_22:
v_xor_b32 v240, s24, v211
v_xor_b32 v241, s24, v211
v_or_b32 v240, v240, v241
v_cmp_ne_u32 vcc, 0, v240
s_sub_u32 s33, s33, 1
s_cmp_eq_u32 s33, 0
s_cbranch_scc1 ge_21
s_nop 1
s_cbranch_vccnz gp_20
ge_21:
v_perm_b32 v240, v209, v208, s72
v_perm_b32 v211, v210, v240, s73
v_lshlrev_b32 v216, 16, v228
v_and_b32 v217, s100, v228
v_lshlrev_b32 v218, 16, v229
v_and_b32 v219, s100, v229
v_lshlrev_b32 v220, 16, v230
v_and_b32 v221, s100, v230
v_lshlrev_b32 v222, 16, v231
v_and_b32 v223, s100, v231
v_lshlrev_b32 v224, 16, v232
v_and_b32 v225, s100, v232
v_lshlrev_b32 v226, 16, v233
v_and_b32 v227, s100, v233
v_add_f32_dpp v208, v208, v208 quad_perm:[1,0,3,2] row_mask:0xf bank_mask:0xf
v_add_f32_dpp v209, v209, v209 quad_perm:[1,0,3,2] row_mask:0xf bank_mask:0xf
v_add_f32_dpp v210, v210, v210 quad_perm:[1,0,3,2] row_mask:0xf bank_mask:0xf
v_add_f32_dpp v211, v211, v211 quad_perm:[1,0,3,2] row_mask:0xf bank_mask:0xf
v_add_f32_dpp v208, v208, v208 quad_perm:[2,3,0,1] row_mask:0xf bank_mask:0xf
v_add_f32_dpp v209, v209, v209 quad_perm:[2,3,0,1] row_mask:0xf bank_mask:0xf
v_add_f32_dpp v210, v210, v210 quad_perm:[2,3,0,1] row_mask:0xf bank_mask:0xf
v_add_f32_dpp v211, v211, v211 quad_perm:[2,3,0,1] row_mask:0xf bank_mask:0xf
v_cvt_pk_bf16_f32 v208, v208, v209
v_cvt_pk_bf16_f32 v210, v210, v211
v_and_b32 v209, s100, v208
v_lshlrev_b32 v208, 16, v208
v_and_b32 v211, s100, v210
v_lshlrev_b32 v210, 16, v210
v_mov_b32_dpp v228, v208 row_newbcast:0 row_mask:0xf bank_mask:0xf
v_mov_b32_dpp v229, v209 row_newbcast:0 row_mask:0xf bank_mask:0xf
v_mov_b32_dpp v230, v210 row_newbcast:0 row_mask:0xf bank_mask:0xf
v_mov_b32_dpp v231, v211 row_newbcast:0 row_mask:0xf bank_mask:0xf
v_mov_b32_dpp v48, v208 row_newbcast:4 row_mask:0xf bank_mask:0xf
v_mov_b32_dpp v49, v209 row_newbcast:4 row_mask:0xf bank_mask:0xf
v_mov_b32_dpp v50, v210 row_newbcast:4 row_mask:0xf bank_mask:0xf
v_mov_b32_dpp v51, v211 row_newbcast:4 row_mask:0xf bank_mask:0xf
v_mov_b32_dpp v232, v208 row_newbcast:8 row_mask:0xf bank_mask:0xf
v_mov_b32_dpp v233, v209 row_newbcast:8 row_mask:0xf bank_mask:0xf
v_mov_b32_dpp v254, v210 row_newbcast:8 row_mask:0xf bank_mask:0xf
v_mov_b32_dpp v255, v211 row_newbcast:8 row_mask:0xf bank_mask:0xf
L_nop4:
s_sub_u32 s33, s27, 18
s_and_b32 s60, s33, 1
s_lshr_b32 s61, s33, 1
s_and_b32 s33, s26, 6
s_add_u32 s60, s60, s33
s_and_b32 s33, s26, 1
s_lshl_b32 s33, s33, 2
s_add_u32 s61, s61, s33
s_and_b32 s33, s26, 4
s_lshr_b32 s62, s61, 1
s_add_u32 s62, s62, s33
v_lshlrev_b32 v28, 4, v1
v_add_u32 v29, 4096, v28
v_add_u32 v30, 8192, v28
s_mul_i32 s63, s25, 9216
s_add_u32 s63, s63, 1048576
s_xor_b32 s33, s25, 0
s_lshl_b32 s32, s60, 2
s_add_u32 s33, s33, s32
s_mul_i32 s33, s33, 36864
s_add_u32 s64, s33, s63
s_xor_b32 s33, s25, 1
s_lshl_b32 s32, s60, 2
s_add_u32 s33, s33, s32
s_mul_i32 s33, s33, 36864
s_add_u32 s65, s33, s63
s_xor_b32 s33, s25, 2
s_lshl_b32 s32, s60, 2
s_add_u32 s33, s33, s32
s_mul_i32 s33, s33, 36864
s_add_u32 s66, s33, s63
s_xor_b32 s33, s25, 3
s_lshl_b32 s32, s60, 2
s_add_u32 s33, s33, s32
s_mul_i32 s33, s33, 36864
s_add_u32 s67, s33, s63
s_and_b32 s33, s26, 4
s_lshl_b32 s33, s33, 1
s_add_u32 s33, s33, s61
s_mul_i32 s33, s33, 73728
s_add_u32 s68, s33, s63
s_add_u32 s68, s68, 0x120000
s_add_u32 s69, s68, 36864
v_min_u32 v16, 17, v1
v_cmp_gt_u32 vcc, 9, v16
v_mov_b32 v17, s62
v_mov_b32 v31, s60
v_cndmask_b32 v17, v17, v31, vcc
v_lshl_add_u32 v16, v16, 3, v17
v_lshlrev_b32 v16, 7, v16
v_add_u32 v16, 131072, v16
s_lshl_b32 s70, s60, 2
s_add_u32 s70, s70, s25
s_lshl_b32 s70, s70, 3
s_add_u32 s70, s70, s61
s_lshl_b32 s70, s70, 10
s_add_u32 s70, s70, 7602176
s_lshl_b32 s71, s60, 3
s_add_u32 s71, s71, s61
s_add_u32 s71, s71, 396
s_mov_b32 s78, 0x3cf15bef
s_waitcnt vmcnt(0)
s_cmp_lg_u32 s25, 0
s_cbranch_scc1 pe_24
s_mov_b32 s33, 20000
poll_23:
buffer_load_dword v17, v16, s[4:7], 0 offen sc1
s_waitcnt vmcnt(0)
v_cmp_ne_u32 vcc, s24, v17
s_sub_u32 s33, s33, 1
s_cmp_eq_u32 s33, 0
s_cbranch_scc1 pe_24
s_nop 1
s_cbranch_vccnz poll_23
pe_24:
s_barrier
buffer_load_dwordx4 a[96:99], v28, s[4:7], s68 offen offset:0 sc1
buffer_load_dwordx4 a[100:103], v28, s[4:7], s69 offen offset:0 sc1
buffer_load_dwordx4 v[64:67], v28, s[4:7], s64 offen offset:0 sc1
buffer_load_dwordx4 v[68:71], v28, s[4:7], s65 offen offset:0 sc1
buffer_load_dwordx4 v[72:75], v28, s[4:7], s66 offen offset:0 sc1
buffer_load_dwordx4 v[76:79], v28, s[4:7], s67 offen offset:0 sc1
buffer_load_dwordx4 a[104:107], v28, s[4:7], s68 offen offset:1024 sc1
buffer_load_dwordx4 a[108:111], v28, s[4:7], s69 offen offset:1024 sc1
buffer_load_dwordx4 v[80:83], v28, s[4:7], s64 offen offset:1024 sc1
buffer_load_dwordx4 v[84:87], v28, s[4:7], s65 offen offset:1024 sc1
buffer_load_dwordx4 v[88:91], v28, s[4:7], s66 offen offset:1024 sc1
buffer_load_dwordx4 v[92:95], v28, s[4:7], s67 offen offset:1024 sc1
buffer_load_dwordx4 a[112:115], v28, s[4:7], s68 offen offset:2048 sc1
buffer_load_dwordx4 a[116:119], v28, s[4:7], s69 offen offset:2048 sc1
buffer_load_dwordx4 v[96:99], v28, s[4:7], s64 offen offset:2048 sc1
buffer_load_dwordx4 v[100:103], v28, s[4:7], s65 offen offset:2048 sc1
buffer_load_dwordx4 v[104:107], v28, s[4:7], s66 offen offset:2048 sc1
buffer_load_dwordx4 v[108:111], v28, s[4:7], s67 offen offset:2048 sc1
buffer_load_dwordx4 a[120:123], v28, s[4:7], s68 offen offset:3072 sc1
buffer_load_dwordx4 a[124:127], v28, s[4:7], s69 offen offset:3072 sc1
buffer_load_dwordx4 v[112:115], v28, s[4:7], s64 offen offset:3072 sc1
buffer_load_dwordx4 v[116:119], v28, s[4:7], s65 offen offset:3072 sc1
buffer_load_dwordx4 v[120:123], v28, s[4:7], s66 offen offset:3072 sc1
buffer_load_dwordx4 v[124:127], v28, s[4:7], s67 offen offset:3072 sc1
s_waitcnt vmcnt(18)
v_mfma_f32_16x16x32_bf16 v[32:35], a[96:99], v[64:67], 0
buffer_load_dwordx4 a[128:131], v29, s[4:7], s68 offen offset:0 sc1
v_mfma_f32_16x16x32_bf16 a[0:3], a[96:99], v[68:71], 0
buffer_load_dwordx4 a[132:135], v29, s[4:7], s69 offen offset:0 sc1
v_mfma_f32_16x16x32_bf16 a[8:11], a[96:99], v[72:75], 0
buffer_load_dwordx4 v[128:131], v29, s[4:7], s64 offen offset:0 sc1
v_mfma_f32_16x16x32_bf16 a[16:19], a[96:99], v[76:79], 0
buffer_load_dwordx4 v[132:135], v29, s[4:7], s65 offen offset:0 sc1
v_mfma_f32_16x16x32_bf16 v[36:39], a[100:103], v[64:67], 0
buffer_load_dwordx4 v[136:139], v29, s[4:7], s66 offen offset:0 sc1
v_mfma_f32_16x16x32_bf16 a[4:7], a[100:103], v[68:71], 0
buffer_load_dwordx4 v[140:143], v29, s[4:7], s67 offen offset:0 sc1
v_mfma_f32_16x16x32_bf16 a[12:15], a[100:103], v[72:75], 0
v_mfma_f32_16x16x32_bf16 a[20:23], a[100:103], v[76:79], 0
s_waitcnt vmcnt(18)
v_mfma_f32_16x16x32_bf16 v[32:35], a[104:107], v[80:83], v[32:35]
buffer_load_dwordx4 a[136:139], v29, s[4:7], s68 offen offset:1024 sc1
v_mfma_f32_16x16x32_bf16 a[0:3], a[104:107], v[84:87], a[0:3]
buffer_load_dwordx4 a[140:143], v29, s[4:7], s69 offen offset:1024 sc1
v_mfma_f32_16x16x32_bf16 a[8:11], a[104:107], v[88:91], a[8:11]
buffer_load_dwordx4 v[144:147], v29, s[4:7], s64 offen offset:1024 sc1
v_mfma_f32_16x16x32_bf16 a[16:19], a[104:107], v[92:95], a[16:19]
buffer_load_dwordx4 v[148:151], v29, s[4:7], s65 offen offset:1024 sc1
v_mfma_f32_16x16x32_bf16 v[36:39], a[108:111], v[80:83], v[36:39]
buffer_load_dwordx4 v[152:155], v29, s[4:7], s66 offen offset:1024 sc1
v_mfma_f32_16x16x32_bf16 a[4:7], a[108:111], v[84:87], a[4:7]
buffer_load_dwordx4 v[156:159], v29, s[4:7], s67 offen offset:1024 sc1
v_mfma_f32_16x16x32_bf16 a[12:15], a[108:111], v[88:91], a[12:15]
v_mfma_f32_16x16x32_bf16 a[20:23], a[108:111], v[92:95], a[20:23]
s_waitcnt vmcnt(18)
v_mfma_f32_16x16x32_bf16 v[32:35], a[112:115], v[96:99], v[32:35]
buffer_load_dwordx4 a[144:147], v29, s[4:7], s68 offen offset:2048 sc1
v_mfma_f32_16x16x32_bf16 a[0:3], a[112:115], v[100:103], a[0:3]
buffer_load_dwordx4 a[148:151], v29, s[4:7], s69 offen offset:2048 sc1
v_mfma_f32_16x16x32_bf16 a[8:11], a[112:115], v[104:107], a[8:11]
buffer_load_dwordx4 v[160:163], v29, s[4:7], s64 offen offset:2048 sc1
v_mfma_f32_16x16x32_bf16 a[16:19], a[112:115], v[108:111], a[16:19]
buffer_load_dwordx4 v[164:167], v29, s[4:7], s65 offen offset:2048 sc1
v_mfma_f32_16x16x32_bf16 v[36:39], a[116:119], v[96:99], v[36:39]
buffer_load_dwordx4 v[168:171], v29, s[4:7], s66 offen offset:2048 sc1
v_mfma_f32_16x16x32_bf16 a[4:7], a[116:119], v[100:103], a[4:7]
buffer_load_dwordx4 v[172:175], v29, s[4:7], s67 offen offset:2048 sc1
v_mfma_f32_16x16x32_bf16 a[12:15], a[116:119], v[104:107], a[12:15]
v_mfma_f32_16x16x32_bf16 a[20:23], a[116:119], v[108:111], a[20:23]
s_waitcnt vmcnt(18)
v_mfma_f32_16x16x32_bf16 v[32:35], a[120:123], v[112:115], v[32:35]
buffer_load_dwordx4 a[152:155], v29, s[4:7], s68 offen offset:3072 sc1
v_mfma_f32_16x16x32_bf16 a[0:3], a[120:123], v[116:119], a[0:3]
buffer_load_dwordx4 a[156:159], v29, s[4:7], s69 offen offset:3072 sc1
v_mfma_f32_16x16x32_bf16 a[8:11], a[120:123], v[120:123], a[8:11]
buffer_load_dwordx4 v[176:179], v29, s[4:7], s64 offen offset:3072 sc1
v_mfma_f32_16x16x32_bf16 a[16:19], a[120:123], v[124:127], a[16:19]
buffer_load_dwordx4 v[180:183], v29, s[4:7], s65 offen offset:3072 sc1
v_mfma_f32_16x16x32_bf16 v[36:39], a[124:127], v[112:115], v[36:39]
buffer_load_dwordx4 v[184:187], v29, s[4:7], s66 offen offset:3072 sc1
v_mfma_f32_16x16x32_bf16 a[4:7], a[124:127], v[116:119], a[4:7]
buffer_load_dwordx4 v[188:191], v29, s[4:7], s67 offen offset:3072 sc1
v_mfma_f32_16x16x32_bf16 a[12:15], a[124:127], v[120:123], a[12:15]
v_mfma_f32_16x16x32_bf16 a[20:23], a[124:127], v[124:127], a[20:23]
s_waitcnt vmcnt(18)
v_mfma_f32_16x16x32_bf16 v[32:35], a[128:131], v[128:131], v[32:35]
buffer_load_dwordx4 a[160:163], v30, s[4:7], s68 offen offset:0 sc1
v_mfma_f32_16x16x32_bf16 a[0:3], a[128:131], v[132:135], a[0:3]
buffer_load_dwordx4 a[164:167], v30, s[4:7], s69 offen offset:0 sc1
v_mfma_f32_16x16x32_bf16 a[8:11], a[128:131], v[136:139], a[8:11]
buffer_load_dwordx4 v[192:195], v30, s[4:7], s64 offen offset:0 sc1
v_mfma_f32_16x16x32_bf16 a[16:19], a[128:131], v[140:143], a[16:19]
buffer_load_dwordx4 v[196:199], v30, s[4:7], s65 offen offset:0 sc1
v_mfma_f32_16x16x32_bf16 v[36:39], a[132:135], v[128:131], v[36:39]
buffer_load_dwordx4 v[200:203], v30, s[4:7], s66 offen offset:0 sc1
v_mfma_f32_16x16x32_bf16 a[4:7], a[132:135], v[132:135], a[4:7]
buffer_load_dwordx4 v[204:207], v30, s[4:7], s67 offen offset:0 sc1
v_mfma_f32_16x16x32_bf16 a[12:15], a[132:135], v[136:139], a[12:15]
v_mfma_f32_16x16x32_bf16 a[20:23], a[132:135], v[140:143], a[20:23]
s_waitcnt vmcnt(18)
v_mfma_f32_16x16x32_bf16 v[32:35], a[136:139], v[144:147], v[32:35]
v_mfma_f32_16x16x32_bf16 a[0:3], a[136:139], v[148:151], a[0:3]
v_mfma_f32_16x16x32_bf16 a[8:11], a[136:139], v[152:155], a[8:11]
v_mfma_f32_16x16x32_bf16 a[16:19], a[136:139], v[156:159], a[16:19]
v_mfma_f32_16x16x32_bf16 v[36:39], a[140:143], v[144:147], v[36:39]
v_mfma_f32_16x16x32_bf16 a[4:7], a[140:143], v[148:151], a[4:7]
v_mfma_f32_16x16x32_bf16 a[12:15], a[140:143], v[152:155], a[12:15]
v_mfma_f32_16x16x32_bf16 a[20:23], a[140:143], v[156:159], a[20:23]
s_waitcnt vmcnt(12)
v_mfma_f32_16x16x32_bf16 v[32:35], a[144:147], v[160:163], v[32:35]
v_mfma_f32_16x16x32_bf16 a[0:3], a[144:147], v[164:167], a[0:3]
v_mfma_f32_16x16x32_bf16 a[8:11], a[144:147], v[168:171], a[8:11]
v_mfma_f32_16x16x32_bf16 a[16:19], a[144:147], v[172:175], a[16:19]
v_mfma_f32_16x16x32_bf16 v[36:39], a[148:151], v[160:163], v[36:39]
v_mfma_f32_16x16x32_bf16 a[4:7], a[148:151], v[164:167], a[4:7]
v_mfma_f32_16x16x32_bf16 a[12:15], a[148:151], v[168:171], a[12:15]
v_mfma_f32_16x16x32_bf16 a[20:23], a[148:151], v[172:175], a[20:23]
s_waitcnt vmcnt(6)
v_mfma_f32_16x16x32_bf16 v[32:35], a[152:155], v[176:179], v[32:35]
v_mfma_f32_16x16x32_bf16 a[0:3], a[152:155], v[180:183], a[0:3]
v_mfma_f32_16x16x32_bf16 a[8:11], a[152:155], v[184:187], a[8:11]
v_mfma_f32_16x16x32_bf16 a[16:19], a[152:155], v[188:191], a[16:19]
v_mfma_f32_16x16x32_bf16 v[36:39], a[156:159], v[176:179], v[36:39]
v_mfma_f32_16x16x32_bf16 a[4:7], a[156:159], v[180:183], a[4:7]
v_mfma_f32_16x16x32_bf16 a[12:15], a[156:159], v[184:187], a[12:15]
v_mfma_f32_16x16x32_bf16 a[20:23], a[156:159], v[188:191], a[20:23]
s_waitcnt vmcnt(0)
v_mfma_f32_16x16x32_bf16 v[32:35], a[160:163], v[192:195], v[32:35]
v_mfma_f32_16x16x32_bf16 a[0:3], a[160:163], v[196:199], a[0:3]
v_mfma_f32_16x16x32_bf16 a[8:11], a[160:163], v[200:203], a[8:11]
v_mfma_f32_16x16x32_bf16 a[16:19], a[160:163], v[204:207], a[16:19]
v_mfma_f32_16x16x32_bf16 v[36:39], a[164:167], v[192:195], v[36:39]
v_mfma_f32_16x16x32_bf16 a[4:7], a[164:167], v[196:199], a[4:7]
v_mfma_f32_16x16x32_bf16 a[12:15], a[164:167], v[200:203], a[12:15]
v_mfma_f32_16x16x32_bf16 a[20:23], a[164:167], v[204:207], a[20:23]
v_lshlrev_b32 v249, 4, v1
v_add_u32 v250, s31, v249
ds_write_b128 v250, a[0:3] offset:0
s_nop 2
ds_write_b128 v250, a[4:7] offset:1024
ds_write_b128 v250, a[8:11] offset:2048
ds_write_b128 v250, a[12:15] offset:3072
ds_write_b128 v250, a[16:19] offset:4096
ds_write_b128 v250, a[20:23] offset:5120
s_xor_b32 s33, s25, 1
s_mul_i32 s33, s33, 36864
s_add_u32 s33, s33, 0
v_add_u32 v251, s33, v249
s_xor_b32 s33, s25, 2
s_mul_i32 s33, s33, 36864
s_add_u32 s33, s33, 0
v_add_u32 v252, s33, v249
s_xor_b32 s33, s25, 3
s_mul_i32 s33, s33, 36864
s_add_u32 s33, s33, 0
v_add_u32 v253, s33, v249
s_waitcnt lgkmcnt(0)
s_barrier
ds_read_b128 v[64:67], v251 offset:0
ds_read_b128 v[68:71], v251 offset:1024
ds_read_b128 v[72:75], v252 offset:2048
ds_read_b128 v[76:79], v252 offset:3072
ds_read_b128 v[80:83], v253 offset:4096
ds_read_b128 v[84:87], v253 offset:5120
s_waitcnt lgkmcnt(4)
v_pk_add_f32 v[32:33], v[32:33], v[64:65]
v_pk_add_f32 v[34:35], v[34:35], v[66:67]
v_pk_add_f32 v[36:37], v[36:37], v[68:69]
v_pk_add_f32 v[38:39], v[38:39], v[70:71]
s_waitcnt lgkmcnt(2)
v_pk_add_f32 v[32:33], v[32:33], v[72:73]
v_pk_add_f32 v[34:35], v[34:35], v[74:75]
v_pk_add_f32 v[36:37], v[36:37], v[76:77]
v_pk_add_f32 v[38:39], v[38:39], v[78:79]
s_waitcnt lgkmcnt(0)
v_pk_add_f32 v[32:33], v[32:33], v[80:81]
v_pk_add_f32 v[34:35], v[34:35], v[82:83]
v_pk_add_f32 v[36:37], v[36:37], v[84:85]
v_pk_add_f32 v[38:39], v[38:39], v[86:87]
v_cvt_pk_bf16_f32 v120, v32, v33
v_cvt_pk_bf16_f32 v121, v34, v35
v_cvt_pk_bf16_f32 v122, v36, v37
v_cvt_pk_bf16_f32 v123, v38, v39
v_lshlrev_b32 v32, 16, v120
v_and_b32 v33, s100, v120
v_lshlrev_b32 v34, 16, v121
v_and_b32 v35, s100, v121
v_lshlrev_b32 v36, 16, v122
v_and_b32 v37, s100, v122
v_lshlrev_b32 v38, 16, v123
v_and_b32 v39, s100, v123
v_mul_f32 v32, s78, v32
v_mul_f32 v33, s78, v33
v_mul_f32 v34, s78, v34
v_mul_f32 v35, s78, v35
v_mul_f32 v36, s78, v36
v_mul_f32 v37, s78, v37
v_mul_f32 v38, s78, v38
v_mul_f32 v39, s78, v39
v_cvt_pk_bf16_f32 v120, v32, v33
v_cvt_pk_bf16_f32 v121, v34, v35
v_cvt_pk_bf16_f32 v122, v36, v37
v_cvt_pk_bf16_f32 v123, v38, v39
buffer_store_dwordx4 v[120:123], v249, s[4:7], s70 offen sc1
L_s3e:
s_waitcnt vmcnt(0)
s_barrier
s_lshl_b32 s32, s71, 7
s_add_u32 s32, s32, 131072
v_cmp_eq_u32 vcc, 0, v0
v_mov_b32 v16, 0x7fffffff
s_nop 0
v_cndmask_b32 v16, v16, 0, vcc
v_mov_b32 v17, s24
buffer_store_dword v17, v16, s[4:7], s32 offen sc1
s_cmp_ge_u32 s27, 24
s_cbranch_scc1 L_fin
s_cmp_lg_u32 s25, 0
s_cbranch_scc1 L_p4f
s_mov_b32 s33, 20000
L_p4:
buffer_load_dword v17, v23, s[4:7], 0 offen sc1
s_waitcnt vmcnt(0)
v_cmp_ne_u32 vcc, s24, v17
s_sub_u32 s33, s33, 1
s_cmp_eq_u32 s33, 0
s_cbranch_scc1 L_p4e
s_and_b32 s48, vcc_lo, 0xff
s_cbranch_scc1 L_p4
L_p4e:
v_mov_b32 v17, vcc_lo
ds_write_b32 v28, v17 offset:61440
s_waitcnt lgkmcnt(0)
L_p4f:
s_barrier
ds_read_b32 v17, v28 offset:61440
buffer_load_dwordx4 v[160:163], v28, s[4:7], s39 offen offset:0 sc1
buffer_load_dwordx4 v[164:167], v28, s[4:7], s39 offen offset:1024 sc1
s_waitcnt lgkmcnt(0)
v_readfirstlane_b32 s48, v17
s_nop 0
s_cmp_lg_u32 s48, 0
s_cbranch_scc1 L_s4b
buffer_load_dwordx4 v[64:67], v28, s[4:7], s40 offen offset:0 sc1
buffer_load_dwordx4 v[68:71], v28, s[4:7], s40 offen offset:1024 sc1
buffer_load_dwordx4 v[72:75], v28, s[4:7], s40 offen offset:2048 sc1
buffer_load_dwordx4 v[76:79], v28, s[4:7], s40 offen offset:3072 sc1
buffer_load_dwordx4 v[80:83], v29, s[4:7], s40 offen offset:0 sc1
buffer_load_dwordx4 v[84:87], v29, s[4:7], s40 offen offset:1024 sc1
buffer_load_dwordx4 v[88:91], v29, s[4:7], s40 offen offset:2048 sc1
buffer_load_dwordx4 v[92:95], v29, s[4:7], s40 offen offset:3072 sc1
s_add_u32 s40, s40, 8192
buffer_load_dwordx4 v[96:99], v28, s[4:7], s40 offen offset:0 sc1
buffer_load_dwordx4 v[100:103], v28, s[4:7], s40 offen offset:1024 sc1
buffer_load_dwordx4 v[104:107], v28, s[4:7], s40 offen offset:2048 sc1
buffer_load_dwordx4 v[108:111], v28, s[4:7], s40 offen offset:3072 sc1
buffer_load_dwordx4 v[112:115], v29, s[4:7], s40 offen offset:0 sc1
buffer_load_dwordx4 v[116:119], v29, s[4:7], s40 offen offset:1024 sc1
buffer_load_dwordx4 v[120:123], v29, s[4:7], s40 offen offset:2048 sc1
buffer_load_dwordx4 v[124:127], v29, s[4:7], s40 offen offset:3072 sc1
s_add_u32 s40, s40, 8192
buffer_load_dwordx4 v[128:131], v28, s[4:7], s40 offen offset:0 sc1
buffer_load_dwordx4 v[132:135], v28, s[4:7], s40 offen offset:1024 sc1
buffer_load_dwordx4 v[136:139], v28, s[4:7], s40 offen offset:2048 sc1
buffer_load_dwordx4 v[140:143], v28, s[4:7], s40 offen offset:3072 sc1
buffer_load_dwordx4 v[144:147], v29, s[4:7], s40 offen offset:0 sc1
buffer_load_dwordx4 v[148:151], v29, s[4:7], s40 offen offset:1024 sc1
buffer_load_dwordx4 v[152:155], v29, s[4:7], s40 offen offset:2048 sc1
buffer_load_dwordx4 v[156:159], v29, s[4:7], s40 offen offset:3072 sc1
s_add_u32 s40, s40, 8192
buffer_load_dword v16, v62, s[4:7], 0 offen sc1
s_waitcnt vmcnt(25)
s_branch L_s4c
L_s4b:
s_waitcnt vmcnt(0)
L_s4c:
v_lshlrev_b32 v168, 16, v160
v_and_b32 v169, s100, v160
v_lshlrev_b32 v170, 16, v161
v_and_b32 v171, s100, v161
v_lshlrev_b32 v172, 16, v162
v_and_b32 v173, s100, v162
v_lshlrev_b32 v174, 16, v163
v_and_b32 v175, s100, v163
v_lshlrev_b32 v176, 16, v164
v_and_b32 v177, s100, v164
v_lshlrev_b32 v178, 16, v165
v_and_b32 v179, s100, v165
v_lshlrev_b32 v180, 16, v166
v_and_b32 v181, s100, v166
v_lshlrev_b32 v182, 16, v167
v_and_b32 v183, s100, v167
v_max3_f32 v24, v168, v169, v170
v_max3_f32 v24, v24, v171, v172
v_max3_f32 v24, v24, v173, v174
v_max3_f32 v24, v24, v175, v176
v_max3_f32 v24, v24, v177, v178
v_max3_f32 v24, v24, v179, v180
v_max3_f32 v24, v24, v181, v182
v_max_f32 v24, v24, v183
v_mov_b32 v25, v24
s_nop 1
v_permlane32_swap_b32 v24, v25
v_max_f32 v24, v24, v25
v_mov_b32 v25, v24
s_nop 1
v_permlane16_swap_b32 v24, v25
v_max_f32 v24, v24, v25
v_mul_f32 v24, 0x3fb8aa3b, v24
s_mov_b32 s78, 0x3fb8aa3b
v_mov_b32 v25, s78
v_pk_fma_f32 v[168:169], v[168:169], v[24:25], v[24:25] op_sel:[0,1,0] op_sel_hi:[1,1,0] neg_lo:[0,0,1] neg_hi:[0,0,1]
v_pk_fma_f32 v[170:171], v[170:171], v[24:25], v[24:25] op_sel:[0,1,0] op_sel_hi:[1,1,0] neg_lo:[0,0,1] neg_hi:[0,0,1]
v_pk_fma_f32 v[172:173], v[172:173], v[24:25], v[24:25] op_sel:[0,1,0] op_sel_hi:[1,1,0] neg_lo:[0,0,1] neg_hi:[0,0,1]
v_pk_fma_f32 v[174:175], v[174:175], v[24:25], v[24:25] op_sel:[0,1,0] op_sel_hi:[1,1,0] neg_lo:[0,0,1] neg_hi:[0,0,1]
v_pk_fma_f32 v[176:177], v[176:177], v[24:25], v[24:25] op_sel:[0,1,0] op_sel_hi:[1,1,0] neg_lo:[0,0,1] neg_hi:[0,0,1]
v_pk_fma_f32 v[178:179], v[178:179], v[24:25], v[24:25] op_sel:[0,1,0] op_sel_hi:[1,1,0] neg_lo:[0,0,1] neg_hi:[0,0,1]
v_pk_fma_f32 v[180:181], v[180:181], v[24:25], v[24:25] op_sel:[0,1,0] op_sel_hi:[1,1,0] neg_lo:[0,0,1] neg_hi:[0,0,1]
v_pk_fma_f32 v[182:183], v[182:183], v[24:25], v[24:25] op_sel:[0,1,0] op_sel_hi:[1,1,0] neg_lo:[0,0,1] neg_hi:[0,0,1]
v_exp_f32 v168, v168
v_exp_f32 v169, v169
v_exp_f32 v170, v170
v_exp_f32 v171, v171
v_exp_f32 v172, v172
v_exp_f32 v173, v173
v_exp_f32 v174, v174
v_exp_f32 v175, v175
v_exp_f32 v176, v176
v_exp_f32 v177, v177
v_exp_f32 v178, v178
v_exp_f32 v179, v179
v_exp_f32 v180, v180
v_exp_f32 v181, v181
v_exp_f32 v182, v182
v_exp_f32 v183, v183
v_cvt_pk_bf16_f32 v160, v168, v169
v_cvt_pk_bf16_f32 v161, v170, v171
v_cvt_pk_bf16_f32 v162, v172, v173
v_cvt_pk_bf16_f32 v163, v174, v175
v_cvt_pk_bf16_f32 v164, v176, v177
v_cvt_pk_bf16_f32 v165, v178, v179
v_cvt_pk_bf16_f32 v166, v180, v181
v_cvt_pk_bf16_f32 v167, v182, v183
ds_write_b128 v8, v[160:163] offset:0
ds_write_b128 v8, v[164:167] offset:1024
v_pk_add_f32 v[168:169], v[168:169], v[176:177]
v_pk_add_f32 v[170:171], v[170:171], v[178:179]
v_pk_add_f32 v[172:173], v[172:173], v[180:181]
v_pk_add_f32 v[174:175], v[174:175], v[182:183]
v_pk_add_f32 v[168:169], v[168:169], v[172:173]
v_pk_add_f32 v[170:171], v[170:171], v[174:175]
v_pk_add_f32 v[168:169], v[168:169], v[170:171]
v_add_f32 v25, v168, v169
v_mov_b32 v17, v25
s_nop 1
v_permlane32_swap_b32 v25, v17
v_add_f32 v25, v25, v17
v_mov_b32 v17, v25
s_nop 1
v_permlane16_swap_b32 v25, v17
v_add_f32 v25, v25, v17
ds_write_b64 v9, v[24:25] offset:8192
s_cmp_eq_u32 s48, 0
s_cbranch_scc1 L_s4d
s_waitcnt vmcnt(0)
s_cmp_lg_u32 s25, 0
s_cbranch_scc1 pe_26
s_mov_b32 s33, 20000
poll_25:
buffer_load_dword v17, v23, s[4:7], 0 offen sc1
s_waitcnt vmcnt(0)
v_cmp_ne_u32 vcc, s24, v17
s_sub_u32 s33, s33, 1
s_cmp_eq_u32 s33, 0
s_cbranch_scc1 pe_26
s_nop 1
s_cbranch_vccnz poll_25
pe_26:
s_barrier
buffer_load_dwordx4 v[64:67], v28, s[4:7], s40 offen offset:0 sc1
buffer_load_dwordx4 v[68:71], v28, s[4:7], s40 offen offset:1024 sc1
buffer_load_dwordx4 v[72:75], v28, s[4:7], s40 offen offset:2048 sc1
buffer_load_dwordx4 v[76:79], v28, s[4:7], s40 offen offset:3072 sc1
buffer_load_dwordx4 v[80:83], v29, s[4:7], s40 offen offset:0 sc1
buffer_load_dwordx4 v[84:87], v29, s[4:7], s40 offen offset:1024 sc1
buffer_load_dwordx4 v[88:91], v29, s[4:7], s40 offen offset:2048 sc1
buffer_load_dwordx4 v[92:95], v29, s[4:7], s40 offen offset:3072 sc1
s_add_u32 s40, s40, 8192
buffer_load_dwordx4 v[96:99], v28, s[4:7], s40 offen offset:0 sc1
buffer_load_dwordx4 v[100:103], v28, s[4:7], s40 offen offset:1024 sc1
buffer_load_dwordx4 v[104:107], v28, s[4:7], s40 offen offset:2048 sc1
buffer_load_dwordx4 v[108:111], v28, s[4:7], s40 offen offset:3072 sc1
buffer_load_dwordx4 v[112:115], v29, s[4:7], s40 offen offset:0 sc1
buffer_load_dwordx4 v[116:119], v29, s[4:7], s40 offen offset:1024 sc1
buffer_load_dwordx4 v[120:123], v29, s[4:7], s40 offen offset:2048 sc1
buffer_load_dwordx4 v[124:127], v29, s[4:7], s40 offen offset:3072 sc1
s_add_u32 s40, s40, 8192
buffer_load_dwordx4 v[128:131], v28, s[4:7], s40 offen offset:0 sc1
buffer_load_dwordx4 v[132:135], v28, s[4:7], s40 offen offset:1024 sc1
buffer_load_dwordx4 v[136:139], v28, s[4:7], s40 offen offset:2048 sc1
buffer_load_dwordx4 v[140:143], v28, s[4:7], s40 offen offset:3072 sc1
buffer_load_dwordx4 v[144:147], v29, s[4:7], s40 offen offset:0 sc1
buffer_load_dwordx4 v[148:151], v29, s[4:7], s40 offen offset:1024 sc1
buffer_load_dwordx4 v[152:155], v29, s[4:7], s40 offen offset:2048 sc1
buffer_load_dwordx4 v[156:159], v29, s[4:7], s40 offen offset:3072 sc1
s_add_u32 s40, s40, 8192
buffer_load_dword v16, v62, s[4:7], 0 offen sc1
L_s4d:
s_waitcnt lgkmcnt(0)
s_barrier
ds_read_b64 v[240:241], v11 offset:8192
ds_read_b64 v[242:243], v11 offset:8704
ds_read_b64 v[244:245], v11 offset:9216
ds_read_b64 v[246:247], v11 offset:9728
ds_read_b128 a[0:3], v28 offset:0
ds_read_b128 a[4:7], v28 offset:1024
ds_read_b128 a[8:11], v28 offset:2048
ds_read_b128 a[12:15], v28 offset:3072
ds_read_b128 a[16:19], v28 offset:4096
ds_read_b128 a[20:23], v28 offset:5120
ds_read_b128 a[24:27], v28 offset:6144
ds_read_b128 a[28:31], v28 offset:7168
s_waitcnt lgkmcnt(8)
v_max3_f32 v24, v240, v242, v244
v_max_f32 v24, v24, v246
v_sub_f32 v240, v240, v24
v_sub_f32 v242, v242, v24
v_sub_f32 v244, v244, v24
v_sub_f32 v246, v246, v24
v_exp_f32 v240, v240
v_exp_f32 v242, v242
v_exp_f32 v244, v244
v_exp_f32 v246, v246
v_mul_f32 v25, v240, v241
v_fma_f32 v25, v242, v243, v25
v_fma_f32 v25, v244, v245, v25
v_fma_f32 v25, v246, v247, v25
v_rcp_f32 v25, v25
s_nop 0
v_mul_f32 v240, v240, v25
v_mul_f32 v242, v242, v25
v_mul_f32 v244, v244, v25
v_mul_f32 v246, v246, v25
s_waitcnt lgkmcnt(0)
s_waitcnt vmcnt(0)
v_cmp_ne_u32 vcc, s24, v16
s_mov_b32 s47, 1
s_nop 0
s_cbranch_vccnz L_kqn
s_mov_b32 s47, 0
buffer_load_dwordx4 a[32:35], v28, s[4:7], s41 offen sc1
buffer_load_dwordx4 a[36:39], v28, s[4:7], s41 offen offset:1024 sc1
buffer_load_dwordx2 a[40:41], v11, s[4:7], s41 offen offset:2048 sc1
s_add_u32 s41, s41, 2560
buffer_load_dwordx4 a[42:45], v28, s[4:7], s41 offen sc1
buffer_load_dwordx4 a[46:49], v28, s[4:7], s41 offen offset:1024 sc1
buffer_load_dwordx2 a[50:51], v11, s[4:7], s41 offen offset:2048 sc1
s_add_u32 s41, s41, 2560
buffer_load_dwordx4 a[52:55], v28, s[4:7], s41 offen sc1
buffer_load_dwordx4 a[56:59], v28, s[4:7], s41 offen offset:1024 sc1
buffer_load_dwordx2 a[60:61], v11, s[4:7], s41 offen offset:2048 sc1
s_add_u32 s41, s41, 2560
L_kqn:
v_mfma_f32_16x16x32_bf16 v[168:171], v[64:67], a[0:3], 0
v_mfma_f32_16x16x32_bf16 v[172:175], v[72:75], a[8:11], 0
v_mfma_f32_16x16x32_bf16 v[176:179], v[80:83], a[16:19], 0
v_mfma_f32_16x16x32_bf16 v[180:183], v[88:91], a[24:27], 0
v_mfma_f32_16x16x32_bf16 v[168:171], v[68:71], a[4:7], v[168:171]
v_mfma_f32_16x16x32_bf16 v[172:175], v[76:79], a[12:15], v[172:175]
v_mfma_f32_16x16x32_bf16 v[176:179], v[84:87], a[20:23], v[176:179]
v_mfma_f32_16x16x32_bf16 v[180:183], v[92:95], a[28:31], v[180:183]
v_mfma_f32_16x16x32_bf16 v[184:187], v[96:99], a[0:3], 0
v_mfma_f32_16x16x32_bf16 v[188:191], v[104:107], a[8:11], 0
v_mfma_f32_16x16x32_bf16 v[192:195], v[112:115], a[16:19], 0
v_mfma_f32_16x16x32_bf16 v[196:199], v[120:123], a[24:27], 0
v_mfma_f32_16x16x32_bf16 v[184:187], v[100:103], a[4:7], v[184:187]
v_mfma_f32_16x16x32_bf16 v[188:191], v[108:111], a[12:15], v[188:191]
v_mfma_f32_16x16x32_bf16 v[192:195], v[116:119], a[20:23], v[192:195]
v_mfma_f32_16x16x32_bf16 v[196:199], v[124:127], a[28:31], v[196:199]
v_mfma_f32_16x16x32_bf16 v[200:203], v[128:131], a[0:3], 0
v_mfma_f32_16x16x32_bf16 v[204:207], v[136:139], a[8:11], 0
v_mfma_f32_16x16x32_bf16 v[208:211], v[144:147], a[16:19], 0
v_mfma_f32_16x16x32_bf16 v[212:215], v[152:155], a[24:27], 0
v_mfma_f32_16x16x32_bf16 v[200:203], v[132:135], a[4:7], v[200:203]
v_mfma_f32_16x16x32_bf16 v[204:207], v[140:143], a[12:15], v[204:207]
v_mfma_f32_16x16x32_bf16 v[208:211], v[148:151], a[20:23], v[208:211]
v_mfma_f32_16x16x32_bf16 v[212:215], v[156:159], a[28:31], v[212:215]
s_cmp_eq_u32 s47, 0
s_cbranch_scc1 L_kqd
s_mov_b32 s33, 20000
poll_27:
buffer_load_dword v17, v62, s[4:7], 0 offen sc1
s_waitcnt vmcnt(0)
v_cmp_ne_u32 vcc, s24, v17
s_sub_u32 s33, s33, 1
s_cmp_eq_u32 s33, 0
s_cbranch_scc1 pe_28
s_nop 1
s_cbranch_vccnz poll_27
pe_28:
buffer_load_dwordx4 a[32:35], v28, s[4:7], s41 offen sc1
buffer_load_dwordx4 a[36:39], v28, s[4:7], s41 offen offset:1024 sc1
buffer_load_dwordx2 a[40:41], v11, s[4:7], s41 offen offset:2048 sc1
s_add_u32 s41, s41, 2560
buffer_load_dwordx4 a[42:45], v28, s[4:7], s41 offen sc1
buffer_load_dwordx4 a[46:49], v28, s[4:7], s41 offen offset:1024 sc1
buffer_load_dwordx2 a[50:51], v11, s[4:7], s41 offen offset:2048 sc1
s_add_u32 s41, s41, 2560
buffer_load_dwordx4 a[52:55], v28, s[4:7], s41 offen sc1
buffer_load_dwordx4 a[56:59], v28, s[4:7], s41 offen offset:1024 sc1
buffer_load_dwordx2 a[60:61], v11, s[4:7], s41 offen offset:2048 sc1
s_add_u32 s41, s41, 2560
L_kqd:
v_pk_mul_f32 v[168:169], v[168:169], v[240:241] op_sel_hi:[1,0]
v_pk_mul_f32 v[170:171], v[170:171], v[240:241] op_sel_hi:[1,0]
v_pk_fma_f32 v[168:169], v[172:173], v[242:243], v[168:169] op_sel_hi:[1,0,1]
v_pk_fma_f32 v[170:171], v[174:175], v[242:243], v[170:171] op_sel_hi:[1,0,1]
v_pk_fma_f32 v[168:169], v[176:177], v[244:245], v[168:169] op_sel_hi:[1,0,1]
v_pk_fma_f32 v[170:171], v[178:179], v[244:245], v[170:171] op_sel_hi:[1,0,1]
v_pk_fma_f32 v[168:169], v[180:181], v[246:247], v[168:169] op_sel_hi:[1,0,1]
v_pk_fma_f32 v[170:171], v[182:183], v[246:247], v[170:171] op_sel_hi:[1,0,1]
v_pk_fma_f32 v[168:169], v[168:169], v[228:229], v[216:217]
v_pk_fma_f32 v[170:171], v[170:171], v[230:231], v[218:219]
v_cvt_pk_bf16_f32 v234, v168, v169
v_cvt_pk_bf16_f32 v235, v170, v171
v_pk_mul_f32 v[184:185], v[184:185], v[240:241] op_sel_hi:[1,0]
v_pk_mul_f32 v[186:187], v[186:187], v[240:241] op_sel_hi:[1,0]
v_pk_fma_f32 v[184:185], v[188:189], v[242:243], v[184:185] op_sel_hi:[1,0,1]
v_pk_fma_f32 v[186:187], v[190:191], v[242:243], v[186:187] op_sel_hi:[1,0,1]
v_pk_fma_f32 v[184:185], v[192:193], v[244:245], v[184:185] op_sel_hi:[1,0,1]
v_pk_fma_f32 v[186:187], v[194:195], v[244:245], v[186:187] op_sel_hi:[1,0,1]
v_pk_fma_f32 v[184:185], v[196:197], v[246:247], v[184:185] op_sel_hi:[1,0,1]
v_pk_fma_f32 v[186:187], v[198:199], v[246:247], v[186:187] op_sel_hi:[1,0,1]
v_pk_fma_f32 v[184:185], v[184:185], v[48:49], v[220:221]
v_pk_fma_f32 v[186:187], v[186:187], v[50:51], v[222:223]
v_cvt_pk_bf16_f32 v236, v184, v185
v_cvt_pk_bf16_f32 v237, v186, v187
v_pk_mul_f32 v[200:201], v[200:201], v[240:241] op_sel_hi:[1,0]
v_pk_mul_f32 v[202:203], v[202:203], v[240:241] op_sel_hi:[1,0]
v_pk_fma_f32 v[200:201], v[204:205], v[242:243], v[200:201] op_sel_hi:[1,0,1]
v_pk_fma_f32 v[202:203], v[206:207], v[242:243], v[202:203] op_sel_hi:[1,0,1]
v_pk_fma_f32 v[200:201], v[208:209], v[244:245], v[200:201] op_sel_hi:[1,0,1]
v_pk_fma_f32 v[202:203], v[210:211], v[244:245], v[202:203] op_sel_hi:[1,0,1]
v_pk_fma_f32 v[200:201], v[212:213], v[246:247], v[200:201] op_sel_hi:[1,0,1]
v_pk_fma_f32 v[202:203], v[214:215], v[246:247], v[202:203] op_sel_hi:[1,0,1]
v_pk_fma_f32 v[200:201], v[200:201], v[232:233], v[224:225]
v_pk_fma_f32 v[202:203], v[202:203], v[254:255], v[226:227]
v_cvt_pk_bf16_f32 v238, v200, v201
v_cvt_pk_bf16_f32 v239, v202, v203
s_waitcnt vmcnt(0)
v_mfma_f32_16x16x16_bf16 v[84:87], a[32:33], v[52:53], 0
v_mfma_f32_16x16x16_bf16 v[64:67], a[32:33], v[234:235], 0
v_mfma_f32_16x16x16_bf16 v[84:87], a[34:35], v[54:55], v[84:87]
v_mfma_f32_16x16x16_bf16 v[68:71], a[34:35], v[234:235], 0
v_mfma_f32_16x16x16_bf16 v[84:87], a[36:37], v[56:57], v[84:87]
v_mfma_f32_16x16x16_bf16 v[72:75], a[36:37], v[234:235], 0
v_mfma_f32_16x16x16_bf16 v[84:87], a[38:39], v[58:59], v[84:87]
v_mfma_f32_16x16x16_bf16 v[76:79], a[38:39], v[234:235], 0
v_mfma_f32_16x16x16_bf16 v[84:87], a[40:41], v[60:61], v[84:87]
v_mfma_f32_16x16x16_bf16 v[80:83], a[40:41], v[234:235], 0
v_mfma_f32_16x16x16_bf16 v[84:87], a[42:43], v[52:53], v[84:87]
v_mfma_f32_16x16x16_bf16 v[64:67], a[42:43], v[236:237], v[64:67]
v_mfma_f32_16x16x16_bf16 v[84:87], a[44:45], v[54:55], v[84:87]
v_mfma_f32_16x16x16_bf16 v[68:71], a[44:45], v[236:237], v[68:71]
v_mfma_f32_16x16x16_bf16 v[84:87], a[46:47], v[56:57], v[84:87]
v_mfma_f32_16x16x16_bf16 v[72:75], a[46:47], v[236:237], v[72:75]
v_mfma_f32_16x16x16_bf16 v[84:87], a[48:49], v[58:59], v[84:87]
v_mfma_f32_16x16x16_bf16 v[76:79], a[48:49], v[236:237], v[76:79]
v_mfma_f32_16x16x16_bf16 v[84:87], a[50:51], v[60:61], v[84:87]
v_mfma_f32_16x16x16_bf16 v[80:83], a[50:51], v[236:237], v[80:83]
v_mfma_f32_16x16x16_bf16 v[84:87], a[52:53], v[52:53], v[84:87]
v_mfma_f32_16x16x16_bf16 v[64:67], a[52:53], v[238:239], v[64:67]
v_mfma_f32_16x16x16_bf16 v[84:87], a[54:55], v[54:55], v[84:87]
v_mfma_f32_16x16x16_bf16 v[68:71], a[54:55], v[238:239], v[68:71]
v_mfma_f32_16x16x16_bf16 v[84:87], a[56:57], v[56:57], v[84:87]
v_mfma_f32_16x16x16_bf16 v[72:75], a[56:57], v[238:239], v[72:75]
v_mfma_f32_16x16x16_bf16 v[84:87], a[58:59], v[58:59], v[84:87]
v_mfma_f32_16x16x16_bf16 v[76:79], a[58:59], v[238:239], v[76:79]
v_mfma_f32_16x16x16_bf16 v[84:87], a[60:61], v[60:61], v[84:87]
v_mfma_f32_16x16x16_bf16 v[80:83], a[60:61], v[238:239], v[80:83]
s_mov_b32 s78, 0x3f803f80
v_mov_b32 v24, 0
v_mov_b32 v25, 0
v_dot2_f32_bf16 v24, v234, s78, v24
v_dot2_f32_bf16 v25, v234, v234, v25
v_dot2_f32_bf16 v24, v235, s78, v24
v_dot2_f32_bf16 v25, v235, v235, v25
v_dot2_f32_bf16 v24, v236, s78, v24
v_dot2_f32_bf16 v25, v236, v236, v25
v_dot2_f32_bf16 v24, v237, s78, v24
v_dot2_f32_bf16 v25, v237, v237, v25
v_dot2_f32_bf16 v24, v238, s78, v24
v_dot2_f32_bf16 v25, v238, v238, v25
v_dot2_f32_bf16 v24, v239, s78, v24
v_dot2_f32_bf16 v25, v239, v239, v25
s_nop 2
v_permlane32_swap_b32 v24, v25
v_add_f32 v24, v24, v25
v_mov_b32 v25, v24
s_nop 1
v_permlane16_swap_b32 v24, v25
v_add_f32 v24, v24, v25
ds_write_b128 v12, v[64:67] offset:16384
ds_write_b128 v12, v[68:71] offset:17408
ds_write_b128 v12, v[72:75] offset:18432
ds_write_b128 v12, v[76:79] offset:19456
ds_write_b128 v12, v[80:83] offset:20480
ds_write_b128 v12, v[84:87] offset:21504
ds_write_b32 v14, v24 offset:16384
s_waitcnt lgkmcnt(0)
s_barrier
ds_read_b128 v[96:99], v18 offset:16384
ds_read_b128 v[100:103], v18 offset:22528
ds_read_b128 v[104:107], v18 offset:28672
ds_read_b128 v[108:111], v18 offset:34816
ds_read_b128 v[112:115], v19 offset:16384
ds_read_b128 v[116:119], v19 offset:22528
ds_read_b128 v[120:123], v19 offset:28672
ds_read_b128 v[124:127], v19 offset:34816
s_waitcnt lgkmcnt(4)
v_pk_add_f32 v[96:97], v[96:97], v[100:101]
v_pk_add_f32 v[104:105], v[104:105], v[108:109]
v_pk_add_f32 v[98:99], v[98:99], v[102:103]
v_pk_add_f32 v[106:107], v[106:107], v[110:111]
v_pk_add_f32 v[96:97], v[96:97], v[104:105]
v_pk_add_f32 v[98:99], v[98:99], v[106:107]
v_perm_b32 v96, v96, v99, s74
v_perm_b32 v97, v97, v99, s75
v_perm_b32 v98, v98, v99, s76
v_mov_b32 v99, s24
buffer_store_dwordx4 v[96:99], v18, s[4:7], s43 offen sc1
s_waitcnt lgkmcnt(0)
v_pk_add_f32 v[112:113], v[112:113], v[116:117]
v_pk_add_f32 v[120:121], v[120:121], v[124:125]
v_pk_add_f32 v[114:115], v[114:115], v[118:119]
v_pk_add_f32 v[122:123], v[122:123], v[126:127]
v_pk_add_f32 v[112:113], v[112:113], v[120:121]
v_pk_add_f32 v[114:115], v[114:115], v[122:123]
v_perm_b32 v112, v112, v115, s74
v_perm_b32 v113, v113, v115, s75
v_perm_b32 v114, v114, v115, s76
v_mov_b32 v115, s24
buffer_store_dwordx4 v[112:115], v10, s[4:7], s43 offen sc1
v_lshlrev_b32 v216, 16, v234
v_and_b32 v217, s100, v234
v_lshlrev_b32 v218, 16, v235
v_and_b32 v219, s100, v235
v_lshlrev_b32 v220, 16, v236
v_and_b32 v221, s100, v236
v_lshlrev_b32 v222, 16, v237
v_and_b32 v223, s100, v237
v_lshlrev_b32 v224, 16, v238
v_and_b32 v225, s100, v238
v_lshlrev_b32 v226, 16, v239
v_and_b32 v227, s100, v239
s_cmp_ge_u32 s25, 2
s_cbranch_scc1 L_pl1
s_mov_b32 s49, 0
s_mov_b32 s33, 20000
pl_29:
buffer_load_dword v17, v63, s[4:7], 0 offen sc1
s_bitcmp1_b32 s49, 0
s_cbranch_scc1 pp_31
s_add_u32 s32, s46, 0
buffer_load_dwordx4 v[128:131], v18, s[4:7], s32 offen sc1
buffer_load_dwordx4 v[152:155], v19, s[4:7], s32 offen sc1
pp_31:
s_bitcmp1_b32 s49, 1
s_cbranch_scc1 pp_32
s_add_u32 s32, s46, 6144
buffer_load_dwordx4 v[132:135], v18, s[4:7], s32 offen sc1
buffer_load_dwordx4 v[156:159], v19, s[4:7], s32 offen sc1
pp_32:
s_bitcmp1_b32 s49, 2
s_cbranch_scc1 pp_33
s_add_u32 s32, s46, 12288
buffer_load_dwordx4 v[136:139], v18, s[4:7], s32 offen sc1
buffer_load_dwordx4 v[160:163], v19, s[4:7], s32 offen sc1
pp_33:
s_bitcmp1_b32 s49, 3
s_cbranch_scc1 pp_34
s_add_u32 s32, s46, 18432
buffer_load_dwordx4 v[140:143], v18, s[4:7], s32 offen sc1
buffer_load_dwordx4 v[164:167], v19, s[4:7], s32 offen sc1
pp_34:
s_bitcmp1_b32 s49, 4
s_cbranch_scc1 pp_35
s_add_u32 s32, s46, 24576
buffer_load_dwordx4 v[144:147], v18, s[4:7], s32 offen sc1
buffer_load_dwordx4 v[168:171], v19, s[4:7], s32 offen sc1
pp_35:
s_bitcmp1_b32 s49, 5
s_cbranch_scc1 pp_36
s_add_u32 s32, s46, 30720
buffer_load_dwordx4 v[148:151], v18, s[4:7], s32 offen sc1
buffer_load_dwordx4 v[172:175], v19, s[4:7], s32 offen sc1
pp_36:
s_waitcnt vmcnt(0)
v_cmp_ne_u32 vcc, s24, v131
v_cmp_ne_u32 s[60:61], s24, v155
s_nop 0
s_or_b64 s[60:61], s[60:61], vcc
s_cselect_b32 s32, 0, 1
s_or_b32 s49, s49, s32
v_cmp_ne_u32 vcc, s24, v135
v_cmp_ne_u32 s[62:63], s24, v159
s_nop 0
s_or_b64 s[62:63], s[62:63], vcc
s_cselect_b32 s32, 0, 2
s_or_b32 s49, s49, s32
v_cmp_ne_u32 vcc, s24, v139
v_cmp_ne_u32 s[64:65], s24, v163
s_nop 0
s_or_b64 s[64:65], s[64:65], vcc
s_cselect_b32 s32, 0, 4
s_or_b32 s49, s49, s32
v_cmp_ne_u32 vcc, s24, v143
v_cmp_ne_u32 s[66:67], s24, v167
s_nop 0
s_or_b64 s[66:67], s[66:67], vcc
s_cselect_b32 s32, 0, 8
s_or_b32 s49, s49, s32
v_cmp_ne_u32 vcc, s24, v147
v_cmp_ne_u32 s[68:69], s24, v171
s_nop 0
s_or_b64 s[68:69], s[68:69], vcc
s_cselect_b32 s32, 0, 16
s_or_b32 s49, s49, s32
v_cmp_ne_u32 vcc, s24, v151
v_cmp_ne_u32 s[70:71], s24, v175
s_nop 0
s_or_b64 s[70:71], s[70:71], vcc
s_cselect_b32 s32, 0, 32
s_or_b32 s49, s49, s32
s_sub_u32 s33, s33, 1
s_cmp_eq_u32 s33, 0
s_cbranch_scc1 ple_30
s_cmp_lg_u32 s49, 63
s_cbranch_scc1 pl_29
ple_30:
s_branch L_pl2
L_pl1:
s_mov_b32 s49, 0
s_mov_b32 s33, 20000
pl_37:
buffer_load_dword v17, v63, s[4:7], 0 offen sc1
s_bitcmp1_b32 s49, 0
s_cbranch_scc1 pp_39
s_add_u32 s32, s46, 0
buffer_load_dwordx4 v[128:131], v18, s[4:7], s32 offen sc1
pp_39:
s_bitcmp1_b32 s49, 1
s_cbranch_scc1 pp_40
s_add_u32 s32, s46, 6144
buffer_load_dwordx4 v[132:135], v18, s[4:7], s32 offen sc1
pp_40:
s_bitcmp1_b32 s49, 2
s_cbranch_scc1 pp_41
s_add_u32 s32, s46, 12288
buffer_load_dwordx4 v[136:139], v18, s[4:7], s32 offen sc1
pp_41:
s_bitcmp1_b32 s49, 3
s_cbranch_scc1 pp_42
s_add_u32 s32, s46, 18432
buffer_load_dwordx4 v[140:143], v18, s[4:7], s32 offen sc1
pp_42:
s_bitcmp1_b32 s49, 4
s_cbranch_scc1 pp_43
s_add_u32 s32, s46, 24576
buffer_load_dwordx4 v[144:147], v18, s[4:7], s32 offen sc1
pp_43:
s_bitcmp1_b32 s49, 5
s_cbranch_scc1 pp_44
s_add_u32 s32, s46, 30720
buffer_load_dwordx4 v[148:151], v18, s[4:7], s32 offen sc1
pp_44:
s_waitcnt vmcnt(0)
v_cmp_ne_u32 vcc, s24, v131
s_nop 0
s_cmp_eq_u64 vcc, 0
s_cselect_b32 s32, 1, 0
s_or_b32 s49, s49, s32
v_cmp_ne_u32 vcc, s24, v135
s_nop 0
s_cmp_eq_u64 vcc, 0
s_cselect_b32 s32, 2, 0
s_or_b32 s49, s49, s32
v_cmp_ne_u32 vcc, s24, v139
s_nop 0
s_cmp_eq_u64 vcc, 0
s_cselect_b32 s32, 4, 0
s_or_b32 s49, s49, s32
v_cmp_ne_u32 vcc, s24, v143
s_nop 0
s_cmp_eq_u64 vcc, 0
s_cselect_b32 s32, 8, 0
s_or_b32 s49, s49, s32
v_cmp_ne_u32 vcc, s24, v147
s_nop 0
s_cmp_eq_u64 vcc, 0
s_cselect_b32 s32, 16, 0
s_or_b32 s49, s49, s32
v_cmp_ne_u32 vcc, s24, v151
s_nop 0
s_cmp_eq_u64 vcc, 0
s_cselect_b32 s32, 32, 0
s_or_b32 s49, s49, s32
s_sub_u32 s33, s33, 1
s_cmp_eq_u32 s33, 0
s_cbranch_scc1 ple_38
s_cmp_lg_u32 s49, 63
s_cbranch_scc1 pl_37
ple_38:
L_pl2:
v_cmp_ne_u32 vcc, s24, v17
s_nop 1
s_cbranch_vccnz L_vol
buffer_load_dwordx4 a[64:67], v28, s[4:7], s42 offen sc1
buffer_load_dwordx4 a[68:71], v28, s[4:7], s42 offen offset:1024 sc1
buffer_load_dwordx2 a[72:73], v11, s[4:7], s42 offen offset:2048 sc1
s_add_u32 s42, s42, 2560
buffer_load_dwordx4 a[74:77], v28, s[4:7], s42 offen sc1
buffer_load_dwordx4 a[78:81], v28, s[4:7], s42 offen offset:1024 sc1
buffer_load_dwordx2 a[82:83], v11, s[4:7], s42 offen offset:2048 sc1
s_add_u32 s42, s42, 2560
buffer_load_dwordx4 a[84:87], v28, s[4:7], s42 offen sc1
buffer_load_dwordx4 a[88:91], v28, s[4:7], s42 offen offset:1024 sc1
buffer_load_dwordx2 a[92:93], v11, s[4:7], s42 offen offset:2048 sc1
s_add_u32 s42, s42, 2560
L_vol:
v_perm_b32 v240, v129, v128, s72
v_perm_b32 v131, v130, v240, s73
v_perm_b32 v241, v133, v132, s72
v_perm_b32 v135, v134, v241, s73
v_perm_b32 v242, v137, v136, s72
v_perm_b32 v139, v138, v242, s73
v_perm_b32 v243, v141, v140, s72
v_perm_b32 v143, v142, v243, s73
v_perm_b32 v240, v145, v144, s72
v_perm_b32 v147, v146, v240, s73
v_perm_b32 v241, v149, v148, s72
v_perm_b32 v151, v150, v241, s73
v_pk_add_f32 v[128:129], v[128:129], v[132:133]
v_pk_add_f32 v[136:137], v[136:137], v[140:141]
v_pk_add_f32 v[144:145], v[144:145], v[148:149]
v_pk_add_f32 v[130:131], v[130:131], v[134:135]
v_pk_add_f32 v[138:139], v[138:139], v[142:143]
v_pk_add_f32 v[146:147], v[146:147], v[150:151]
v_pk_add_f32 v[128:129], v[128:129], v[136:137]
v_pk_add_f32 v[130:131], v[130:131], v[138:139]
v_pk_add_f32 v[128:129], v[128:129], v[144:145]
v_pk_add_f32 v[130:131], v[130:131], v[146:147]
ds_write_b128 v18, v[128:131] offset:49152
v_perm_b32 v240, v153, v152, s72
v_perm_b32 v155, v154, v240, s73
v_perm_b32 v241, v157, v156, s72
v_perm_b32 v159, v158, v241, s73
v_perm_b32 v242, v161, v160, s72
v_perm_b32 v163, v162, v242, s73
v_perm_b32 v243, v165, v164, s72
v_perm_b32 v167, v166, v243, s73
v_perm_b32 v240, v169, v168, s72
v_perm_b32 v171, v170, v240, s73
v_perm_b32 v241, v173, v172, s72
v_perm_b32 v175, v174, v241, s73
v_pk_add_f32 v[152:153], v[152:153], v[156:157]
v_pk_add_f32 v[160:161], v[160:161], v[164:165]
v_pk_add_f32 v[168:169], v[168:169], v[172:173]
v_pk_add_f32 v[154:155], v[154:155], v[158:159]
v_pk_add_f32 v[162:163], v[162:163], v[166:167]
v_pk_add_f32 v[170:171], v[170:171], v[174:175]
v_pk_add_f32 v[152:153], v[152:153], v[160:161]
v_pk_add_f32 v[154:155], v[154:155], v[162:163]
v_pk_add_f32 v[152:153], v[152:153], v[168:169]
v_pk_add_f32 v[154:155], v[154:155], v[170:171]
ds_write_b128 v15, v[152:155] offset:49152
s_cbranch_vccz L_vod
s_mov_b32 s33, 20000
poll_45:
buffer_load_dword v17, v63, s[4:7], 0 offen sc1
s_waitcnt vmcnt(0)
v_cmp_ne_u32 vcc, s24, v17
s_sub_u32 s33, s33, 1
s_cmp_eq_u32 s33, 0
s_cbranch_scc1 pe_46
s_nop 1
s_cbranch_vccnz poll_45
pe_46:
buffer_load_dwordx4 a[64:67], v28, s[4:7], s42 offen sc1
buffer_load_dwordx4 a[68:71], v28, s[4:7], s42 offen offset:1024 sc1
buffer_load_dwordx2 a[72:73], v11, s[4:7], s42 offen offset:2048 sc1
s_add_u32 s42, s42, 2560
buffer_load_dwordx4 a[74:77], v28, s[4:7], s42 offen sc1
buffer_load_dwordx4 a[78:81], v28, s[4:7], s42 offen offset:1024 sc1
buffer_load_dwordx2 a[82:83], v11, s[4:7], s42 offen offset:2048 sc1
s_add_u32 s42, s42, 2560
buffer_load_dwordx4 a[84:87], v28, s[4:7], s42 offen sc1
buffer_load_dwordx4 a[88:91], v28, s[4:7], s42 offen offset:1024 sc1
buffer_load_dwordx2 a[92:93], v11, s[4:7], s42 offen offset:2048 sc1
s_add_u32 s42, s42, 2560
L_vod:
s_waitcnt lgkmcnt(0)
s_barrier
ds_read_b32 v24, v13 offset:49152
ds_read_b32 v25, v13 offset:49168
ds_read_b128 v[96:99], v26 offset:54272
ds_read_b128 v[64:67], v28 offset:49152
ds_read_b128 v[100:103], v26 offset:54288
ds_read_b128 v[68:71], v28 offset:50176
ds_read_b128 v[104:107], v26 offset:54304
ds_read_b128 v[72:75], v28 offset:51200
ds_read_b128 v[108:111], v26 offset:54320
ds_read_b128 v[76:79], v28 offset:52224
ds_read_b128 v[112:115], v26 offset:54336
ds_read_b128 v[80:83], v28 offset:53248
s_waitcnt lgkmcnt(10)
v_mul_f32 v24, 0x3a638e39, v24
v_mul_f32 v25, 0x3a638e39, v25
v_fma_f32 v25, -v24, v24, v25
v_max_f32 v25, 0, v25
v_add_f32 v25, 0x3727c5ac, v25
v_rsq_f32 v25, v25
s_nop 0
v_mul_f32 v25, 0x3d2e1a93, v25
s_waitcnt lgkmcnt(8)
v_pk_fma_f32 v[64:65], v[24:25], v[96:97], v[64:65] op_sel_hi:[0,1,1] neg_lo:[1,0,0] neg_hi:[1,0,0]
v_pk_fma_f32 v[66:67], v[24:25], v[98:99], v[66:67] op_sel_hi:[0,1,1] neg_lo:[1,0,0] neg_hi:[1,0,0]
s_waitcnt lgkmcnt(6)
v_pk_fma_f32 v[68:69], v[24:25], v[100:101], v[68:69] op_sel_hi:[0,1,1] neg_lo:[1,0,0] neg_hi:[1,0,0]
v_pk_fma_f32 v[70:71], v[24:25], v[102:103], v[70:71] op_sel_hi:[0,1,1] neg_lo:[1,0,0] neg_hi:[1,0,0]
s_waitcnt lgkmcnt(4)
v_pk_fma_f32 v[72:73], v[24:25], v[104:105], v[72:73] op_sel_hi:[0,1,1] neg_lo:[1,0,0] neg_hi:[1,0,0]
v_pk_fma_f32 v[74:75], v[24:25], v[106:107], v[74:75] op_sel_hi:[0,1,1] neg_lo:[1,0,0] neg_hi:[1,0,0]
s_waitcnt lgkmcnt(2)
v_pk_fma_f32 v[76:77], v[24:25], v[108:109], v[76:77] op_sel_hi:[0,1,1] neg_lo:[1,0,0] neg_hi:[1,0,0]
v_pk_fma_f32 v[78:79], v[24:25], v[110:111], v[78:79] op_sel_hi:[0,1,1] neg_lo:[1,0,0] neg_hi:[1,0,0]
s_waitcnt lgkmcnt(0)
v_pk_fma_f32 v[80:81], v[24:25], v[112:113], v[80:81] op_sel_hi:[0,1,1] neg_lo:[1,0,0] neg_hi:[1,0,0]
v_pk_fma_f32 v[82:83], v[24:25], v[114:115], v[82:83] op_sel_hi:[0,1,1] neg_lo:[1,0,0] neg_hi:[1,0,0]
v_pk_mul_f32 v[64:65], v[64:65], v[24:25] op_sel:[0,1] op_sel_hi:[1,1]
v_pk_mul_f32 v[66:67], v[66:67], v[24:25] op_sel:[0,1] op_sel_hi:[1,1]
v_pk_mul_f32 v[68:69], v[68:69], v[24:25] op_sel:[0,1] op_sel_hi:[1,1]
v_pk_mul_f32 v[70:71], v[70:71], v[24:25] op_sel:[0,1] op_sel_hi:[1,1]
v_pk_mul_f32 v[72:73], v[72:73], v[24:25] op_sel:[0,1] op_sel_hi:[1,1]
v_pk_mul_f32 v[74:75], v[74:75], v[24:25] op_sel:[0,1] op_sel_hi:[1,1]
v_pk_mul_f32 v[76:77], v[76:77], v[24:25] op_sel:[0,1] op_sel_hi:[1,1]
v_pk_mul_f32 v[78:79], v[78:79], v[24:25] op_sel:[0,1] op_sel_hi:[1,1]
v_mul_f32 v80, v80, v25
v_fma_f32 v81, v81, v25, v27
v_fma_f32 v82, v82, v25, v27
v_fma_f32 v83, v83, v25, v27
v_max3_f32 v24, v64, v65, v66
v_max3_f32 v24, v24, v67, v68
v_max3_f32 v24, v24, v69, v70
v_max3_f32 v24, v24, v71, v72
v_max3_f32 v24, v24, v73, v74
v_max3_f32 v24, v24, v75, v76
v_max3_f32 v24, v24, v77, v78
v_max3_f32 v24, v24, v79, v80
v_max3_f32 v24, v24, v81, v82
v_max_f32 v24, v24, v83
v_mov_b32 v25, v24
s_nop 1
v_permlane32_swap_b32 v24, v25
v_max_f32 v24, v24, v25
v_mov_b32 v25, v24
s_nop 1
v_permlane16_swap_b32 v24, v25
v_max_f32 v24, v24, v25
v_pk_add_f32 v[64:65], v[64:65], v[24:25] op_sel_hi:[1,0] neg_lo:[0,1] neg_hi:[0,1]
v_pk_add_f32 v[66:67], v[66:67], v[24:25] op_sel_hi:[1,0] neg_lo:[0,1] neg_hi:[0,1]
v_pk_add_f32 v[68:69], v[68:69], v[24:25] op_sel_hi:[1,0] neg_lo:[0,1] neg_hi:[0,1]
v_pk_add_f32 v[70:71], v[70:71], v[24:25] op_sel_hi:[1,0] neg_lo:[0,1] neg_hi:[0,1]
v_pk_add_f32 v[72:73], v[72:73], v[24:25] op_sel_hi:[1,0] neg_lo:[0,1] neg_hi:[0,1]
v_pk_add_f32 v[74:75], v[74:75], v[24:25] op_sel_hi:[1,0] neg_lo:[0,1] neg_hi:[0,1]
v_pk_add_f32 v[76:77], v[76:77], v[24:25] op_sel_hi:[1,0] neg_lo:[0,1] neg_hi:[0,1]
v_pk_add_f32 v[78:79], v[78:79], v[24:25] op_sel_hi:[1,0] neg_lo:[0,1] neg_hi:[0,1]
v_pk_add_f32 v[80:81], v[80:81], v[24:25] op_sel_hi:[1,0] neg_lo:[0,1] neg_hi:[0,1]
v_pk_add_f32 v[82:83], v[82:83], v[24:25] op_sel_hi:[1,0] neg_lo:[0,1] neg_hi:[0,1]
v_exp_f32 v64, v64
v_exp_f32 v65, v65
v_exp_f32 v66, v66
v_exp_f32 v67, v67
v_exp_f32 v68, v68
v_exp_f32 v69, v69
v_exp_f32 v70, v70
v_exp_f32 v71, v71
v_exp_f32 v72, v72
v_exp_f32 v73, v73
v_exp_f32 v74, v74
v_exp_f32 v75, v75
v_exp_f32 v76, v76
v_exp_f32 v77, v77
v_exp_f32 v78, v78
v_exp_f32 v79, v79
v_exp_f32 v80, v80
v_exp_f32 v81, v81
v_exp_f32 v82, v82
v_exp_f32 v83, v83
v_pk_add_f32 v[96:97], v[64:65], v[74:75]
v_pk_add_f32 v[98:99], v[66:67], v[76:77]
v_pk_add_f32 v[100:101], v[68:69], v[78:79]
v_pk_add_f32 v[102:103], v[70:71], v[80:81]
v_pk_add_f32 v[104:105], v[72:73], v[82:83]
v_pk_add_f32 v[96:97], v[96:97], v[98:99]
v_pk_add_f32 v[100:101], v[100:101], v[102:103]
v_pk_add_f32 v[96:97], v[96:97], v[104:105]
v_pk_add_f32 v[96:97], v[96:97], v[100:101]
v_add_f32 v24, v96, v97
v_mov_b32 v25, v24
s_nop 1
v_permlane32_swap_b32 v24, v25
v_add_f32 v24, v24, v25
v_mov_b32 v25, v24
s_nop 1
v_permlane16_swap_b32 v24, v25
v_add_f32 v24, v24, v25
v_rcp_f32 v24, v24
s_nop 0
v_pk_mul_f32 v[64:65], v[64:65], v[24:25] op_sel_hi:[1,0]
v_pk_mul_f32 v[66:67], v[66:67], v[24:25] op_sel_hi:[1,0]
v_pk_mul_f32 v[68:69], v[68:69], v[24:25] op_sel_hi:[1,0]
v_pk_mul_f32 v[70:71], v[70:71], v[24:25] op_sel_hi:[1,0]
v_pk_mul_f32 v[72:73], v[72:73], v[24:25] op_sel_hi:[1,0]
v_pk_mul_f32 v[74:75], v[74:75], v[24:25] op_sel_hi:[1,0]
v_pk_mul_f32 v[76:77], v[76:77], v[24:25] op_sel_hi:[1,0]
v_pk_mul_f32 v[78:79], v[78:79], v[24:25] op_sel_hi:[1,0]
v_pk_mul_f32 v[80:81], v[80:81], v[24:25] op_sel_hi:[1,0]
v_pk_mul_f32 v[82:83], v[82:83], v[24:25] op_sel_hi:[1,0]
v_cvt_pk_bf16_f32 v96, v64, v65
v_cvt_pk_bf16_f32 v97, v66, v67
v_cvt_pk_bf16_f32 v98, v68, v69
v_cvt_pk_bf16_f32 v99, v70, v71
v_cvt_pk_bf16_f32 v100, v72, v73
v_cvt_pk_bf16_f32 v101, v74, v75
v_cvt_pk_bf16_f32 v102, v76, v77
v_cvt_pk_bf16_f32 v103, v78, v79
v_cvt_pk_bf16_f32 v104, v80, v81
v_cvt_pk_bf16_f32 v105, v82, v83
s_waitcnt vmcnt(0)
v_mfma_f32_16x16x32_bf16 v[128:131], a[64:67], v[96:99], 0
v_mfma_f32_16x16x32_bf16 v[132:135], a[74:77], v[96:99], 0
v_mfma_f32_16x16x32_bf16 v[136:139], a[84:87], v[96:99], 0
v_mfma_f32_16x16x32_bf16 v[128:131], a[68:71], v[100:103], v[128:131]
v_mfma_f32_16x16x32_bf16 v[132:135], a[78:81], v[100:103], v[132:135]
v_mfma_f32_16x16x32_bf16 v[136:139], a[88:91], v[100:103], v[136:139]
s_nop 3
v_mfma_f32_16x16x16_bf16 v[128:131], a[72:73], v[104:105], v[128:131]
v_mfma_f32_16x16x16_bf16 v[132:135], a[82:83], v[104:105], v[132:135]
v_mfma_f32_16x16x16_bf16 v[136:139], a[92:93], v[104:105], v[136:139]
s_nop 5
v_cvt_pk_bf16_f32 v128, v128, v129
v_cvt_pk_bf16_f32 v130, v130, v131
v_and_b32 v129, s100, v128
v_lshlrev_b32 v128, 16, v128
v_and_b32 v131, s100, v130
v_lshlrev_b32 v130, 16, v130
v_pk_add_f32 v[128:129], v[128:129], v[216:217]
v_pk_add_f32 v[130:131], v[130:131], v[218:219]
v_cvt_pk_bf16_f32 v128, v128, v129
v_cvt_pk_bf16_f32 v129, v130, v131
buffer_store_dwordx2 v[128:129], v4, s[12:15], s38 offen offset:0
v_cvt_pk_bf16_f32 v132, v132, v133
v_cvt_pk_bf16_f32 v134, v134, v135
v_and_b32 v133, s100, v132
v_lshlrev_b32 v132, 16, v132
v_and_b32 v135, s100, v134
v_lshlrev_b32 v134, 16, v134
v_pk_add_f32 v[132:133], v[132:133], v[220:221]
v_pk_add_f32 v[134:135], v[134:135], v[222:223]
v_cvt_pk_bf16_f32 v132, v132, v133
v_cvt_pk_bf16_f32 v133, v134, v135
buffer_store_dwordx2 v[132:133], v4, s[12:15], s38 offen offset:32
v_cvt_pk_bf16_f32 v136, v136, v137
v_cvt_pk_bf16_f32 v138, v138, v139
v_and_b32 v137, s100, v136
v_lshlrev_b32 v136, 16, v136
v_and_b32 v139, s100, v138
v_lshlrev_b32 v138, 16, v138
v_pk_add_f32 v[136:137], v[136:137], v[224:225]
v_pk_add_f32 v[138:139], v[138:139], v[226:227]
v_cvt_pk_bf16_f32 v136, v136, v137
v_cvt_pk_bf16_f32 v137, v138, v139
buffer_store_dwordx2 v[136:137], v4, s[12:15], s38 offen offset:64
s_branch L_fin
L_idle:
s_mul_i32 s33, s26, 6
s_add_u32 s33, s33, s27
s_sub_u32 s33, s33, 26
s_cmp_ge_u32 s33, 10
s_cbranch_scc1 L_fin
s_lshr_b32 s26, s33, 1
s_add_u32 s26, s26, 3
s_and_b32 s27, s33, 1
s_add_u32 s27, s27, 24
s_branch L_s3s
s_branch L_fin
L_side:
s_lshl_b32 s77, s26, 3
s_add_u32 s77, s77, s27
s_sub_u32 s77, s77, 48
s_cmp_ge_u32 s77, 36
s_cbranch_scc1 L_help
s_mov_b32 s8, s40
s_mov_b32 s9, s41
s_mov_b32 s10, 354816
s_mov_b32 s11, 0x20000
s_mov_b32 s12, s48
s_mov_b32 s13, s49
s_mov_b32 s14, 5308416
s_mov_b32 s15, 0x20000
v_lshrrev_b32 v16, 3, v1
v_mul_u32_u24 v16, 4608, v16
v_lshrrev_b32 v17, 4, v1
v_lshlrev_b32 v17, 1, v17
v_and_b32 v4, 7, v1
v_xor_b32 v17, v17, v4
v_lshl_add_u32 v4, v17, 4, v16
v_add_u32 v5, 35840, v4
v_add_u32 v6, 71680, v4
v_add_u32 v7, 107520, v4
v_lshrrev_b32 v16, 3, v1
v_mul_u32_u24 v16, 2304, v16
v_lshrrev_b32 v17, 4, v1
v_and_b32 v10, 7, v1
v_xor_b32 v8, v10, v17
v_xor_b32 v9, 4, v8
v_lshl_add_u32 v8, v8, 4, v16
v_lshl_add_u32 v9, v9, 4, v16
v_add_u32 v9, 17408, v9
v_add_u32 v10, 34816, v8
v_add_u32 v11, 34816, v9
v_lshrrev_b32 v16, 3, v1
v_min_u32 v17, 4, v16
v_sub_u32 v16, v16, v17
v_mul_u32_u24 v16, 2304, v16
v_sub_u32 v12, v9, v16
s_lshl_b32 s64, s77, 7
s_mul_i32 s60, s25, 1179648
s_add_u32 s60, s60, s64
s_lshr_b32 s33, s25, 1
s_add_u32 s33, s33, 16
s_mul_i32 s61, s33, 294912
s_add_u32 s61, s61, s64
s_lshl_b32 s64, s33, 7
s_mul_i32 s66, s25, 40960
s_add_u32 s33, s27, 0
s_and_b32 s33, s33, 3
s_lshl_b32 s96, s33, 7
s_mul_i32 s33, s33, 294912
s_add_u32 s79, s33, s60
s_add_u32 m0, s66, 0
s_add_u32 s32, s79, 0
buffer_load_dwordx4 v4, s[12:15], s32 offen offset:0 nt lds
buffer_load_dwordx4 v5, s[12:15], s32 offen offset:1024 nt lds
buffer_load_dwordx4 v6, s[12:15], s32 offen offset:2048 nt lds
buffer_load_dwordx4 v7, s[12:15], s32 offen offset:3072 nt lds
s_add_u32 m0, s66, 4096
s_add_u32 s32, s79, 147456
buffer_load_dwordx4 v4, s[12:15], s32 offen offset:0 nt lds
buffer_load_dwordx4 v5, s[12:15], s32 offen offset:1024 nt lds
buffer_load_dwordx4 v6, s[12:15], s32 offen offset:2048 nt lds
buffer_load_dwordx4 v7, s[12:15], s32 offen offset:3072 nt lds
s_add_u32 s33, s27, 1
s_and_b32 s33, s33, 3
s_lshl_b32 s97, s33, 7
s_mul_i32 s33, s33, 294912
s_add_u32 s79, s33, s60
s_add_u32 m0, s66, 8192
s_add_u32 s32, s79, 0
buffer_load_dwordx4 v4, s[12:15], s32 offen offset:0 nt lds
buffer_load_dwordx4 v5, s[12:15], s32 offen offset:1024 nt lds
buffer_load_dwordx4 v6, s[12:15], s32 offen offset:2048 nt lds
buffer_load_dwordx4 v7, s[12:15], s32 offen offset:3072 nt lds
s_add_u32 m0, s66, 12288
s_add_u32 s32, s79, 147456
buffer_load_dwordx4 v4, s[12:15], s32 offen offset:0 nt lds
buffer_load_dwordx4 v5, s[12:15], s32 offen offset:1024 nt lds
buffer_load_dwordx4 v6, s[12:15], s32 offen offset:2048 nt lds
buffer_load_dwordx4 v7, s[12:15], s32 offen offset:3072 nt lds
s_add_u32 s33, s27, 2
s_and_b32 s33, s33, 3
s_lshl_b32 s98, s33, 7
s_mul_i32 s33, s33, 294912
s_add_u32 s79, s33, s60
s_add_u32 m0, s66, 16384
s_add_u32 s32, s79, 0
buffer_load_dwordx4 v4, s[12:15], s32 offen offset:0 nt lds
buffer_load_dwordx4 v5, s[12:15], s32 offen offset:1024 nt lds
buffer_load_dwordx4 v6, s[12:15], s32 offen offset:2048 nt lds
buffer_load_dwordx4 v7, s[12:15], s32 offen offset:3072 nt lds
s_add_u32 m0, s66, 20480
s_add_u32 s32, s79, 147456
buffer_load_dwordx4 v4, s[12:15], s32 offen offset:0 nt lds
buffer_load_dwordx4 v5, s[12:15], s32 offen offset:1024 nt lds
buffer_load_dwordx4 v6, s[12:15], s32 offen offset:2048 nt lds
buffer_load_dwordx4 v7, s[12:15], s32 offen offset:3072 nt lds
s_add_u32 s33, s27, 3
s_and_b32 s33, s33, 3
s_lshl_b32 s99, s33, 7
s_mul_i32 s33, s33, 294912
s_add_u32 s79, s33, s60
s_add_u32 m0, s66, 24576
s_add_u32 s32, s79, 0
buffer_load_dwordx4 v4, s[12:15], s32 offen offset:0 nt lds
buffer_load_dwordx4 v5, s[12:15], s32 offen offset:1024 nt lds
buffer_load_dwordx4 v6, s[12:15], s32 offen offset:2048 nt lds
buffer_load_dwordx4 v7, s[12:15], s32 offen offset:3072 nt lds
s_add_u32 m0, s66, 28672
s_add_u32 s32, s79, 147456
buffer_load_dwordx4 v4, s[12:15], s32 offen offset:0 nt lds
buffer_load_dwordx4 v5, s[12:15], s32 offen offset:1024 nt lds
buffer_load_dwordx4 v6, s[12:15], s32 offen offset:2048 nt lds
buffer_load_dwordx4 v7, s[12:15], s32 offen offset:3072 nt lds
s_add_u32 m0, s66, 32768
s_add_u32 s32, s61, 0
buffer_load_dwordx4 v4, s[12:15], s32 offen offset:0 nt lds
buffer_load_dwordx4 v5, s[12:15], s32 offen offset:1024 nt lds
buffer_load_dwordx4 v6, s[12:15], s32 offen offset:2048 nt lds
buffer_load_dwordx4 v7, s[12:15], s32 offen offset:3072 nt lds
s_add_u32 m0, s66, 36864
s_add_u32 s32, s61, 147456
buffer_load_dwordx4 v4, s[12:15], s32 offen offset:0 nt lds
buffer_load_dwordx4 v5, s[12:15], s32 offen offset:1024 nt lds
buffer_load_dwordx4 v6, s[12:15], s32 offen offset:2048 nt lds
buffer_load_dwordx4 v7, s[12:15], s32 offen offset:3072 nt lds
s_and_b32 s33, s25, 1
s_mul_i32 s62, s33, 177408
s_sub_u32 s63, 177408, s62
s_add_u32 s64, s64, s62
s_lshl_b32 s33, s25, 9
s_add_u32 s62, s62, s33
s_add_u32 s63, s63, s33
s_and_b32 s65, s25, 2
s_cmp_ge_u32 s77, 18
s_cselect_b32 s69, 18, 0
s_cselect_b32 s70, 0x5A000, 0
s_sub_u32 s69, s77, s69
s_mov_b32 s67, s31
s_mov_b32 s31, s66
v_lshrrev_b32 v16, 5, v1
v_mul_u32_u24 v18, 1024, v16
v_bfe_u32 v16, v1, 2, 3
v_lshl_add_u32 v18, v16, 7, v18
v_lshrrev_b32 v17, 1, v16
v_and_b32 v16, 3, v1
v_lshl_add_u32 v18, v16, 3, v18
v_add_u32 v18, s31, v18
v_xor_b32 v17, s65, v17
v_xor_b32 v16, 0, v17
v_lshl_add_u32 v20, v16, 5, v18
v_xor_b32 v16, 1, v17
v_lshl_add_u32 v21, v16, 5, v18
v_xor_b32 v16, 2, v17
v_lshl_add_u32 v22, v16, 5, v18
v_xor_b32 v16, 3, v17
v_lshl_add_u32 v23, v16, 5, v18
s_mov_b32 s31, s67
v_bfe_u32 v16, v1, 3, 1
v_lshlrev_b32 v18, 10, v16
v_and_b32 v16, 7, v1
v_lshl_add_u32 v18, v16, 7, v18
v_bfe_u32 v16, v1, 4, 1
v_lshl_add_u32 v18, v16, 3, v18
v_bfe_u32 v17, v1, 1, 3
v_lshrrev_b32 v16, 5, v1
v_xor_b32 v17, v17, v16
v_add_u32 v18, s66, v18
v_xor_b32 v16, 0, v17
v_lshl_add_u32 v24, v16, 4, v18
v_xor_b32 v16, 2, v17
v_lshl_add_u32 v25, v16, 4, v18
v_xor_b32 v16, 4, v17
v_lshl_add_u32 v26, v16, 4, v18
v_xor_b32 v16, 6, v17
v_lshl_add_u32 v27, v16, 4, v18
s_mov_b32 s72, 0x0c04000c
s_mov_b32 s73, 0x04020100
s_mov_b32 s74, 0x07060501
s_mov_b32 s75, 0x07060502
s_mov_b32 s76, 0x07060503
s_waitcnt vmcnt(32)
v_readfirstlane_b32 s24, v3
s_nop 0
s_mul_i32 s24, s24, 0x9E3779B1
s_add_u32 s24, s24, 0x7F4A7C15
ds_read_b64_tr_b16 a[120:121], v20 offset:0
ds_read_b64_tr_b16 a[122:123], v20 offset:2048
ds_read_b64_tr_b16 a[124:125], v21 offset:0
ds_read_b64_tr_b16 a[126:127], v21 offset:2048
ds_read_b64_tr_b16 a[128:129], v22 offset:0
ds_read_b64_tr_b16 a[130:131], v22 offset:2048
ds_read_b64_tr_b16 a[132:133], v23 offset:0
ds_read_b64_tr_b16 a[134:135], v23 offset:2048
ds_read_b64_tr_b16 a[136:137], v20 offset:4096
ds_read_b64_tr_b16 a[138:139], v20 offset:6144
ds_read_b64_tr_b16 a[140:141], v21 offset:4096
ds_read_b64_tr_b16 a[142:143], v21 offset:6144
ds_read_b64_tr_b16 a[144:145], v22 offset:4096
ds_read_b64_tr_b16 a[146:147], v22 offset:6144
ds_read_b64_tr_b16 a[148:149], v23 offset:4096
ds_read_b64_tr_b16 a[150:151], v23 offset:6144
s_waitcnt vmcnt(24)
ds_read_b64_tr_b16 a[152:153], v20 offset:8192
ds_read_b64_tr_b16 a[154:155], v20 offset:10240
ds_read_b64_tr_b16 a[156:157], v21 offset:8192
ds_read_b64_tr_b16 a[158:159], v21 offset:10240
ds_read_b64_tr_b16 a[160:161], v22 offset:8192
ds_read_b64_tr_b16 a[162:163], v22 offset:10240
ds_read_b64_tr_b16 a[164:165], v23 offset:8192
ds_read_b64_tr_b16 a[166:167], v23 offset:10240
ds_read_b64_tr_b16 a[168:169], v20 offset:12288
ds_read_b64_tr_b16 a[170:171], v20 offset:14336
ds_read_b64_tr_b16 a[172:173], v21 offset:12288
ds_read_b64_tr_b16 a[174:175], v21 offset:14336
ds_read_b64_tr_b16 a[176:177], v22 offset:12288
ds_read_b64_tr_b16 a[178:179], v22 offset:14336
ds_read_b64_tr_b16 a[180:181], v23 offset:12288
ds_read_b64_tr_b16 a[182:183], v23 offset:14336
s_waitcnt lgkmcnt(0)
s_add_u32 s79, s62, s96
s_add_u32 m0, s66, 0
s_add_u32 s32, s79, 0
buffer_load_dwordx4 v8, s[8:11], s32 offen offset:0  lds
buffer_load_dwordx4 v9, s[8:11], s32 offen offset:1024  lds
buffer_load_dwordx4 v10, s[8:11], s32 offen offset:2048  lds
buffer_load_dwordx4 v11, s[8:11], s32 offen offset:3072  lds
s_add_u32 m0, s66, 4096
s_add_u32 s32, s79, 73728
buffer_load_dwordx4 v8, s[8:11], s32 offen offset:0  lds
buffer_load_dwordx4 v9, s[8:11], s32 offen offset:1024  lds
buffer_load_dwordx4 v10, s[8:11], s32 offen offset:2048  lds
buffer_load_dwordx4 v11, s[8:11], s32 offen offset:3072  lds
s_add_u32 m0, s66, 8192
s_add_u32 s32, s79, 147456
buffer_load_dwordx4 v8, s[8:11], s32 offen offset:0  lds
buffer_load_dwordx4 v12, s[8:11], s32 offen offset:1024 lds
s_waitcnt vmcnt(26)
ds_read_b64_tr_b16 a[184:185], v20 offset:16384
ds_read_b64_tr_b16 a[186:187], v20 offset:18432
ds_read_b64_tr_b16 a[188:189], v21 offset:16384
ds_read_b64_tr_b16 a[190:191], v21 offset:18432
ds_read_b64_tr_b16 a[192:193], v22 offset:16384
ds_read_b64_tr_b16 a[194:195], v22 offset:18432
ds_read_b64_tr_b16 a[196:197], v23 offset:16384
ds_read_b64_tr_b16 a[198:199], v23 offset:18432
ds_read_b64_tr_b16 a[200:201], v20 offset:20480
ds_read_b64_tr_b16 a[202:203], v20 offset:22528
ds_read_b64_tr_b16 a[204:205], v21 offset:20480
ds_read_b64_tr_b16 a[206:207], v21 offset:22528
ds_read_b64_tr_b16 a[208:209], v22 offset:20480
ds_read_b64_tr_b16 a[210:211], v22 offset:22528
ds_read_b64_tr_b16 a[212:213], v23 offset:20480
ds_read_b64_tr_b16 a[214:215], v23 offset:22528
s_waitcnt lgkmcnt(0)
s_add_u32 s79, s63, s96
s_add_u32 m0, s66, 10240
s_add_u32 s32, s79, 0
buffer_load_dwordx4 v8, s[8:11], s32 offen offset:0  lds
buffer_load_dwordx4 v9, s[8:11], s32 offen offset:1024  lds
buffer_load_dwordx4 v10, s[8:11], s32 offen offset:2048  lds
buffer_load_dwordx4 v11, s[8:11], s32 offen offset:3072  lds
s_add_u32 m0, s66, 14336
s_add_u32 s32, s79, 73728
buffer_load_dwordx4 v8, s[8:11], s32 offen offset:0  lds
buffer_load_dwordx4 v9, s[8:11], s32 offen offset:1024  lds
buffer_load_dwordx4 v10, s[8:11], s32 offen offset:2048  lds
buffer_load_dwordx4 v11, s[8:11], s32 offen offset:3072  lds
s_add_u32 m0, s66, 18432
s_add_u32 s32, s79, 147456
buffer_load_dwordx4 v8, s[8:11], s32 offen offset:0  lds
buffer_load_dwordx4 v12, s[8:11], s32 offen offset:1024 lds
s_waitcnt vmcnt(28)
ds_read_b64_tr_b16 a[216:217], v20 offset:24576
ds_read_b64_tr_b16 a[218:219], v20 offset:26624
ds_read_b64_tr_b16 a[220:221], v21 offset:24576
ds_read_b64_tr_b16 a[222:223], v21 offset:26624
ds_read_b64_tr_b16 a[224:225], v22 offset:24576
ds_read_b64_tr_b16 a[226:227], v22 offset:26624
ds_read_b64_tr_b16 a[228:229], v23 offset:24576
ds_read_b64_tr_b16 a[230:231], v23 offset:26624
ds_read_b64_tr_b16 a[232:233], v20 offset:28672
ds_read_b64_tr_b16 a[234:235], v20 offset:30720
ds_read_b64_tr_b16 a[236:237], v21 offset:28672
ds_read_b64_tr_b16 a[238:239], v21 offset:30720
ds_read_b64_tr_b16 a[240:241], v22 offset:28672
ds_read_b64_tr_b16 a[242:243], v22 offset:30720
ds_read_b64_tr_b16 a[244:245], v23 offset:28672
ds_read_b64_tr_b16 a[246:247], v23 offset:30720
s_waitcnt lgkmcnt(0)
s_add_u32 s79, s62, s97
s_add_u32 m0, s66, 20480
s_add_u32 s32, s79, 0
buffer_load_dwordx4 v8, s[8:11], s32 offen offset:0  lds
buffer_load_dwordx4 v9, s[8:11], s32 offen offset:1024  lds
buffer_load_dwordx4 v10, s[8:11], s32 offen offset:2048  lds
buffer_load_dwordx4 v11, s[8:11], s32 offen offset:3072  lds
s_add_u32 m0, s66, 24576
s_add_u32 s32, s79, 73728
buffer_load_dwordx4 v8, s[8:11], s32 offen offset:0  lds
buffer_load_dwordx4 v9, s[8:11], s32 offen offset:1024  lds
buffer_load_dwordx4 v10, s[8:11], s32 offen offset:2048  lds
buffer_load_dwordx4 v11, s[8:11], s32 offen offset:3072  lds
s_add_u32 m0, s66, 28672
s_add_u32 s32, s79, 147456
buffer_load_dwordx4 v8, s[8:11], s32 offen offset:0  lds
buffer_load_dwordx4 v12, s[8:11], s32 offen offset:1024 lds
s_waitcnt vmcnt(30)
ds_read_b64_tr_b16 a[248:249], v20 offset:32768
ds_read_b64_tr_b16 a[250:251], v20 offset:34816
ds_read_b64_tr_b16 a[252:253], v21 offset:32768
ds_read_b64_tr_b16 a[254:255], v21 offset:34816
ds_read_b64_tr_b16 v[232:233], v22 offset:32768
ds_read_b64_tr_b16 v[234:235], v22 offset:34816
ds_read_b64_tr_b16 v[236:237], v23 offset:32768
ds_read_b64_tr_b16 v[238:239], v23 offset:34816
ds_read_b64_tr_b16 v[240:241], v20 offset:36864
ds_read_b64_tr_b16 v[242:243], v20 offset:38912
ds_read_b64_tr_b16 v[244:245], v21 offset:36864
ds_read_b64_tr_b16 v[246:247], v21 offset:38912
ds_read_b64_tr_b16 v[248:249], v22 offset:36864
ds_read_b64_tr_b16 v[250:251], v22 offset:38912
ds_read_b64_tr_b16 v[252:253], v23 offset:36864
ds_read_b64_tr_b16 v[254:255], v23 offset:38912
s_waitcnt lgkmcnt(0)
s_add_u32 s79, s63, s97
s_add_u32 m0, s66, 30720
s_add_u32 s32, s79, 0
buffer_load_dwordx4 v8, s[8:11], s32 offen offset:0  lds
buffer_load_dwordx4 v9, s[8:11], s32 offen offset:1024  lds
buffer_load_dwordx4 v10, s[8:11], s32 offen offset:2048  lds
buffer_load_dwordx4 v11, s[8:11], s32 offen offset:3072  lds
s_add_u32 m0, s66, 34816
s_add_u32 s32, s79, 73728
buffer_load_dwordx4 v8, s[8:11], s32 offen offset:0  lds
buffer_load_dwordx4 v9, s[8:11], s32 offen offset:1024  lds
buffer_load_dwordx4 v10, s[8:11], s32 offen offset:2048  lds
buffer_load_dwordx4 v11, s[8:11], s32 offen offset:3072  lds
s_add_u32 m0, s66, 38912
s_add_u32 s32, s79, 147456
buffer_load_dwordx4 v8, s[8:11], s32 offen offset:0  lds
buffer_load_dwordx4 v12, s[8:11], s32 offen offset:1024 lds
s_waitcnt vmcnt(30)
ds_read_b64 v[104:105], v24 offset:0
ds_read_b64 v[106:107], v25 offset:0
ds_read_b64 v[108:109], v24 offset:2048
ds_read_b64 v[110:111], v25 offset:2048
ds_read_b64 v[112:113], v24 offset:4096
ds_read_b64 v[114:115], v25 offset:4096
ds_read_b64 v[116:117], v24 offset:6144
ds_read_b64 v[118:119], v25 offset:6144
ds_read_b64 v[120:121], v24 offset:8192
ds_read_b64 v[122:123], v25 offset:8192
ds_read_b64 v[124:125], v26 offset:0
ds_read_b64 v[126:127], v27 offset:0
ds_read_b64 v[128:129], v26 offset:2048
ds_read_b64 v[130:131], v27 offset:2048
ds_read_b64 v[132:133], v26 offset:4096
ds_read_b64 v[134:135], v27 offset:4096
ds_read_b64 v[136:137], v26 offset:6144
ds_read_b64 v[138:139], v27 offset:6144
ds_read_b64 v[140:141], v26 offset:8192
ds_read_b64 v[142:143], v27 offset:8192
s_waitcnt lgkmcnt(0)
v_mfma_f32_16x16x32_bf16 v[32:35], a[120:123], v[104:107], 0
s_add_u32 s79, s62, s98
s_add_u32 m0, s66, 0
s_add_u32 s32, s79, 0
buffer_load_dwordx4 v8, s[8:11], s32 offen offset:0  lds
v_mfma_f32_16x16x32_bf16 v[36:39], a[124:127], v[104:107], 0
v_mfma_f32_16x16x32_bf16 a[40:43], a[128:131], v[104:107], 0
v_mfma_f32_16x16x32_bf16 a[44:47], a[132:135], v[104:107], 0
buffer_load_dwordx4 v9, s[8:11], s32 offen offset:1024  lds
v_mfma_f32_16x16x32_bf16 v[40:43], a[120:123], v[108:111], 0
v_mfma_f32_16x16x32_bf16 v[44:47], a[124:127], v[108:111], 0
v_mfma_f32_16x16x32_bf16 a[48:51], a[128:131], v[108:111], 0
v_mfma_f32_16x16x32_bf16 a[52:55], a[132:135], v[108:111], 0
buffer_load_dwordx4 v10, s[8:11], s32 offen offset:2048  lds
v_mfma_f32_16x16x32_bf16 v[48:51], a[120:123], v[112:115], 0
v_mfma_f32_16x16x32_bf16 v[52:55], a[124:127], v[112:115], 0
v_mfma_f32_16x16x32_bf16 a[56:59], a[128:131], v[112:115], 0
buffer_load_dwordx4 v11, s[8:11], s32 offen offset:3072  lds
v_mfma_f32_16x16x32_bf16 a[60:63], a[132:135], v[112:115], 0
s_waitcnt vmcnt(24)
v_mfma_f32_16x16x32_bf16 v[56:59], a[120:123], v[116:119], 0
ds_read_b64 v[144:145], v24 offset:10240
v_mfma_f32_16x16x32_bf16 v[60:63], a[124:127], v[116:119], 0
v_mfma_f32_16x16x32_bf16 a[64:67], a[128:131], v[116:119], 0
s_add_u32 m0, s66, 4096
s_add_u32 s32, s79, 73728
buffer_load_dwordx4 v8, s[8:11], s32 offen offset:0  lds
ds_read_b64 v[146:147], v25 offset:10240
v_mfma_f32_16x16x32_bf16 a[68:71], a[132:135], v[116:119], 0
ds_read_b64 v[148:149], v24 offset:12288
v_mfma_f32_16x16x32_bf16 v[64:67], a[120:123], v[120:123], 0
ds_read_b64 v[150:151], v25 offset:12288
v_mfma_f32_16x16x32_bf16 v[68:71], a[124:127], v[120:123], 0
ds_read_b64 v[152:153], v24 offset:14336
v_mfma_f32_16x16x32_bf16 a[72:75], a[128:131], v[120:123], 0
buffer_load_dwordx4 v9, s[8:11], s32 offen offset:1024  lds
ds_read_b64 v[154:155], v25 offset:14336
v_mfma_f32_16x16x32_bf16 a[76:79], a[132:135], v[120:123], 0
v_mfma_f32_16x16x32_bf16 v[32:35], a[136:139], v[124:127], v[32:35]
ds_read_b64 v[156:157], v24 offset:16384
v_mfma_f32_16x16x32_bf16 v[36:39], a[140:143], v[124:127], v[36:39]
buffer_load_dwordx4 v10, s[8:11], s32 offen offset:2048  lds
ds_read_b64 v[158:159], v25 offset:16384
v_mfma_f32_16x16x32_bf16 a[40:43], a[144:147], v[124:127], a[40:43]
ds_read_b64 v[160:161], v24 offset:18432
v_mfma_f32_16x16x32_bf16 a[44:47], a[148:151], v[124:127], a[44:47]
ds_read_b64 v[162:163], v25 offset:18432
v_mfma_f32_16x16x32_bf16 v[40:43], a[136:139], v[128:131], v[40:43]
ds_read_b64 v[164:165], v26 offset:10240
v_mfma_f32_16x16x32_bf16 v[44:47], a[140:143], v[128:131], v[44:47]
buffer_load_dwordx4 v11, s[8:11], s32 offen offset:3072  lds
ds_read_b64 v[166:167], v27 offset:10240
v_mfma_f32_16x16x32_bf16 a[48:51], a[144:147], v[128:131], a[48:51]
v_mfma_f32_16x16x32_bf16 a[52:55], a[148:151], v[128:131], a[52:55]
ds_read_b64 v[168:169], v26 offset:12288
v_mfma_f32_16x16x32_bf16 v[48:51], a[136:139], v[132:135], v[48:51]
ds_read_b64 v[170:171], v27 offset:12288
v_mfma_f32_16x16x32_bf16 v[52:55], a[140:143], v[132:135], v[52:55]
s_add_u32 m0, s66, 8192
s_add_u32 s32, s79, 147456
buffer_load_dwordx4 v8, s[8:11], s32 offen offset:0  lds
ds_read_b64 v[172:173], v26 offset:14336
v_mfma_f32_16x16x32_bf16 a[56:59], a[144:147], v[132:135], a[56:59]
ds_read_b64 v[174:175], v27 offset:14336
v_mfma_f32_16x16x32_bf16 a[60:63], a[148:151], v[132:135], a[60:63]
ds_read_b64 v[176:177], v26 offset:16384
v_mfma_f32_16x16x32_bf16 v[56:59], a[136:139], v[136:139], v[56:59]
buffer_load_dwordx4 v12, s[8:11], s32 offen offset:1024 lds
ds_read_b64 v[178:179], v27 offset:16384
v_mfma_f32_16x16x32_bf16 v[60:63], a[140:143], v[136:139], v[60:63]
v_mfma_f32_16x16x32_bf16 a[64:67], a[144:147], v[136:139], a[64:67]
ds_read_b64 v[180:181], v26 offset:18432
v_mfma_f32_16x16x32_bf16 a[68:71], a[148:151], v[136:139], a[68:71]
ds_read_b64 v[182:183], v27 offset:18432
v_mfma_f32_16x16x32_bf16 v[64:67], a[136:139], v[140:143], v[64:67]
v_mfma_f32_16x16x32_bf16 v[68:71], a[140:143], v[140:143], v[68:71]
v_mfma_f32_16x16x32_bf16 a[72:75], a[144:147], v[140:143], a[72:75]
v_mfma_f32_16x16x32_bf16 a[76:79], a[148:151], v[140:143], a[76:79]
s_waitcnt lgkmcnt(0)
v_mfma_f32_16x16x32_bf16 a[0:3], a[120:123], v[144:147], 0
s_add_u32 s79, s63, s98
s_add_u32 m0, s66, 10240
s_add_u32 s32, s79, 0
buffer_load_dwordx4 v8, s[8:11], s32 offen offset:0  lds
v_mfma_f32_16x16x32_bf16 a[4:7], a[124:127], v[144:147], 0
v_mfma_f32_16x16x32_bf16 a[80:83], a[128:131], v[144:147], 0
v_mfma_f32_16x16x32_bf16 a[84:87], a[132:135], v[144:147], 0
buffer_load_dwordx4 v9, s[8:11], s32 offen offset:1024  lds
v_mfma_f32_16x16x32_bf16 a[8:11], a[120:123], v[148:151], 0
v_mfma_f32_16x16x32_bf16 a[12:15], a[124:127], v[148:151], 0
v_mfma_f32_16x16x32_bf16 a[88:91], a[128:131], v[148:151], 0
v_mfma_f32_16x16x32_bf16 a[92:95], a[132:135], v[148:151], 0
buffer_load_dwordx4 v10, s[8:11], s32 offen offset:2048  lds
v_mfma_f32_16x16x32_bf16 a[16:19], a[120:123], v[152:155], 0
v_mfma_f32_16x16x32_bf16 a[20:23], a[124:127], v[152:155], 0
v_mfma_f32_16x16x32_bf16 a[96:99], a[128:131], v[152:155], 0
buffer_load_dwordx4 v11, s[8:11], s32 offen offset:3072  lds
v_mfma_f32_16x16x32_bf16 a[100:103], a[132:135], v[152:155], 0
s_waitcnt vmcnt(24)
v_mfma_f32_16x16x32_bf16 a[24:27], a[120:123], v[156:159], 0
ds_read_b64 v[104:105], v24 offset:20480
v_mfma_f32_16x16x32_bf16 a[28:31], a[124:127], v[156:159], 0
v_mfma_f32_16x16x32_bf16 a[104:107], a[128:131], v[156:159], 0
s_add_u32 m0, s66, 14336
s_add_u32 s32, s79, 73728
buffer_load_dwordx4 v8, s[8:11], s32 offen offset:0  lds
ds_read_b64 v[106:107], v25 offset:20480
v_mfma_f32_16x16x32_bf16 a[108:111], a[132:135], v[156:159], 0
ds_read_b64 v[108:109], v24 offset:22528
v_mfma_f32_16x16x32_bf16 a[32:35], a[120:123], v[160:163], 0
ds_read_b64 v[110:111], v25 offset:22528
v_mfma_f32_16x16x32_bf16 a[36:39], a[124:127], v[160:163], 0
ds_read_b64 v[112:113], v24 offset:24576
v_mfma_f32_16x16x32_bf16 a[112:115], a[128:131], v[160:163], 0
buffer_load_dwordx4 v9, s[8:11], s32 offen offset:1024  lds
ds_read_b64 v[114:115], v25 offset:24576
v_mfma_f32_16x16x32_bf16 a[116:119], a[132:135], v[160:163], 0
v_mfma_f32_16x16x32_bf16 a[0:3], a[136:139], v[164:167], a[0:3]
ds_read_b64 v[116:117], v24 offset:26624
v_mfma_f32_16x16x32_bf16 a[4:7], a[140:143], v[164:167], a[4:7]
buffer_load_dwordx4 v10, s[8:11], s32 offen offset:2048  lds
ds_read_b64 v[118:119], v25 offset:26624
v_mfma_f32_16x16x32_bf16 a[80:83], a[144:147], v[164:167], a[80:83]
ds_read_b64 v[120:121], v24 offset:28672
v_mfma_f32_16x16x32_bf16 a[84:87], a[148:151], v[164:167], a[84:87]
ds_read_b64 v[122:123], v25 offset:28672
v_mfma_f32_16x16x32_bf16 a[8:11], a[136:139], v[168:171], a[8:11]
ds_read_b64 v[124:125], v26 offset:20480
v_mfma_f32_16x16x32_bf16 a[12:15], a[140:143], v[168:171], a[12:15]
buffer_load_dwordx4 v11, s[8:11], s32 offen offset:3072  lds
ds_read_b64 v[126:127], v27 offset:20480
v_mfma_f32_16x16x32_bf16 a[88:91], a[144:147], v[168:171], a[88:91]
v_mfma_f32_16x16x32_bf16 a[92:95], a[148:151], v[168:171], a[92:95]
ds_read_b64 v[128:129], v26 offset:22528
v_mfma_f32_16x16x32_bf16 a[16:19], a[136:139], v[172:175], a[16:19]
ds_read_b64 v[130:131], v27 offset:22528
v_mfma_f32_16x16x32_bf16 a[20:23], a[140:143], v[172:175], a[20:23]
s_add_u32 m0, s66, 18432
s_add_u32 s32, s79, 147456
buffer_load_dwordx4 v8, s[8:11], s32 offen offset:0  lds
ds_read_b64 v[132:133], v26 offset:24576
v_mfma_f32_16x16x32_bf16 a[96:99], a[144:147], v[172:175], a[96:99]
ds_read_b64 v[134:135], v27 offset:24576
v_mfma_f32_16x16x32_bf16 a[100:103], a[148:151], v[172:175], a[100:103]
ds_read_b64 v[136:137], v26 offset:26624
v_mfma_f32_16x16x32_bf16 a[24:27], a[136:139], v[176:179], a[24:27]
buffer_load_dwordx4 v12, s[8:11], s32 offen offset:1024 lds
ds_read_b64 v[138:139], v27 offset:26624
v_mfma_f32_16x16x32_bf16 a[28:31], a[140:143], v[176:179], a[28:31]
v_mfma_f32_16x16x32_bf16 a[104:107], a[144:147], v[176:179], a[104:107]
ds_read_b64 v[140:141], v26 offset:28672
v_mfma_f32_16x16x32_bf16 a[108:111], a[148:151], v[176:179], a[108:111]
ds_read_b64 v[142:143], v27 offset:28672
v_mfma_f32_16x16x32_bf16 a[32:35], a[136:139], v[180:183], a[32:35]
v_mfma_f32_16x16x32_bf16 a[36:39], a[140:143], v[180:183], a[36:39]
v_mfma_f32_16x16x32_bf16 a[112:115], a[144:147], v[180:183], a[112:115]
v_mfma_f32_16x16x32_bf16 a[116:119], a[148:151], v[180:183], a[116:119]
s_waitcnt lgkmcnt(0)
v_mfma_f32_16x16x32_bf16 v[32:35], a[152:155], v[104:107], v[32:35]
s_add_u32 s79, s62, s99
s_add_u32 m0, s66, 20480
s_add_u32 s32, s79, 0
buffer_load_dwordx4 v8, s[8:11], s32 offen offset:0  lds
v_mfma_f32_16x16x32_bf16 v[36:39], a[156:159], v[104:107], v[36:39]
v_mfma_f32_16x16x32_bf16 a[40:43], a[160:163], v[104:107], a[40:43]
v_mfma_f32_16x16x32_bf16 a[44:47], a[164:167], v[104:107], a[44:47]
buffer_load_dwordx4 v9, s[8:11], s32 offen offset:1024  lds
v_mfma_f32_16x16x32_bf16 v[40:43], a[152:155], v[108:111], v[40:43]
v_mfma_f32_16x16x32_bf16 v[44:47], a[156:159], v[108:111], v[44:47]
v_mfma_f32_16x16x32_bf16 a[48:51], a[160:163], v[108:111], a[48:51]
v_mfma_f32_16x16x32_bf16 a[52:55], a[164:167], v[108:111], a[52:55]
buffer_load_dwordx4 v10, s[8:11], s32 offen offset:2048  lds
v_mfma_f32_16x16x32_bf16 v[48:51], a[152:155], v[112:115], v[48:51]
v_mfma_f32_16x16x32_bf16 v[52:55], a[156:159], v[112:115], v[52:55]
v_mfma_f32_16x16x32_bf16 a[56:59], a[160:163], v[112:115], a[56:59]
buffer_load_dwordx4 v11, s[8:11], s32 offen offset:3072  lds
v_mfma_f32_16x16x32_bf16 a[60:63], a[164:167], v[112:115], a[60:63]
s_waitcnt vmcnt(24)
v_mfma_f32_16x16x32_bf16 v[56:59], a[152:155], v[116:119], v[56:59]
ds_read_b64 v[144:145], v24 offset:30720
v_mfma_f32_16x16x32_bf16 v[60:63], a[156:159], v[116:119], v[60:63]
v_mfma_f32_16x16x32_bf16 a[64:67], a[160:163], v[116:119], a[64:67]
s_add_u32 m0, s66, 24576
s_add_u32 s32, s79, 73728
buffer_load_dwordx4 v8, s[8:11], s32 offen offset:0  lds
ds_read_b64 v[146:147], v25 offset:30720
v_mfma_f32_16x16x32_bf16 a[68:71], a[164:167], v[116:119], a[68:71]
ds_read_b64 v[148:149], v24 offset:32768
v_mfma_f32_16x16x32_bf16 v[64:67], a[152:155], v[120:123], v[64:67]
ds_read_b64 v[150:151], v25 offset:32768
v_mfma_f32_16x16x32_bf16 v[68:71], a[156:159], v[120:123], v[68:71]
ds_read_b64 v[152:153], v24 offset:34816
v_mfma_f32_16x16x32_bf16 a[72:75], a[160:163], v[120:123], a[72:75]
buffer_load_dwordx4 v9, s[8:11], s32 offen offset:1024  lds
ds_read_b64 v[154:155], v25 offset:34816
v_mfma_f32_16x16x32_bf16 a[76:79], a[164:167], v[120:123], a[76:79]
v_mfma_f32_16x16x32_bf16 v[32:35], a[168:171], v[124:127], v[32:35]
ds_read_b64 v[156:157], v24 offset:36864
v_mfma_f32_16x16x32_bf16 v[36:39], a[172:175], v[124:127], v[36:39]
buffer_load_dwordx4 v10, s[8:11], s32 offen offset:2048  lds
ds_read_b64 v[158:159], v25 offset:36864
v_mfma_f32_16x16x32_bf16 a[40:43], a[176:179], v[124:127], a[40:43]
ds_read_b64 v[160:161], v24 offset:38912
v_mfma_f32_16x16x32_bf16 a[44:47], a[180:183], v[124:127], a[44:47]
ds_read_b64 v[162:163], v25 offset:38912
v_mfma_f32_16x16x32_bf16 v[40:43], a[168:171], v[128:131], v[40:43]
ds_read_b64 v[164:165], v26 offset:30720
v_mfma_f32_16x16x32_bf16 v[44:47], a[172:175], v[128:131], v[44:47]
buffer_load_dwordx4 v11, s[8:11], s32 offen offset:3072  lds
ds_read_b64 v[166:167], v27 offset:30720
v_mfma_f32_16x16x32_bf16 a[48:51], a[176:179], v[128:131], a[48:51]
v_mfma_f32_16x16x32_bf16 a[52:55], a[180:183], v[128:131], a[52:55]
ds_read_b64 v[168:169], v26 offset:32768
v_mfma_f32_16x16x32_bf16 v[48:51], a[168:171], v[132:135], v[48:51]
ds_read_b64 v[170:171], v27 offset:32768
v_mfma_f32_16x16x32_bf16 v[52:55], a[172:175], v[132:135], v[52:55]
s_add_u32 m0, s66, 28672
s_add_u32 s32, s79, 147456
buffer_load_dwordx4 v8, s[8:11], s32 offen offset:0  lds
ds_read_b64 v[172:173], v26 offset:34816
v_mfma_f32_16x16x32_bf16 a[56:59], a[176:179], v[132:135], a[56:59]
ds_read_b64 v[174:175], v27 offset:34816
v_mfma_f32_16x16x32_bf16 a[60:63], a[180:183], v[132:135], a[60:63]
ds_read_b64 v[176:177], v26 offset:36864
v_mfma_f32_16x16x32_bf16 v[56:59], a[168:171], v[136:139], v[56:59]
buffer_load_dwordx4 v12, s[8:11], s32 offen offset:1024 lds
ds_read_b64 v[178:179], v27 offset:36864
v_mfma_f32_16x16x32_bf16 v[60:63], a[172:175], v[136:139], v[60:63]
v_mfma_f32_16x16x32_bf16 a[64:67], a[176:179], v[136:139], a[64:67]
ds_read_b64 v[180:181], v26 offset:38912
v_mfma_f32_16x16x32_bf16 a[68:71], a[180:183], v[136:139], a[68:71]
ds_read_b64 v[182:183], v27 offset:38912
v_mfma_f32_16x16x32_bf16 v[64:67], a[168:171], v[140:143], v[64:67]
v_mfma_f32_16x16x32_bf16 v[68:71], a[172:175], v[140:143], v[68:71]
v_mfma_f32_16x16x32_bf16 a[72:75], a[176:179], v[140:143], a[72:75]
v_mfma_f32_16x16x32_bf16 a[76:79], a[180:183], v[140:143], a[76:79]
s_waitcnt lgkmcnt(0)
v_mfma_f32_16x16x32_bf16 a[0:3], a[152:155], v[144:147], a[0:3]
s_add_u32 s79, s63, s99
s_add_u32 m0, s66, 30720
s_add_u32 s32, s79, 0
buffer_load_dwordx4 v8, s[8:11], s32 offen offset:0  lds
v_mfma_f32_16x16x32_bf16 a[4:7], a[156:159], v[144:147], a[4:7]
v_mfma_f32_16x16x32_bf16 a[80:83], a[160:163], v[144:147], a[80:83]
v_mfma_f32_16x16x32_bf16 a[84:87], a[164:167], v[144:147], a[84:87]
buffer_load_dwordx4 v9, s[8:11], s32 offen offset:1024  lds
v_mfma_f32_16x16x32_bf16 a[8:11], a[152:155], v[148:151], a[8:11]
v_mfma_f32_16x16x32_bf16 a[12:15], a[156:159], v[148:151], a[12:15]
v_mfma_f32_16x16x32_bf16 a[88:91], a[160:163], v[148:151], a[88:91]
v_mfma_f32_16x16x32_bf16 a[92:95], a[164:167], v[148:151], a[92:95]
buffer_load_dwordx4 v10, s[8:11], s32 offen offset:2048  lds
v_mfma_f32_16x16x32_bf16 a[16:19], a[152:155], v[152:155], a[16:19]
v_mfma_f32_16x16x32_bf16 a[20:23], a[156:159], v[152:155], a[20:23]
v_mfma_f32_16x16x32_bf16 a[96:99], a[160:163], v[152:155], a[96:99]
buffer_load_dwordx4 v11, s[8:11], s32 offen offset:3072  lds
v_mfma_f32_16x16x32_bf16 a[100:103], a[164:167], v[152:155], a[100:103]
s_waitcnt vmcnt(24)
v_mfma_f32_16x16x32_bf16 a[24:27], a[152:155], v[156:159], a[24:27]
ds_read_b64 v[104:105], v24 offset:0
v_mfma_f32_16x16x32_bf16 a[28:31], a[156:159], v[156:159], a[28:31]
v_mfma_f32_16x16x32_bf16 a[104:107], a[160:163], v[156:159], a[104:107]
s_add_u32 m0, s66, 34816
s_add_u32 s32, s79, 73728
buffer_load_dwordx4 v8, s[8:11], s32 offen offset:0  lds
ds_read_b64 v[106:107], v25 offset:0
v_mfma_f32_16x16x32_bf16 a[108:111], a[164:167], v[156:159], a[108:111]
ds_read_b64 v[108:109], v24 offset:2048
v_mfma_f32_16x16x32_bf16 a[32:35], a[152:155], v[160:163], a[32:35]
ds_read_b64 v[110:111], v25 offset:2048
v_mfma_f32_16x16x32_bf16 a[36:39], a[156:159], v[160:163], a[36:39]
ds_read_b64 v[112:113], v24 offset:4096
v_mfma_f32_16x16x32_bf16 a[112:115], a[160:163], v[160:163], a[112:115]
buffer_load_dwordx4 v9, s[8:11], s32 offen offset:1024  lds
ds_read_b64 v[114:115], v25 offset:4096
v_mfma_f32_16x16x32_bf16 a[116:119], a[164:167], v[160:163], a[116:119]
v_mfma_f32_16x16x32_bf16 a[0:3], a[168:171], v[164:167], a[0:3]
ds_read_b64 v[116:117], v24 offset:6144
v_mfma_f32_16x16x32_bf16 a[4:7], a[172:175], v[164:167], a[4:7]
buffer_load_dwordx4 v10, s[8:11], s32 offen offset:2048  lds
ds_read_b64 v[118:119], v25 offset:6144
v_mfma_f32_16x16x32_bf16 a[80:83], a[176:179], v[164:167], a[80:83]
ds_read_b64 v[120:121], v24 offset:8192
v_mfma_f32_16x16x32_bf16 a[84:87], a[180:183], v[164:167], a[84:87]
ds_read_b64 v[122:123], v25 offset:8192
v_mfma_f32_16x16x32_bf16 a[8:11], a[168:171], v[168:171], a[8:11]
ds_read_b64 v[124:125], v26 offset:0
v_mfma_f32_16x16x32_bf16 a[12:15], a[172:175], v[168:171], a[12:15]
buffer_load_dwordx4 v11, s[8:11], s32 offen offset:3072  lds
ds_read_b64 v[126:127], v27 offset:0
v_mfma_f32_16x16x32_bf16 a[88:91], a[176:179], v[168:171], a[88:91]
v_mfma_f32_16x16x32_bf16 a[92:95], a[180:183], v[168:171], a[92:95]
ds_read_b64 v[128:129], v26 offset:2048
v_mfma_f32_16x16x32_bf16 a[16:19], a[168:171], v[172:175], a[16:19]
ds_read_b64 v[130:131], v27 offset:2048
v_mfma_f32_16x16x32_bf16 a[20:23], a[172:175], v[172:175], a[20:23]
s_add_u32 m0, s66, 38912
s_add_u32 s32, s79, 147456
buffer_load_dwordx4 v8, s[8:11], s32 offen offset:0  lds
ds_read_b64 v[132:133], v26 offset:4096
v_mfma_f32_16x16x32_bf16 a[96:99], a[176:179], v[172:175], a[96:99]
ds_read_b64 v[134:135], v27 offset:4096
v_mfma_f32_16x16x32_bf16 a[100:103], a[180:183], v[172:175], a[100:103]
ds_read_b64 v[136:137], v26 offset:6144
v_mfma_f32_16x16x32_bf16 a[24:27], a[168:171], v[176:179], a[24:27]
buffer_load_dwordx4 v12, s[8:11], s32 offen offset:1024 lds
ds_read_b64 v[138:139], v27 offset:6144
v_mfma_f32_16x16x32_bf16 a[28:31], a[172:175], v[176:179], a[28:31]
v_mfma_f32_16x16x32_bf16 a[104:107], a[176:179], v[176:179], a[104:107]
ds_read_b64 v[140:141], v26 offset:8192
v_mfma_f32_16x16x32_bf16 a[108:111], a[180:183], v[176:179], a[108:111]
ds_read_b64 v[142:143], v27 offset:8192
v_mfma_f32_16x16x32_bf16 a[32:35], a[168:171], v[180:183], a[32:35]
v_mfma_f32_16x16x32_bf16 a[36:39], a[172:175], v[180:183], a[36:39]
v_mfma_f32_16x16x32_bf16 a[112:115], a[176:179], v[180:183], a[112:115]
v_mfma_f32_16x16x32_bf16 a[116:119], a[180:183], v[180:183], a[116:119]
s_waitcnt lgkmcnt(0)
v_mfma_f32_16x16x32_bf16 v[32:35], a[184:187], v[104:107], v[32:35]
s_add_u32 m0, s66, 0
s_add_u32 s32, s64, 0
buffer_load_dwordx4 v8, s[8:11], s32 offen offset:0  lds
v_mfma_f32_16x16x32_bf16 v[36:39], a[188:191], v[104:107], v[36:39]
v_mfma_f32_16x16x32_bf16 a[40:43], a[192:195], v[104:107], a[40:43]
v_mfma_f32_16x16x32_bf16 a[44:47], a[196:199], v[104:107], a[44:47]
buffer_load_dwordx4 v9, s[8:11], s32 offen offset:1024  lds
v_mfma_f32_16x16x32_bf16 v[40:43], a[184:187], v[108:111], v[40:43]
v_mfma_f32_16x16x32_bf16 v[44:47], a[188:191], v[108:111], v[44:47]
v_mfma_f32_16x16x32_bf16 a[48:51], a[192:195], v[108:111], a[48:51]
v_mfma_f32_16x16x32_bf16 a[52:55], a[196:199], v[108:111], a[52:55]
buffer_load_dwordx4 v10, s[8:11], s32 offen offset:2048  lds
v_mfma_f32_16x16x32_bf16 v[48:51], a[184:187], v[112:115], v[48:51]
v_mfma_f32_16x16x32_bf16 v[52:55], a[188:191], v[112:115], v[52:55]
v_mfma_f32_16x16x32_bf16 a[56:59], a[192:195], v[112:115], a[56:59]
buffer_load_dwordx4 v11, s[8:11], s32 offen offset:3072  lds
v_mfma_f32_16x16x32_bf16 a[60:63], a[196:199], v[112:115], a[60:63]
s_waitcnt vmcnt(24)
v_mfma_f32_16x16x32_bf16 v[56:59], a[184:187], v[116:119], v[56:59]
ds_read_b64 v[144:145], v24 offset:10240
v_mfma_f32_16x16x32_bf16 v[60:63], a[188:191], v[116:119], v[60:63]
v_mfma_f32_16x16x32_bf16 a[64:67], a[192:195], v[116:119], a[64:67]
s_add_u32 m0, s66, 4096
s_add_u32 s32, s64, 73728
buffer_load_dwordx4 v8, s[8:11], s32 offen offset:0  lds
ds_read_b64 v[146:147], v25 offset:10240
v_mfma_f32_16x16x32_bf16 a[68:71], a[196:199], v[116:119], a[68:71]
ds_read_b64 v[148:149], v24 offset:12288
v_mfma_f32_16x16x32_bf16 v[64:67], a[184:187], v[120:123], v[64:67]
ds_read_b64 v[150:151], v25 offset:12288
v_mfma_f32_16x16x32_bf16 v[68:71], a[188:191], v[120:123], v[68:71]
ds_read_b64 v[152:153], v24 offset:14336
v_mfma_f32_16x16x32_bf16 a[72:75], a[192:195], v[120:123], a[72:75]
buffer_load_dwordx4 v9, s[8:11], s32 offen offset:1024  lds
ds_read_b64 v[154:155], v25 offset:14336
v_mfma_f32_16x16x32_bf16 a[76:79], a[196:199], v[120:123], a[76:79]
v_mfma_f32_16x16x32_bf16 v[32:35], a[200:203], v[124:127], v[32:35]
ds_read_b64 v[156:157], v24 offset:16384
v_mfma_f32_16x16x32_bf16 v[36:39], a[204:207], v[124:127], v[36:39]
buffer_load_dwordx4 v10, s[8:11], s32 offen offset:2048  lds
ds_read_b64 v[158:159], v25 offset:16384
v_mfma_f32_16x16x32_bf16 a[40:43], a[208:211], v[124:127], a[40:43]
ds_read_b64 v[160:161], v24 offset:18432
v_mfma_f32_16x16x32_bf16 a[44:47], a[212:215], v[124:127], a[44:47]
ds_read_b64 v[162:163], v25 offset:18432
v_mfma_f32_16x16x32_bf16 v[40:43], a[200:203], v[128:131], v[40:43]
ds_read_b64 v[164:165], v26 offset:10240
v_mfma_f32_16x16x32_bf16 v[44:47], a[204:207], v[128:131], v[44:47]
buffer_load_dwordx4 v11, s[8:11], s32 offen offset:3072  lds
ds_read_b64 v[166:167], v27 offset:10240
v_mfma_f32_16x16x32_bf16 a[48:51], a[208:211], v[128:131], a[48:51]
v_mfma_f32_16x16x32_bf16 a[52:55], a[212:215], v[128:131], a[52:55]
ds_read_b64 v[168:169], v26 offset:12288
v_mfma_f32_16x16x32_bf16 v[48:51], a[200:203], v[132:135], v[48:51]
ds_read_b64 v[170:171], v27 offset:12288
v_mfma_f32_16x16x32_bf16 v[52:55], a[204:207], v[132:135], v[52:55]
s_add_u32 m0, s66, 8192
s_add_u32 s32, s64, 147456
buffer_load_dwordx4 v8, s[8:11], s32 offen offset:0  lds
ds_read_b64 v[172:173], v26 offset:14336
v_mfma_f32_16x16x32_bf16 a[56:59], a[208:211], v[132:135], a[56:59]
ds_read_b64 v[174:175], v27 offset:14336
v_mfma_f32_16x16x32_bf16 a[60:63], a[212:215], v[132:135], a[60:63]
ds_read_b64 v[176:177], v26 offset:16384
v_mfma_f32_16x16x32_bf16 v[56:59], a[200:203], v[136:139], v[56:59]
buffer_load_dwordx4 v12, s[8:11], s32 offen offset:1024 lds
ds_read_b64 v[178:179], v27 offset:16384
v_mfma_f32_16x16x32_bf16 v[60:63], a[204:207], v[136:139], v[60:63]
v_mfma_f32_16x16x32_bf16 a[64:67], a[208:211], v[136:139], a[64:67]
ds_read_b64 v[180:181], v26 offset:18432
v_mfma_f32_16x16x32_bf16 a[68:71], a[212:215], v[136:139], a[68:71]
ds_read_b64 v[182:183], v27 offset:18432
v_mfma_f32_16x16x32_bf16 v[64:67], a[200:203], v[140:143], v[64:67]
v_mfma_f32_16x16x32_bf16 v[68:71], a[204:207], v[140:143], v[68:71]
v_mfma_f32_16x16x32_bf16 a[72:75], a[208:211], v[140:143], a[72:75]
v_mfma_f32_16x16x32_bf16 a[76:79], a[212:215], v[140:143], a[76:79]
s_waitcnt lgkmcnt(0)
v_mfma_f32_16x16x32_bf16 a[0:3], a[184:187], v[144:147], a[0:3]
v_mfma_f32_16x16x32_bf16 a[4:7], a[188:191], v[144:147], a[4:7]
v_mfma_f32_16x16x32_bf16 a[80:83], a[192:195], v[144:147], a[80:83]
v_mfma_f32_16x16x32_bf16 a[84:87], a[196:199], v[144:147], a[84:87]
v_mfma_f32_16x16x32_bf16 a[8:11], a[184:187], v[148:151], a[8:11]
v_mfma_f32_16x16x32_bf16 a[12:15], a[188:191], v[148:151], a[12:15]
v_mfma_f32_16x16x32_bf16 a[88:91], a[192:195], v[148:151], a[88:91]
v_mfma_f32_16x16x32_bf16 a[92:95], a[196:199], v[148:151], a[92:95]
v_mfma_f32_16x16x32_bf16 a[16:19], a[184:187], v[152:155], a[16:19]
v_mfma_f32_16x16x32_bf16 a[20:23], a[188:191], v[152:155], a[20:23]
v_mfma_f32_16x16x32_bf16 a[96:99], a[192:195], v[152:155], a[96:99]
v_mfma_f32_16x16x32_bf16 a[100:103], a[196:199], v[152:155], a[100:103]
s_waitcnt vmcnt(20)
v_mfma_f32_16x16x32_bf16 a[24:27], a[184:187], v[156:159], a[24:27]
ds_read_b64 v[104:105], v24 offset:20480
v_mfma_f32_16x16x32_bf16 a[28:31], a[188:191], v[156:159], a[28:31]
v_mfma_f32_16x16x32_bf16 a[104:107], a[192:195], v[156:159], a[104:107]
ds_read_b64 v[106:107], v25 offset:20480
v_mfma_f32_16x16x32_bf16 a[108:111], a[196:199], v[156:159], a[108:111]
ds_read_b64 v[108:109], v24 offset:22528
v_mfma_f32_16x16x32_bf16 a[32:35], a[184:187], v[160:163], a[32:35]
ds_read_b64 v[110:111], v25 offset:22528
v_mfma_f32_16x16x32_bf16 a[36:39], a[188:191], v[160:163], a[36:39]
ds_read_b64 v[112:113], v24 offset:24576
v_mfma_f32_16x16x32_bf16 a[112:115], a[192:195], v[160:163], a[112:115]
ds_read_b64 v[114:115], v25 offset:24576
v_mfma_f32_16x16x32_bf16 a[116:119], a[196:199], v[160:163], a[116:119]
v_mfma_f32_16x16x32_bf16 a[0:3], a[200:203], v[164:167], a[0:3]
ds_read_b64 v[116:117], v24 offset:26624
v_mfma_f32_16x16x32_bf16 a[4:7], a[204:207], v[164:167], a[4:7]
ds_read_b64 v[118:119], v25 offset:26624
v_mfma_f32_16x16x32_bf16 a[80:83], a[208:211], v[164:167], a[80:83]
ds_read_b64 v[120:121], v24 offset:28672
v_mfma_f32_16x16x32_bf16 a[84:87], a[212:215], v[164:167], a[84:87]
ds_read_b64 v[122:123], v25 offset:28672
v_mfma_f32_16x16x32_bf16 a[8:11], a[200:203], v[168:171], a[8:11]
ds_read_b64 v[124:125], v26 offset:20480
v_mfma_f32_16x16x32_bf16 a[12:15], a[204:207], v[168:171], a[12:15]
ds_read_b64 v[126:127], v27 offset:20480
v_mfma_f32_16x16x32_bf16 a[88:91], a[208:211], v[168:171], a[88:91]
v_mfma_f32_16x16x32_bf16 a[92:95], a[212:215], v[168:171], a[92:95]
ds_read_b64 v[128:129], v26 offset:22528
v_mfma_f32_16x16x32_bf16 a[16:19], a[200:203], v[172:175], a[16:19]
ds_read_b64 v[130:131], v27 offset:22528
v_mfma_f32_16x16x32_bf16 a[20:23], a[204:207], v[172:175], a[20:23]
ds_read_b64 v[132:133], v26 offset:24576
v_mfma_f32_16x16x32_bf16 a[96:99], a[208:211], v[172:175], a[96:99]
ds_read_b64 v[134:135], v27 offset:24576
v_mfma_f32_16x16x32_bf16 a[100:103], a[212:215], v[172:175], a[100:103]
ds_read_b64 v[136:137], v26 offset:26624
v_mfma_f32_16x16x32_bf16 a[24:27], a[200:203], v[176:179], a[24:27]
ds_read_b64 v[138:139], v27 offset:26624
v_mfma_f32_16x16x32_bf16 a[28:31], a[204:207], v[176:179], a[28:31]
v_mfma_f32_16x16x32_bf16 a[104:107], a[208:211], v[176:179], a[104:107]
ds_read_b64 v[140:141], v26 offset:28672
v_mfma_f32_16x16x32_bf16 a[108:111], a[212:215], v[176:179], a[108:111]
ds_read_b64 v[142:143], v27 offset:28672
v_mfma_f32_16x16x32_bf16 a[32:35], a[200:203], v[180:183], a[32:35]
v_mfma_f32_16x16x32_bf16 a[36:39], a[204:207], v[180:183], a[36:39]
v_mfma_f32_16x16x32_bf16 a[112:115], a[208:211], v[180:183], a[112:115]
v_mfma_f32_16x16x32_bf16 a[116:119], a[212:215], v[180:183], a[116:119]
s_waitcnt lgkmcnt(0)
v_mfma_f32_16x16x32_bf16 v[32:35], a[216:219], v[104:107], v[32:35]
v_mfma_f32_16x16x32_bf16 v[36:39], a[220:223], v[104:107], v[36:39]
v_mfma_f32_16x16x32_bf16 a[40:43], a[224:227], v[104:107], a[40:43]
v_mfma_f32_16x16x32_bf16 a[44:47], a[228:231], v[104:107], a[44:47]
v_mfma_f32_16x16x32_bf16 v[40:43], a[216:219], v[108:111], v[40:43]
v_mfma_f32_16x16x32_bf16 v[44:47], a[220:223], v[108:111], v[44:47]
v_mfma_f32_16x16x32_bf16 a[48:51], a[224:227], v[108:111], a[48:51]
v_mfma_f32_16x16x32_bf16 a[52:55], a[228:231], v[108:111], a[52:55]
v_mfma_f32_16x16x32_bf16 v[48:51], a[216:219], v[112:115], v[48:51]
v_mfma_f32_16x16x32_bf16 v[52:55], a[220:223], v[112:115], v[52:55]
v_mfma_f32_16x16x32_bf16 a[56:59], a[224:227], v[112:115], a[56:59]
v_mfma_f32_16x16x32_bf16 a[60:63], a[228:231], v[112:115], a[60:63]
s_waitcnt vmcnt(10)
v_mfma_f32_16x16x32_bf16 v[56:59], a[216:219], v[116:119], v[56:59]
ds_read_b64 v[144:145], v24 offset:30720
v_mfma_f32_16x16x32_bf16 v[60:63], a[220:223], v[116:119], v[60:63]
v_mfma_f32_16x16x32_bf16 a[64:67], a[224:227], v[116:119], a[64:67]
ds_read_b64 v[146:147], v25 offset:30720
v_mfma_f32_16x16x32_bf16 a[68:71], a[228:231], v[116:119], a[68:71]
ds_read_b64 v[148:149], v24 offset:32768
v_mfma_f32_16x16x32_bf16 v[64:67], a[216:219], v[120:123], v[64:67]
ds_read_b64 v[150:151], v25 offset:32768
v_mfma_f32_16x16x32_bf16 v[68:71], a[220:223], v[120:123], v[68:71]
ds_read_b64 v[152:153], v24 offset:34816
v_mfma_f32_16x16x32_bf16 a[72:75], a[224:227], v[120:123], a[72:75]
ds_read_b64 v[154:155], v25 offset:34816
v_mfma_f32_16x16x32_bf16 a[76:79], a[228:231], v[120:123], a[76:79]
v_mfma_f32_16x16x32_bf16 v[32:35], a[232:235], v[124:127], v[32:35]
ds_read_b64 v[156:157], v24 offset:36864
v_mfma_f32_16x16x32_bf16 v[36:39], a[236:239], v[124:127], v[36:39]
ds_read_b64 v[158:159], v25 offset:36864
v_mfma_f32_16x16x32_bf16 a[40:43], a[240:243], v[124:127], a[40:43]
ds_read_b64 v[160:161], v24 offset:38912
v_mfma_f32_16x16x32_bf16 a[44:47], a[244:247], v[124:127], a[44:47]
ds_read_b64 v[162:163], v25 offset:38912
v_mfma_f32_16x16x32_bf16 v[40:43], a[232:235], v[128:131], v[40:43]
ds_read_b64 v[164:165], v26 offset:30720
v_mfma_f32_16x16x32_bf16 v[44:47], a[236:239], v[128:131], v[44:47]
ds_read_b64 v[166:167], v27 offset:30720
v_mfma_f32_16x16x32_bf16 a[48:51], a[240:243], v[128:131], a[48:51]
v_mfma_f32_16x16x32_bf16 a[52:55], a[244:247], v[128:131], a[52:55]
ds_read_b64 v[168:169], v26 offset:32768
v_mfma_f32_16x16x32_bf16 v[48:51], a[232:235], v[132:135], v[48:51]
ds_read_b64 v[170:171], v27 offset:32768
v_mfma_f32_16x16x32_bf16 v[52:55], a[236:239], v[132:135], v[52:55]
ds_read_b64 v[172:173], v26 offset:34816
v_mfma_f32_16x16x32_bf16 a[56:59], a[240:243], v[132:135], a[56:59]
ds_read_b64 v[174:175], v27 offset:34816
v_mfma_f32_16x16x32_bf16 a[60:63], a[244:247], v[132:135], a[60:63]
ds_read_b64 v[176:177], v26 offset:36864
v_mfma_f32_16x16x32_bf16 v[56:59], a[232:235], v[136:139], v[56:59]
ds_read_b64 v[178:179], v27 offset:36864
v_mfma_f32_16x16x32_bf16 v[60:63], a[236:239], v[136:139], v[60:63]
v_mfma_f32_16x16x32_bf16 a[64:67], a[240:243], v[136:139], a[64:67]
ds_read_b64 v[180:181], v26 offset:38912
v_mfma_f32_16x16x32_bf16 a[68:71], a[244:247], v[136:139], a[68:71]
ds_read_b64 v[182:183], v27 offset:38912
v_mfma_f32_16x16x32_bf16 v[64:67], a[232:235], v[140:143], v[64:67]
v_mfma_f32_16x16x32_bf16 v[68:71], a[236:239], v[140:143], v[68:71]
v_mfma_f32_16x16x32_bf16 a[72:75], a[240:243], v[140:143], a[72:75]
v_mfma_f32_16x16x32_bf16 a[76:79], a[244:247], v[140:143], a[76:79]
s_waitcnt lgkmcnt(0)
v_mfma_f32_16x16x32_bf16 a[0:3], a[216:219], v[144:147], a[0:3]
v_mfma_f32_16x16x32_bf16 a[4:7], a[220:223], v[144:147], a[4:7]
v_mfma_f32_16x16x32_bf16 a[80:83], a[224:227], v[144:147], a[80:83]
v_mfma_f32_16x16x32_bf16 a[84:87], a[228:231], v[144:147], a[84:87]
v_mfma_f32_16x16x32_bf16 a[8:11], a[216:219], v[148:151], a[8:11]
v_mfma_f32_16x16x32_bf16 a[12:15], a[220:223], v[148:151], a[12:15]
v_mfma_f32_16x16x32_bf16 a[88:91], a[224:227], v[148:151], a[88:91]
v_mfma_f32_16x16x32_bf16 a[92:95], a[228:231], v[148:151], a[92:95]
v_mfma_f32_16x16x32_bf16 a[16:19], a[216:219], v[152:155], a[16:19]
v_mfma_f32_16x16x32_bf16 a[20:23], a[220:223], v[152:155], a[20:23]
v_mfma_f32_16x16x32_bf16 a[96:99], a[224:227], v[152:155], a[96:99]
v_mfma_f32_16x16x32_bf16 a[100:103], a[228:231], v[152:155], a[100:103]
s_waitcnt vmcnt(0)
v_mfma_f32_16x16x32_bf16 a[24:27], a[216:219], v[156:159], a[24:27]
ds_read_b64 v[104:105], v24 offset:0
v_mfma_f32_16x16x32_bf16 a[28:31], a[220:223], v[156:159], a[28:31]
v_mfma_f32_16x16x32_bf16 a[104:107], a[224:227], v[156:159], a[104:107]
ds_read_b64 v[106:107], v25 offset:0
v_mfma_f32_16x16x32_bf16 a[108:111], a[228:231], v[156:159], a[108:111]
ds_read_b64 v[108:109], v24 offset:2048
v_mfma_f32_16x16x32_bf16 a[32:35], a[216:219], v[160:163], a[32:35]
ds_read_b64 v[110:111], v25 offset:2048
v_mfma_f32_16x16x32_bf16 a[36:39], a[220:223], v[160:163], a[36:39]
ds_read_b64 v[112:113], v24 offset:4096
v_mfma_f32_16x16x32_bf16 a[112:115], a[224:227], v[160:163], a[112:115]
ds_read_b64 v[114:115], v25 offset:4096
v_mfma_f32_16x16x32_bf16 a[116:119], a[228:231], v[160:163], a[116:119]
v_mfma_f32_16x16x32_bf16 a[0:3], a[232:235], v[164:167], a[0:3]
ds_read_b64 v[116:117], v24 offset:6144
v_mfma_f32_16x16x32_bf16 a[4:7], a[236:239], v[164:167], a[4:7]
ds_read_b64 v[118:119], v25 offset:6144
v_mfma_f32_16x16x32_bf16 a[80:83], a[240:243], v[164:167], a[80:83]
ds_read_b64 v[120:121], v24 offset:8192
v_mfma_f32_16x16x32_bf16 a[84:87], a[244:247], v[164:167], a[84:87]
ds_read_b64 v[122:123], v25 offset:8192
v_mfma_f32_16x16x32_bf16 a[8:11], a[232:235], v[168:171], a[8:11]
ds_read_b64 v[124:125], v26 offset:0
v_mfma_f32_16x16x32_bf16 a[12:15], a[236:239], v[168:171], a[12:15]
ds_read_b64 v[126:127], v27 offset:0
v_mfma_f32_16x16x32_bf16 a[88:91], a[240:243], v[168:171], a[88:91]
v_mfma_f32_16x16x32_bf16 a[92:95], a[244:247], v[168:171], a[92:95]
ds_read_b64 v[128:129], v26 offset:2048
v_mfma_f32_16x16x32_bf16 a[16:19], a[232:235], v[172:175], a[16:19]
ds_read_b64 v[130:131], v27 offset:2048
v_mfma_f32_16x16x32_bf16 a[20:23], a[236:239], v[172:175], a[20:23]
ds_read_b64 v[132:133], v26 offset:4096
v_mfma_f32_16x16x32_bf16 a[96:99], a[240:243], v[172:175], a[96:99]
ds_read_b64 v[134:135], v27 offset:4096
v_mfma_f32_16x16x32_bf16 a[100:103], a[244:247], v[172:175], a[100:103]
ds_read_b64 v[136:137], v26 offset:6144
v_mfma_f32_16x16x32_bf16 a[24:27], a[232:235], v[176:179], a[24:27]
ds_read_b64 v[138:139], v27 offset:6144
v_mfma_f32_16x16x32_bf16 a[28:31], a[236:239], v[176:179], a[28:31]
v_mfma_f32_16x16x32_bf16 a[104:107], a[240:243], v[176:179], a[104:107]
ds_read_b64 v[140:141], v26 offset:8192
v_mfma_f32_16x16x32_bf16 a[108:111], a[244:247], v[176:179], a[108:111]
ds_read_b64 v[142:143], v27 offset:8192
v_mfma_f32_16x16x32_bf16 a[32:35], a[232:235], v[180:183], a[32:35]
v_mfma_f32_16x16x32_bf16 a[36:39], a[236:239], v[180:183], a[36:39]
v_mfma_f32_16x16x32_bf16 a[112:115], a[240:243], v[180:183], a[112:115]
v_mfma_f32_16x16x32_bf16 a[116:119], a[244:247], v[180:183], a[116:119]
s_waitcnt lgkmcnt(0)
v_mfma_f32_16x16x32_bf16 v[32:35], a[248:251], v[104:107], v[32:35]
v_mfma_f32_16x16x32_bf16 v[36:39], a[252:255], v[104:107], v[36:39]
v_mfma_f32_16x16x32_bf16 a[40:43], v[232:235], v[104:107], a[40:43]
v_mfma_f32_16x16x32_bf16 a[44:47], v[236:239], v[104:107], a[44:47]
v_mfma_f32_16x16x32_bf16 v[40:43], a[248:251], v[108:111], v[40:43]
v_mfma_f32_16x16x32_bf16 v[44:47], a[252:255], v[108:111], v[44:47]
v_mfma_f32_16x16x32_bf16 a[48:51], v[232:235], v[108:111], a[48:51]
v_mfma_f32_16x16x32_bf16 a[52:55], v[236:239], v[108:111], a[52:55]
v_mfma_f32_16x16x32_bf16 v[48:51], a[248:251], v[112:115], v[48:51]
v_mfma_f32_16x16x32_bf16 v[52:55], a[252:255], v[112:115], v[52:55]
v_mfma_f32_16x16x32_bf16 a[56:59], v[232:235], v[112:115], a[56:59]
v_mfma_f32_16x16x32_bf16 a[60:63], v[236:239], v[112:115], a[60:63]
v_mfma_f32_16x16x32_bf16 v[56:59], a[248:251], v[116:119], v[56:59]
v_mfma_f32_16x16x32_bf16 v[60:63], a[252:255], v[116:119], v[60:63]
v_mfma_f32_16x16x32_bf16 a[64:67], v[232:235], v[116:119], a[64:67]
v_mfma_f32_16x16x32_bf16 a[68:71], v[236:239], v[116:119], a[68:71]
v_mfma_f32_16x16x32_bf16 v[64:67], a[248:251], v[120:123], v[64:67]
v_mfma_f32_16x16x32_bf16 v[68:71], a[252:255], v[120:123], v[68:71]
v_mfma_f32_16x16x32_bf16 a[72:75], v[232:235], v[120:123], a[72:75]
v_mfma_f32_16x16x32_bf16 a[76:79], v[236:239], v[120:123], a[76:79]
v_mfma_f32_16x16x32_bf16 v[32:35], v[240:243], v[124:127], v[32:35]
v_mfma_f32_16x16x32_bf16 v[36:39], v[244:247], v[124:127], v[36:39]
v_mfma_f32_16x16x32_bf16 a[40:43], v[248:251], v[124:127], a[40:43]
v_mfma_f32_16x16x32_bf16 a[44:47], v[252:255], v[124:127], a[44:47]
v_mfma_f32_16x16x32_bf16 v[40:43], v[240:243], v[128:131], v[40:43]
v_mfma_f32_16x16x32_bf16 v[44:47], v[244:247], v[128:131], v[44:47]
v_mfma_f32_16x16x32_bf16 a[48:51], v[248:251], v[128:131], a[48:51]
v_mfma_f32_16x16x32_bf16 a[52:55], v[252:255], v[128:131], a[52:55]
v_mfma_f32_16x16x32_bf16 v[48:51], v[240:243], v[132:135], v[48:51]
v_mfma_f32_16x16x32_bf16 v[52:55], v[244:247], v[132:135], v[52:55]
v_mfma_f32_16x16x32_bf16 a[56:59], v[248:251], v[132:135], a[56:59]
v_mfma_f32_16x16x32_bf16 a[60:63], v[252:255], v[132:135], a[60:63]
v_mfma_f32_16x16x32_bf16 v[56:59], v[240:243], v[136:139], v[56:59]
v_mfma_f32_16x16x32_bf16 v[60:63], v[244:247], v[136:139], v[60:63]
v_mfma_f32_16x16x32_bf16 a[64:67], v[248:251], v[136:139], a[64:67]
v_mfma_f32_16x16x32_bf16 a[68:71], v[252:255], v[136:139], a[68:71]
v_mfma_f32_16x16x32_bf16 v[64:67], v[240:243], v[140:143], v[64:67]
v_mfma_f32_16x16x32_bf16 v[68:71], v[244:247], v[140:143], v[68:71]
v_mfma_f32_16x16x32_bf16 a[72:75], v[248:251], v[140:143], a[72:75]
v_mfma_f32_16x16x32_bf16 a[76:79], v[252:255], v[140:143], a[76:79]
s_waitcnt lgkmcnt(0)
s_barrier
s_nop 7
s_lshr_b32 s68, s77, 1
s_and_b32 s67, s77, 1
s_mov_b32 s8, s46
s_mov_b32 s9, s47
s_mov_b32 s10, 2654208
s_mov_b32 s11, 0x20000
v_lshrrev_b32 v16, 3, v1
v_mul_u32_u24 v16, 2304, v16
v_lshrrev_b32 v17, 4, v1
v_and_b32 v6, 7, v1
v_xor_b32 v4, v6, v17
v_xor_b32 v5, 4, v4
v_lshl_add_u32 v4, v4, 4, v16
v_lshl_add_u32 v5, v5, 4, v16
v_add_u32 v5, 17408, v5
v_add_u32 v6, 34816, v4
v_add_u32 v7, 34816, v5
s_mul_i32 s60, s25, 9
s_mul_i32 s61, s68, 147456
s_mov_b32 s66, s31
v_lshlrev_b32 v10, 4, v1
v_add_u32 v11, s31, v10
ds_write_b128 v11, a[0:3] offset:0
ds_write_b128 v11, a[4:7] offset:1024
ds_write_b128 v11, a[8:11] offset:2048
ds_write_b128 v11, a[12:15] offset:3072
ds_write_b128 v11, a[16:19] offset:4096
ds_write_b128 v11, a[20:23] offset:5120
ds_write_b128 v11, a[24:27] offset:6144
ds_write_b128 v11, a[28:31] offset:7168
ds_write_b128 v11, a[32:35] offset:8192
ds_write_b128 v11, a[36:39] offset:9216
ds_write_b128 v11, a[40:43] offset:10240
ds_write_b128 v11, a[44:47] offset:11264
ds_write_b128 v11, a[48:51] offset:12288
ds_write_b128 v11, a[52:55] offset:13312
ds_write_b128 v11, a[56:59] offset:14336
ds_write_b128 v11, a[60:63] offset:15360
ds_write_b128 v11, a[64:67] offset:16384
ds_write_b128 v11, a[68:71] offset:17408
ds_write_b128 v11, a[72:75] offset:18432
ds_write_b128 v11, a[76:79] offset:19456
ds_write_b128 v11, a[80:83] offset:20480
ds_write_b128 v11, a[84:87] offset:21504
ds_write_b128 v11, a[88:91] offset:22528
ds_write_b128 v11, a[92:95] offset:23552
ds_write_b128 v11, a[96:99] offset:24576
ds_write_b128 v11, a[100:103] offset:25600
ds_write_b128 v11, a[104:107] offset:26624
ds_write_b128 v11, a[108:111] offset:27648
ds_write_b128 v11, a[112:115] offset:28672
ds_write_b128 v11, a[116:119] offset:29696
s_xor_b32 s33, s25, 1
s_mul_i32 s33, s33, 36864
s_add_u32 s33, s33, 0
v_add_u32 v12, s33, v10
s_xor_b32 s33, s25, 2
s_mul_i32 s33, s33, 36864
s_add_u32 s33, s33, 0
v_add_u32 v13, s33, v10
s_xor_b32 s33, s25, 3
s_mul_i32 s33, s33, 36864
s_add_u32 s33, s33, 0
v_add_u32 v14, s33, v10
s_waitcnt lgkmcnt(0)
s_barrier
ds_read_b128 v[104:107], v12 offset:0
ds_read_b128 v[108:111], v12 offset:1024
ds_read_b128 v[112:115], v12 offset:2048
ds_read_b128 v[116:119], v12 offset:3072
ds_read_b128 v[120:123], v12 offset:4096
ds_read_b128 v[124:127], v12 offset:5120
ds_read_b128 v[128:131], v12 offset:6144
ds_read_b128 v[132:135], v12 offset:7168
ds_read_b128 v[136:139], v12 offset:8192
ds_read_b128 v[140:143], v12 offset:9216
ds_read_b128 v[144:147], v13 offset:10240
ds_read_b128 v[148:151], v13 offset:11264
ds_read_b128 v[152:155], v13 offset:12288
ds_read_b128 v[156:159], v13 offset:13312
ds_read_b128 v[160:163], v13 offset:14336
ds_read_b128 v[164:167], v13 offset:15360
ds_read_b128 v[168:171], v13 offset:16384
ds_read_b128 v[172:175], v13 offset:17408
ds_read_b128 v[176:179], v13 offset:18432
ds_read_b128 v[180:183], v13 offset:19456
ds_read_b128 v[184:187], v14 offset:20480
ds_read_b128 v[188:191], v14 offset:21504
ds_read_b128 v[192:195], v14 offset:22528
ds_read_b128 v[196:199], v14 offset:23552
ds_read_b128 v[200:203], v14 offset:24576
ds_read_b128 v[204:207], v14 offset:25600
ds_read_b128 v[208:211], v14 offset:26624
ds_read_b128 v[212:215], v14 offset:27648
ds_read_b128 v[216:219], v14 offset:28672
ds_read_b128 v[220:223], v14 offset:29696
s_waitcnt lgkmcnt(15)
v_pk_add_f32 v[32:33], v[32:33], v[104:105]
v_pk_add_f32 v[34:35], v[34:35], v[106:107]
v_pk_add_f32 v[36:37], v[36:37], v[108:109]
v_pk_add_f32 v[38:39], v[38:39], v[110:111]
v_pk_add_f32 v[40:41], v[40:41], v[112:113]
v_pk_add_f32 v[42:43], v[42:43], v[114:115]
v_pk_add_f32 v[44:45], v[44:45], v[116:117]
v_pk_add_f32 v[46:47], v[46:47], v[118:119]
v_pk_add_f32 v[48:49], v[48:49], v[120:121]
v_pk_add_f32 v[50:51], v[50:51], v[122:123]
v_pk_add_f32 v[52:53], v[52:53], v[124:125]
v_pk_add_f32 v[54:55], v[54:55], v[126:127]
v_pk_add_f32 v[56:57], v[56:57], v[128:129]
v_pk_add_f32 v[58:59], v[58:59], v[130:131]
v_pk_add_f32 v[60:61], v[60:61], v[132:133]
v_pk_add_f32 v[62:63], v[62:63], v[134:135]
v_pk_add_f32 v[64:65], v[64:65], v[136:137]
v_pk_add_f32 v[66:67], v[66:67], v[138:139]
v_pk_add_f32 v[68:69], v[68:69], v[140:141]
v_pk_add_f32 v[70:71], v[70:71], v[142:143]
s_waitcnt lgkmcnt(10)
v_pk_add_f32 v[32:33], v[32:33], v[144:145]
v_pk_add_f32 v[34:35], v[34:35], v[146:147]
v_pk_add_f32 v[36:37], v[36:37], v[148:149]
v_pk_add_f32 v[38:39], v[38:39], v[150:151]
v_pk_add_f32 v[40:41], v[40:41], v[152:153]
v_pk_add_f32 v[42:43], v[42:43], v[154:155]
v_pk_add_f32 v[44:45], v[44:45], v[156:157]
v_pk_add_f32 v[46:47], v[46:47], v[158:159]
v_pk_add_f32 v[48:49], v[48:49], v[160:161]
v_pk_add_f32 v[50:51], v[50:51], v[162:163]
v_pk_add_f32 v[52:53], v[52:53], v[164:165]
v_pk_add_f32 v[54:55], v[54:55], v[166:167]
v_pk_add_f32 v[56:57], v[56:57], v[168:169]
v_pk_add_f32 v[58:59], v[58:59], v[170:171]
v_pk_add_f32 v[60:61], v[60:61], v[172:173]
v_pk_add_f32 v[62:63], v[62:63], v[174:175]
v_pk_add_f32 v[64:65], v[64:65], v[176:177]
v_pk_add_f32 v[66:67], v[66:67], v[178:179]
v_pk_add_f32 v[68:69], v[68:69], v[180:181]
v_pk_add_f32 v[70:71], v[70:71], v[182:183]
s_waitcnt lgkmcnt(0)
v_pk_add_f32 v[32:33], v[32:33], v[184:185]
v_pk_add_f32 v[34:35], v[34:35], v[186:187]
v_pk_add_f32 v[36:37], v[36:37], v[188:189]
v_pk_add_f32 v[38:39], v[38:39], v[190:191]
v_pk_add_f32 v[40:41], v[40:41], v[192:193]
v_pk_add_f32 v[42:43], v[42:43], v[194:195]
v_pk_add_f32 v[44:45], v[44:45], v[196:197]
v_pk_add_f32 v[46:47], v[46:47], v[198:199]
v_pk_add_f32 v[48:49], v[48:49], v[200:201]
v_pk_add_f32 v[50:51], v[50:51], v[202:203]
v_pk_add_f32 v[52:53], v[52:53], v[204:205]
v_pk_add_f32 v[54:55], v[54:55], v[206:207]
v_pk_add_f32 v[56:57], v[56:57], v[208:209]
v_pk_add_f32 v[58:59], v[58:59], v[210:211]
v_pk_add_f32 v[60:61], v[60:61], v[212:213]
v_pk_add_f32 v[62:63], v[62:63], v[214:215]
v_pk_add_f32 v[64:65], v[64:65], v[216:217]
v_pk_add_f32 v[66:67], v[66:67], v[218:219]
v_pk_add_f32 v[68:69], v[68:69], v[220:221]
v_pk_add_f32 v[70:71], v[70:71], v[222:223]
s_and_b32 s33, s25, 1
s_mul_i32 s71, s33, 180
s_lshl_b32 s33, s69, 1
s_add_u32 s71, s71, s33
s_lshr_b32 s33, s25, 1
s_add_u32 s71, s71, s33
s_lshl_b32 s71, s71, 10
s_add_u32 s71, s71, s70
s_add_u32 s71, s71, 5242880
v_cvt_pk_bf16_f32 v232, v32, v33
v_cvt_pk_bf16_f32 v233, v34, v35
v_cvt_pk_bf16_f32 v234, v36, v37
v_cvt_pk_bf16_f32 v235, v38, v39
buffer_store_dwordx4 v[232:235], v10, s[4:7], s71 offen sc1
s_add_u32 s71, s71, 36864
v_cvt_pk_bf16_f32 v236, v40, v41
v_cvt_pk_bf16_f32 v237, v42, v43
v_cvt_pk_bf16_f32 v238, v44, v45
v_cvt_pk_bf16_f32 v239, v46, v47
buffer_store_dwordx4 v[236:239], v10, s[4:7], s71 offen sc1
s_add_u32 s71, s71, 36864
v_cvt_pk_bf16_f32 v232, v48, v49
v_cvt_pk_bf16_f32 v233, v50, v51
v_cvt_pk_bf16_f32 v234, v52, v53
v_cvt_pk_bf16_f32 v235, v54, v55
buffer_store_dwordx4 v[232:235], v10, s[4:7], s71 offen sc1
s_add_u32 s71, s71, 36864
v_cvt_pk_bf16_f32 v236, v56, v57
v_cvt_pk_bf16_f32 v237, v58, v59
v_cvt_pk_bf16_f32 v238, v60, v61
v_cvt_pk_bf16_f32 v239, v62, v63
buffer_store_dwordx4 v[236:239], v10, s[4:7], s71 offen sc1
s_add_u32 s71, s71, 36864
v_cvt_pk_bf16_f32 v232, v64, v65
v_cvt_pk_bf16_f32 v233, v66, v67
v_cvt_pk_bf16_f32 v234, v68, v69
v_cvt_pk_bf16_f32 v235, v70, v71
buffer_store_dwordx4 v[232:235], v10, s[4:7], s71 offen sc1
s_add_u32 s71, s71, 36864
s_barrier
s_add_u32 s62, s60, 0
s_and_b32 s63, s62, 1
s_mul_i32 s63, s63, 73728
s_lshr_b32 s62, s62, 1
s_lshl_b32 s62, s62, 7
s_add_u32 s62, s62, s63
s_add_u32 s62, s62, s61
s_add_u32 m0, s66, 0
s_add_u32 s32, s62, 0
buffer_load_dwordx4 v4, s[8:11], s32 offen offset:0  lds
buffer_load_dwordx4 v5, s[8:11], s32 offen offset:1024  lds
buffer_load_dwordx4 v6, s[8:11], s32 offen offset:2048  lds
buffer_load_dwordx4 v7, s[8:11], s32 offen offset:3072  lds
s_add_u32 s78, s77, 216
s_waitcnt vmcnt(4)
s_barrier
s_lshl_b32 s32, s78, 7
s_add_u32 s32, s32, 131072
v_cmp_eq_u32 vcc, 0, v0
v_mov_b32 v16, 0x7fffffff
s_nop 0
v_cndmask_b32 v16, v16, 0, vcc
v_mov_b32 v17, s24
buffer_store_dword v17, v16, s[4:7], s32 offen sc1
s_add_u32 s62, s60, 1
s_and_b32 s63, s62, 1
s_mul_i32 s63, s63, 73728
s_lshr_b32 s62, s62, 1
s_lshl_b32 s62, s62, 7
s_add_u32 s62, s62, s63
s_add_u32 s62, s62, s61
s_add_u32 m0, s66, 4096
s_add_u32 s32, s62, 0
buffer_load_dwordx4 v4, s[8:11], s32 offen offset:0  lds
buffer_load_dwordx4 v5, s[8:11], s32 offen offset:1024  lds
buffer_load_dwordx4 v6, s[8:11], s32 offen offset:2048  lds
buffer_load_dwordx4 v7, s[8:11], s32 offen offset:3072  lds
s_add_u32 s62, s60, 2
s_and_b32 s63, s62, 1
s_mul_i32 s63, s63, 73728
s_lshr_b32 s62, s62, 1
s_lshl_b32 s62, s62, 7
s_add_u32 s62, s62, s63
s_add_u32 s62, s62, s61
s_add_u32 m0, s66, 8192
s_add_u32 s32, s62, 0
buffer_load_dwordx4 v4, s[8:11], s32 offen offset:0  lds
buffer_load_dwordx4 v5, s[8:11], s32 offen offset:1024  lds
buffer_load_dwordx4 v6, s[8:11], s32 offen offset:2048  lds
buffer_load_dwordx4 v7, s[8:11], s32 offen offset:3072  lds
s_add_u32 s62, s60, 3
s_and_b32 s63, s62, 1
s_mul_i32 s63, s63, 73728
s_lshr_b32 s62, s62, 1
s_lshl_b32 s62, s62, 7
s_add_u32 s62, s62, s63
s_add_u32 s62, s62, s61
s_add_u32 m0, s66, 12288
s_add_u32 s32, s62, 0
buffer_load_dwordx4 v4, s[8:11], s32 offen offset:0  lds
buffer_load_dwordx4 v5, s[8:11], s32 offen offset:1024  lds
buffer_load_dwordx4 v6, s[8:11], s32 offen offset:2048  lds
buffer_load_dwordx4 v7, s[8:11], s32 offen offset:3072  lds
s_add_u32 s62, s60, 4
s_and_b32 s63, s62, 1
s_mul_i32 s63, s63, 73728
s_lshr_b32 s62, s62, 1
s_lshl_b32 s62, s62, 7
s_add_u32 s62, s62, s63
s_add_u32 s62, s62, s61
s_add_u32 m0, s66, 16384
s_add_u32 s32, s62, 0
buffer_load_dwordx4 v4, s[8:11], s32 offen offset:0  lds
buffer_load_dwordx4 v5, s[8:11], s32 offen offset:1024  lds
buffer_load_dwordx4 v6, s[8:11], s32 offen offset:2048  lds
buffer_load_dwordx4 v7, s[8:11], s32 offen offset:3072  lds
s_add_u32 s62, s60, 5
s_and_b32 s63, s62, 1
s_mul_i32 s63, s63, 73728
s_lshr_b32 s62, s62, 1
s_lshl_b32 s62, s62, 7
s_add_u32 s62, s62, s63
s_add_u32 s62, s62, s61
s_add_u32 m0, s66, 20480
s_add_u32 s32, s62, 0
buffer_load_dwordx4 v4, s[8:11], s32 offen offset:0  lds
buffer_load_dwordx4 v5, s[8:11], s32 offen offset:1024  lds
buffer_load_dwordx4 v6, s[8:11], s32 offen offset:2048  lds
buffer_load_dwordx4 v7, s[8:11], s32 offen offset:3072  lds
s_add_u32 s62, s60, 6
s_and_b32 s63, s62, 1
s_mul_i32 s63, s63, 73728
s_lshr_b32 s62, s62, 1
s_lshl_b32 s62, s62, 7
s_add_u32 s62, s62, s63
s_add_u32 s62, s62, s61
s_add_u32 m0, s66, 24576
s_add_u32 s32, s62, 0
buffer_load_dwordx4 v4, s[8:11], s32 offen offset:0  lds
buffer_load_dwordx4 v5, s[8:11], s32 offen offset:1024  lds
buffer_load_dwordx4 v6, s[8:11], s32 offen offset:2048  lds
buffer_load_dwordx4 v7, s[8:11], s32 offen offset:3072  lds
s_add_u32 s62, s60, 7
s_and_b32 s63, s62, 1
s_mul_i32 s63, s63, 73728
s_lshr_b32 s62, s62, 1
s_lshl_b32 s62, s62, 7
s_add_u32 s62, s62, s63
s_add_u32 s62, s62, s61
s_add_u32 m0, s66, 28672
s_add_u32 s32, s62, 0
buffer_load_dwordx4 v4, s[8:11], s32 offen offset:0  lds
buffer_load_dwordx4 v5, s[8:11], s32 offen offset:1024  lds
buffer_load_dwordx4 v6, s[8:11], s32 offen offset:2048  lds
buffer_load_dwordx4 v7, s[8:11], s32 offen offset:3072  lds
s_add_u32 s62, s60, 8
s_and_b32 s63, s62, 1
s_mul_i32 s63, s63, 73728
s_lshr_b32 s62, s62, 1
s_lshl_b32 s62, s62, 7
s_add_u32 s62, s62, s63
s_add_u32 s62, s62, s61
s_add_u32 m0, s66, 32768
s_add_u32 s32, s62, 0
buffer_load_dwordx4 v4, s[8:11], s32 offen offset:0  lds
buffer_load_dwordx4 v5, s[8:11], s32 offen offset:1024  lds
buffer_load_dwordx4 v6, s[8:11], s32 offen offset:2048  lds
buffer_load_dwordx4 v7, s[8:11], s32 offen offset:3072  lds
v_lshlrev_b32 v28, 4, v1
v_add_u32 v29, 4096, v28
v_add_u32 v30, 8192, v28
s_mul_i32 s60, s67, 184320
s_mul_i32 s33, s25, 9216
s_add_u32 s33, s33, 5242880
s_add_u32 s60, s60, s33
s_add_u32 s61, s60, 36864
s_add_u32 s62, s60, 73728
s_add_u32 s63, s60, 110592
s_add_u32 s64, s60, 147456
v_min_u32 v16, 35, v1
v_lshlrev_b32 v16, 7, v16
v_add_u32 v16, 158720, v16
v_bfe_u32 v19, v1, 3, 1
v_lshlrev_b32 v18, 10, v19
v_and_b32 v19, 7, v1
v_lshl_add_u32 v18, v19, 7, v18
v_bfe_u32 v19, v1, 4, 1
v_lshl_add_u32 v18, v19, 3, v18
v_bfe_u32 v17, v1, 1, 3
v_lshrrev_b32 v19, 5, v1
v_xor_b32 v17, v17, v19
s_mul_i32 s33, s25, 9
s_add_u32 s33, s33, 0
s_and_b32 s78, s33, 1
s_lshl_b32 s78, s78, 2
s_lshr_b32 s33, s33, 1
s_lshl_b32 s33, s33, 13
s_lshl_b32 s79, s25, 11
s_add_u32 s33, s33, s79
v_xor_b32 v19, s78, v17
v_xor_b32 v19, 0, v19
v_lshl_add_u32 v52, v19, 4, v18
v_add_u32 v52, s33, v52
v_xor_b32 v53, 2048, v52
v_xor_b32 v54, 4096, v52
v_xor_b32 v55, 6144, v52
v_xor_b32 v19, s78, v17
v_xor_b32 v19, 2, v19
v_lshl_add_u32 v56, v19, 4, v18
v_add_u32 v56, s33, v56
v_xor_b32 v57, 2048, v56
v_xor_b32 v58, 4096, v56
v_xor_b32 v59, 6144, v56
s_mul_i32 s33, s25, 9
s_add_u32 s33, s33, 1
s_and_b32 s78, s33, 1
s_lshl_b32 s78, s78, 2
s_lshr_b32 s33, s33, 1
s_lshl_b32 s33, s33, 13
s_lshl_b32 s79, s25, 11
s_add_u32 s33, s33, s79
v_xor_b32 v19, s78, v17
v_xor_b32 v19, 0, v19
v_lshl_add_u32 v60, v19, 4, v18
v_add_u32 v60, s33, v60
v_xor_b32 v61, 2048, v60
v_xor_b32 v62, 4096, v60
v_xor_b32 v63, 6144, v60
v_xor_b32 v19, s78, v17
v_xor_b32 v19, 2, v19
v_lshl_add_u32 v64, v19, 4, v18
v_add_u32 v64, s33, v64
v_xor_b32 v65, 2048, v64
v_xor_b32 v66, 4096, v64
v_xor_b32 v67, 6144, v64
s_mul_i32 s71, s67, 72
s_lshl_b32 s33, s68, 2
s_add_u32 s71, s71, s33
s_add_u32 s71, s71, s25
s_mul_i32 s71, s71, 2560
s_add_u32 s71, s71, 7864320
s_mov_b32 s12, s50
s_mov_b32 s13, s51
s_mov_b32 s14, 2654208
s_mov_b32 s15, 0x20000
v_lshrrev_b32 v19, 3, v1
v_mul_u32_u24 v19, 2304, v19
v_lshrrev_b32 v31, 4, v1
v_lshlrev_b32 v31, 1, v31
v_and_b32 v4, 7, v1
v_xor_b32 v31, v31, v4
v_lshl_add_u32 v4, v31, 4, v19
v_add_u32 v5, 17408, v4
v_add_u32 v6, 34816, v4
v_add_u32 v7, 52224, v4
s_mul_i32 s65, s25, 663552
s_lshl_b32 s33, s68, 7
s_add_u32 s65, s65, s33
v_lshrrev_b32 v17, 5, v1
v_mul_u32_u24 v19, 1024, v17
v_bfe_u32 v17, v1, 2, 3
v_lshl_add_u32 v19, v17, 7, v19
v_lshrrev_b32 v18, 1, v17
v_and_b32 v17, 3, v1
v_lshl_add_u32 v19, v17, 3, v19
v_add_u32 v19, s31, v19
v_xor_b32 v18, s25, v18
v_xor_b32 v17, 0, v18
v_lshl_add_u32 v20, v17, 5, v19
v_xor_b32 v17, 1, v18
v_lshl_add_u32 v21, v17, 5, v19
v_xor_b32 v17, 2, v18
v_lshl_add_u32 v22, v17, 5, v19
v_xor_b32 v17, 3, v18
v_lshl_add_u32 v23, v17, 5, v19
v_lshlrev_b32 v9, 3, v1
s_and_b32 s66, s27, 6
s_add_u32 s79, s66, 0
s_cmp_ge_u32 s79, 9
s_cselect_b32 s33, 9, 0
s_sub_u32 s79, s79, s33
s_lshl_b32 s79, s79, 10
v_add_u32 v240, s79, v28
s_add_u32 s79, s66, 1
s_cmp_ge_u32 s79, 9
s_cselect_b32 s33, 9, 0
s_sub_u32 s79, s79, s33
s_lshl_b32 s79, s79, 10
v_add_u32 v241, s79, v28
s_add_u32 s79, s66, 2
s_cmp_ge_u32 s79, 9
s_cselect_b32 s33, 9, 0
s_sub_u32 s79, s79, s33
s_lshl_b32 s79, s79, 10
v_add_u32 v242, s79, v28
s_add_u32 s79, s66, 3
s_cmp_ge_u32 s79, 9
s_cselect_b32 s33, 9, 0
s_sub_u32 s79, s79, s33
s_lshl_b32 s79, s79, 10
v_add_u32 v243, s79, v28
s_add_u32 s79, s66, 4
s_cmp_ge_u32 s79, 9
s_cselect_b32 s33, 9, 0
s_sub_u32 s79, s79, s33
s_lshl_b32 s79, s79, 10
v_add_u32 v244, s79, v28
s_add_u32 s79, s66, 5
s_cmp_ge_u32 s79, 9
s_cselect_b32 s33, 9, 0
s_sub_u32 s79, s79, s33
s_lshl_b32 s79, s79, 10
v_add_u32 v245, s79, v28
s_add_u32 s79, s66, 6
s_cmp_ge_u32 s79, 9
s_cselect_b32 s33, 9, 0
s_sub_u32 s79, s79, s33
s_lshl_b32 s79, s79, 10
v_add_u32 v246, s79, v28
s_add_u32 s79, s66, 7
s_cmp_ge_u32 s79, 9
s_cselect_b32 s33, 9, 0
s_sub_u32 s79, s79, s33
s_lshl_b32 s79, s79, 10
v_add_u32 v247, s79, v28
s_add_u32 s79, s66, 8
s_cmp_ge_u32 s79, 9
s_cselect_b32 s33, 9, 0
s_sub_u32 s79, s79, s33
s_lshl_b32 s79, s79, 10
v_add_u32 v248, s79, v28
s_waitcnt vmcnt(0)
s_barrier
s_cmp_lg_u32 s66, 0
s_cbranch_scc1 L_kr0
ds_read_b64 a[120:121], v52 offset:0
ds_read_b64 a[122:123], v56 offset:0
ds_read_b64 a[124:125], v53 offset:0
ds_read_b64 a[126:127], v57 offset:0
ds_read_b64 a[128:129], v54 offset:0
ds_read_b64 a[130:131], v58 offset:0
ds_read_b64 a[132:133], v55 offset:0
ds_read_b64 a[134:135], v59 offset:0
ds_read_b64 a[136:137], v60 offset:0
ds_read_b64 a[138:139], v64 offset:0
ds_read_b64 a[140:141], v61 offset:0
ds_read_b64 a[142:143], v65 offset:0
ds_read_b64 a[144:145], v62 offset:0
ds_read_b64 a[146:147], v66 offset:0
ds_read_b64 a[148:149], v63 offset:0
ds_read_b64 a[150:151], v67 offset:0
ds_read_b64 a[152:153], v52 offset:8192
ds_read_b64 a[154:155], v56 offset:8192
ds_read_b64 a[156:157], v53 offset:8192
ds_read_b64 a[158:159], v57 offset:8192
ds_read_b64 a[160:161], v54 offset:8192
ds_read_b64 a[162:163], v58 offset:8192
ds_read_b64 a[164:165], v55 offset:8192
ds_read_b64 a[166:167], v59 offset:8192
ds_read_b64 a[168:169], v60 offset:8192
ds_read_b64 a[170:171], v64 offset:8192
ds_read_b64 a[172:173], v61 offset:8192
ds_read_b64 a[174:175], v65 offset:8192
ds_read_b64 a[176:177], v62 offset:8192
ds_read_b64 a[178:179], v66 offset:8192
ds_read_b64 a[180:181], v63 offset:8192
ds_read_b64 a[182:183], v67 offset:8192
ds_read_b64 a[184:185], v52 offset:16384
ds_read_b64 a[186:187], v56 offset:16384
ds_read_b64 a[188:189], v53 offset:16384
ds_read_b64 a[190:191], v57 offset:16384
ds_read_b64 a[192:193], v54 offset:16384
ds_read_b64 a[194:195], v58 offset:16384
ds_read_b64 a[196:197], v55 offset:16384
ds_read_b64 a[198:199], v59 offset:16384
ds_read_b64 a[200:201], v60 offset:16384
ds_read_b64 a[202:203], v64 offset:16384
ds_read_b64 a[204:205], v61 offset:16384
ds_read_b64 a[206:207], v65 offset:16384
ds_read_b64 a[208:209], v62 offset:16384
ds_read_b64 a[210:211], v66 offset:16384
ds_read_b64 a[212:213], v63 offset:16384
ds_read_b64 a[214:215], v67 offset:16384
ds_read_b64 a[216:217], v52 offset:24576
ds_read_b64 a[218:219], v56 offset:24576
ds_read_b64 a[220:221], v53 offset:24576
ds_read_b64 a[222:223], v57 offset:24576
ds_read_b64 a[224:225], v54 offset:24576
ds_read_b64 a[226:227], v58 offset:24576
ds_read_b64 a[228:229], v55 offset:24576
ds_read_b64 a[230:231], v59 offset:24576
ds_read_b64 a[232:233], v60 offset:24576
ds_read_b64 a[234:235], v64 offset:24576
ds_read_b64 a[236:237], v61 offset:24576
ds_read_b64 a[238:239], v65 offset:24576
ds_read_b64 a[240:241], v62 offset:24576
ds_read_b64 a[242:243], v66 offset:24576
ds_read_b64 a[244:245], v63 offset:24576
ds_read_b64 a[246:247], v67 offset:24576
ds_read_b64 a[248:249], v52 offset:32768
ds_read_b64 a[250:251], v56 offset:32768
ds_read_b64 a[252:253], v53 offset:32768
ds_read_b64 a[254:255], v57 offset:32768
ds_read_b64 v[232:233], v54 offset:32768
ds_read_b64 v[234:235], v58 offset:32768
ds_read_b64 v[236:237], v55 offset:32768
ds_read_b64 v[238:239], v59 offset:32768
s_branch L_kre
L_kr0:
s_cmp_lg_u32 s66, 2
s_cbranch_scc1 L_kr1
ds_read_b64 a[120:121], v52 offset:8192
ds_read_b64 a[122:123], v56 offset:8192
ds_read_b64 a[124:125], v53 offset:8192
ds_read_b64 a[126:127], v57 offset:8192
ds_read_b64 a[128:129], v54 offset:8192
ds_read_b64 a[130:131], v58 offset:8192
ds_read_b64 a[132:133], v55 offset:8192
ds_read_b64 a[134:135], v59 offset:8192
ds_read_b64 a[136:137], v60 offset:8192
ds_read_b64 a[138:139], v64 offset:8192
ds_read_b64 a[140:141], v61 offset:8192
ds_read_b64 a[142:143], v65 offset:8192
ds_read_b64 a[144:145], v62 offset:8192
ds_read_b64 a[146:147], v66 offset:8192
ds_read_b64 a[148:149], v63 offset:8192
ds_read_b64 a[150:151], v67 offset:8192
ds_read_b64 a[152:153], v52 offset:16384
ds_read_b64 a[154:155], v56 offset:16384
ds_read_b64 a[156:157], v53 offset:16384
ds_read_b64 a[158:159], v57 offset:16384
ds_read_b64 a[160:161], v54 offset:16384
ds_read_b64 a[162:163], v58 offset:16384
ds_read_b64 a[164:165], v55 offset:16384
ds_read_b64 a[166:167], v59 offset:16384
ds_read_b64 a[168:169], v60 offset:16384
ds_read_b64 a[170:171], v64 offset:16384
ds_read_b64 a[172:173], v61 offset:16384
ds_read_b64 a[174:175], v65 offset:16384
ds_read_b64 a[176:177], v62 offset:16384
ds_read_b64 a[178:179], v66 offset:16384
ds_read_b64 a[180:181], v63 offset:16384
ds_read_b64 a[182:183], v67 offset:16384
ds_read_b64 a[184:185], v52 offset:24576
ds_read_b64 a[186:187], v56 offset:24576
ds_read_b64 a[188:189], v53 offset:24576
ds_read_b64 a[190:191], v57 offset:24576
ds_read_b64 a[192:193], v54 offset:24576
ds_read_b64 a[194:195], v58 offset:24576
ds_read_b64 a[196:197], v55 offset:24576
ds_read_b64 a[198:199], v59 offset:24576
ds_read_b64 a[200:201], v60 offset:24576
ds_read_b64 a[202:203], v64 offset:24576
ds_read_b64 a[204:205], v61 offset:24576
ds_read_b64 a[206:207], v65 offset:24576
ds_read_b64 a[208:209], v62 offset:24576
ds_read_b64 a[210:211], v66 offset:24576
ds_read_b64 a[212:213], v63 offset:24576
ds_read_b64 a[214:215], v67 offset:24576
ds_read_b64 a[216:217], v52 offset:32768
ds_read_b64 a[218:219], v56 offset:32768
ds_read_b64 a[220:221], v53 offset:32768
ds_read_b64 a[222:223], v57 offset:32768
ds_read_b64 a[224:225], v54 offset:32768
ds_read_b64 a[226:227], v58 offset:32768
ds_read_b64 a[228:229], v55 offset:32768
ds_read_b64 a[230:231], v59 offset:32768
ds_read_b64 a[232:233], v52 offset:0
ds_read_b64 a[234:235], v56 offset:0
ds_read_b64 a[236:237], v53 offset:0
ds_read_b64 a[238:239], v57 offset:0
ds_read_b64 a[240:241], v54 offset:0
ds_read_b64 a[242:243], v58 offset:0
ds_read_b64 a[244:245], v55 offset:0
ds_read_b64 a[246:247], v59 offset:0
ds_read_b64 a[248:249], v60 offset:0
ds_read_b64 a[250:251], v64 offset:0
ds_read_b64 a[252:253], v61 offset:0
ds_read_b64 a[254:255], v65 offset:0
ds_read_b64 v[232:233], v62 offset:0
ds_read_b64 v[234:235], v66 offset:0
ds_read_b64 v[236:237], v63 offset:0
ds_read_b64 v[238:239], v67 offset:0
s_branch L_kre
L_kr1:
s_cmp_lg_u32 s66, 4
s_cbranch_scc1 L_kr2
ds_read_b64 a[120:121], v52 offset:16384
ds_read_b64 a[122:123], v56 offset:16384
ds_read_b64 a[124:125], v53 offset:16384
ds_read_b64 a[126:127], v57 offset:16384
ds_read_b64 a[128:129], v54 offset:16384
ds_read_b64 a[130:131], v58 offset:16384
ds_read_b64 a[132:133], v55 offset:16384
ds_read_b64 a[134:135], v59 offset:16384
ds_read_b64 a[136:137], v60 offset:16384
ds_read_b64 a[138:139], v64 offset:16384
ds_read_b64 a[140:141], v61 offset:16384
ds_read_b64 a[142:143], v65 offset:16384
ds_read_b64 a[144:145], v62 offset:16384
ds_read_b64 a[146:147], v66 offset:16384
ds_read_b64 a[148:149], v63 offset:16384
ds_read_b64 a[150:151], v67 offset:16384
ds_read_b64 a[152:153], v52 offset:24576
ds_read_b64 a[154:155], v56 offset:24576
ds_read_b64 a[156:157], v53 offset:24576
ds_read_b64 a[158:159], v57 offset:24576
ds_read_b64 a[160:161], v54 offset:24576
ds_read_b64 a[162:163], v58 offset:24576
ds_read_b64 a[164:165], v55 offset:24576
ds_read_b64 a[166:167], v59 offset:24576
ds_read_b64 a[168:169], v60 offset:24576
ds_read_b64 a[170:171], v64 offset:24576
ds_read_b64 a[172:173], v61 offset:24576
ds_read_b64 a[174:175], v65 offset:24576
ds_read_b64 a[176:177], v62 offset:24576
ds_read_b64 a[178:179], v66 offset:24576
ds_read_b64 a[180:181], v63 offset:24576
ds_read_b64 a[182:183], v67 offset:24576
ds_read_b64 a[184:185], v52 offset:32768
ds_read_b64 a[186:187], v56 offset:32768
ds_read_b64 a[188:189], v53 offset:32768
ds_read_b64 a[190:191], v57 offset:32768
ds_read_b64 a[192:193], v54 offset:32768
ds_read_b64 a[194:195], v58 offset:32768
ds_read_b64 a[196:197], v55 offset:32768
ds_read_b64 a[198:199], v59 offset:32768
ds_read_b64 a[200:201], v52 offset:0
ds_read_b64 a[202:203], v56 offset:0
ds_read_b64 a[204:205], v53 offset:0
ds_read_b64 a[206:207], v57 offset:0
ds_read_b64 a[208:209], v54 offset:0
ds_read_b64 a[210:211], v58 offset:0
ds_read_b64 a[212:213], v55 offset:0
ds_read_b64 a[214:215], v59 offset:0
ds_read_b64 a[216:217], v60 offset:0
ds_read_b64 a[218:219], v64 offset:0
ds_read_b64 a[220:221], v61 offset:0
ds_read_b64 a[222:223], v65 offset:0
ds_read_b64 a[224:225], v62 offset:0
ds_read_b64 a[226:227], v66 offset:0
ds_read_b64 a[228:229], v63 offset:0
ds_read_b64 a[230:231], v67 offset:0
ds_read_b64 a[232:233], v52 offset:8192
ds_read_b64 a[234:235], v56 offset:8192
ds_read_b64 a[236:237], v53 offset:8192
ds_read_b64 a[238:239], v57 offset:8192
ds_read_b64 a[240:241], v54 offset:8192
ds_read_b64 a[242:243], v58 offset:8192
ds_read_b64 a[244:245], v55 offset:8192
ds_read_b64 a[246:247], v59 offset:8192
ds_read_b64 a[248:249], v60 offset:8192
ds_read_b64 a[250:251], v64 offset:8192
ds_read_b64 a[252:253], v61 offset:8192
ds_read_b64 a[254:255], v65 offset:8192
ds_read_b64 v[232:233], v62 offset:8192
ds_read_b64 v[234:235], v66 offset:8192
ds_read_b64 v[236:237], v63 offset:8192
ds_read_b64 v[238:239], v67 offset:8192
s_branch L_kre
L_kr2:
ds_read_b64 a[120:121], v52 offset:24576
ds_read_b64 a[122:123], v56 offset:24576
ds_read_b64 a[124:125], v53 offset:24576
ds_read_b64 a[126:127], v57 offset:24576
ds_read_b64 a[128:129], v54 offset:24576
ds_read_b64 a[130:131], v58 offset:24576
ds_read_b64 a[132:133], v55 offset:24576
ds_read_b64 a[134:135], v59 offset:24576
ds_read_b64 a[136:137], v60 offset:24576
ds_read_b64 a[138:139], v64 offset:24576
ds_read_b64 a[140:141], v61 offset:24576
ds_read_b64 a[142:143], v65 offset:24576
ds_read_b64 a[144:145], v62 offset:24576
ds_read_b64 a[146:147], v66 offset:24576
ds_read_b64 a[148:149], v63 offset:24576
ds_read_b64 a[150:151], v67 offset:24576
ds_read_b64 a[152:153], v52 offset:32768
ds_read_b64 a[154:155], v56 offset:32768
ds_read_b64 a[156:157], v53 offset:32768
ds_read_b64 a[158:159], v57 offset:32768
ds_read_b64 a[160:161], v54 offset:32768
ds_read_b64 a[162:163], v58 offset:32768
ds_read_b64 a[164:165], v55 offset:32768
ds_read_b64 a[166:167], v59 offset:32768
ds_read_b64 a[168:169], v52 offset:0
ds_read_b64 a[170:171], v56 offset:0
ds_read_b64 a[172:173], v53 offset:0
ds_read_b64 a[174:175], v57 offset:0
ds_read_b64 a[176:177], v54 offset:0
ds_read_b64 a[178:179], v58 offset:0
ds_read_b64 a[180:181], v55 offset:0
ds_read_b64 a[182:183], v59 offset:0
ds_read_b64 a[184:185], v60 offset:0
ds_read_b64 a[186:187], v64 offset:0
ds_read_b64 a[188:189], v61 offset:0
ds_read_b64 a[190:191], v65 offset:0
ds_read_b64 a[192:193], v62 offset:0
ds_read_b64 a[194:195], v66 offset:0
ds_read_b64 a[196:197], v63 offset:0
ds_read_b64 a[198:199], v67 offset:0
ds_read_b64 a[200:201], v52 offset:8192
ds_read_b64 a[202:203], v56 offset:8192
ds_read_b64 a[204:205], v53 offset:8192
ds_read_b64 a[206:207], v57 offset:8192
ds_read_b64 a[208:209], v54 offset:8192
ds_read_b64 a[210:211], v58 offset:8192
ds_read_b64 a[212:213], v55 offset:8192
ds_read_b64 a[214:215], v59 offset:8192
ds_read_b64 a[216:217], v60 offset:8192
ds_read_b64 a[218:219], v64 offset:8192
ds_read_b64 a[220:221], v61 offset:8192
ds_read_b64 a[222:223], v65 offset:8192
ds_read_b64 a[224:225], v62 offset:8192
ds_read_b64 a[226:227], v66 offset:8192
ds_read_b64 a[228:229], v63 offset:8192
ds_read_b64 a[230:231], v67 offset:8192
ds_read_b64 a[232:233], v52 offset:16384
ds_read_b64 a[234:235], v56 offset:16384
ds_read_b64 a[236:237], v53 offset:16384
ds_read_b64 a[238:239], v57 offset:16384
ds_read_b64 a[240:241], v54 offset:16384
ds_read_b64 a[242:243], v58 offset:16384
ds_read_b64 a[244:245], v55 offset:16384
ds_read_b64 a[246:247], v59 offset:16384
ds_read_b64 a[248:249], v60 offset:16384
ds_read_b64 a[250:251], v64 offset:16384
ds_read_b64 a[252:253], v61 offset:16384
ds_read_b64 a[254:255], v65 offset:16384
ds_read_b64 v[232:233], v62 offset:16384
ds_read_b64 v[234:235], v66 offset:16384
ds_read_b64 v[236:237], v63 offset:16384
ds_read_b64 v[238:239], v67 offset:16384
L_kre:
s_waitcnt lgkmcnt(0)
s_waitcnt vmcnt(0)
s_cmp_lg_u32 s25, 0
s_cbranch_scc1 pe_48
s_mov_b32 s33, 20000
poll_47:
buffer_load_dword v17, v16, s[4:7], 0 offen sc1
s_waitcnt vmcnt(0)
v_cmp_ne_u32 vcc, s24, v17
s_sub_u32 s33, s33, 1
s_cmp_eq_u32 s33, 0
s_cbranch_scc1 pe_48
s_nop 1
s_cbranch_vccnz poll_47
pe_48:
s_barrier
buffer_load_dwordx4 v[112:115], v240, s[4:7], s60 offen offset:0 sc1
buffer_load_dwordx4 v[116:119], v240, s[4:7], s61 offen offset:0 sc1
buffer_load_dwordx4 v[120:123], v240, s[4:7], s62 offen offset:0 sc1
buffer_load_dwordx4 v[124:127], v240, s[4:7], s63 offen offset:0 sc1
buffer_load_dwordx4 v[128:131], v240, s[4:7], s64 offen offset:0 sc1
buffer_load_dwordx4 v[132:135], v241, s[4:7], s60 offen offset:0 sc1
buffer_load_dwordx4 v[136:139], v241, s[4:7], s61 offen offset:0 sc1
buffer_load_dwordx4 v[140:143], v241, s[4:7], s62 offen offset:0 sc1
buffer_load_dwordx4 v[144:147], v241, s[4:7], s63 offen offset:0 sc1
buffer_load_dwordx4 v[148:151], v241, s[4:7], s64 offen offset:0 sc1
buffer_load_dwordx4 v[152:155], v242, s[4:7], s60 offen offset:0 sc1
buffer_load_dwordx4 v[156:159], v242, s[4:7], s61 offen offset:0 sc1
buffer_load_dwordx4 v[160:163], v242, s[4:7], s62 offen offset:0 sc1
buffer_load_dwordx4 v[164:167], v242, s[4:7], s63 offen offset:0 sc1
buffer_load_dwordx4 v[168:171], v242, s[4:7], s64 offen offset:0 sc1
buffer_load_dwordx4 v[172:175], v243, s[4:7], s60 offen offset:0 sc1
buffer_load_dwordx4 v[176:179], v243, s[4:7], s61 offen offset:0 sc1
buffer_load_dwordx4 v[180:183], v243, s[4:7], s62 offen offset:0 sc1
buffer_load_dwordx4 v[184:187], v243, s[4:7], s63 offen offset:0 sc1
buffer_load_dwordx4 v[188:191], v243, s[4:7], s64 offen offset:0 sc1
buffer_load_dwordx4 v[192:195], v244, s[4:7], s60 offen offset:0 sc1
buffer_load_dwordx4 v[196:199], v244, s[4:7], s61 offen offset:0 sc1
buffer_load_dwordx4 v[200:203], v244, s[4:7], s62 offen offset:0 sc1
buffer_load_dwordx4 v[204:207], v244, s[4:7], s63 offen offset:0 sc1
buffer_load_dwordx4 v[208:211], v244, s[4:7], s64 offen offset:0 sc1
s_waitcnt vmcnt(20)
v_mfma_f32_16x16x32_bf16 v[32:35], a[120:123], v[112:115], 0
buffer_load_dwordx4 v[212:215], v245, s[4:7], s60 offen offset:0 sc1
v_mfma_f32_16x16x32_bf16 a[0:3], a[124:127], v[112:115], 0
v_mfma_f32_16x16x32_bf16 a[20:23], a[128:131], v[112:115], 0
v_mfma_f32_16x16x32_bf16 a[40:43], a[132:135], v[112:115], 0
buffer_load_dwordx4 v[216:219], v245, s[4:7], s61 offen offset:0 sc1
v_mfma_f32_16x16x32_bf16 v[36:39], a[120:123], v[116:119], 0
v_mfma_f32_16x16x32_bf16 a[4:7], a[124:127], v[116:119], 0
v_mfma_f32_16x16x32_bf16 a[24:27], a[128:131], v[116:119], 0
buffer_load_dwordx4 v[220:223], v245, s[4:7], s62 offen offset:0 sc1
v_mfma_f32_16x16x32_bf16 a[44:47], a[132:135], v[116:119], 0
v_mfma_f32_16x16x32_bf16 v[40:43], a[120:123], v[120:123], 0
v_mfma_f32_16x16x32_bf16 a[8:11], a[124:127], v[120:123], 0
v_mfma_f32_16x16x32_bf16 a[28:31], a[128:131], v[120:123], 0
buffer_load_dwordx4 v[224:227], v245, s[4:7], s63 offen offset:0 sc1
v_mfma_f32_16x16x32_bf16 a[48:51], a[132:135], v[120:123], 0
v_mfma_f32_16x16x32_bf16 v[44:47], a[120:123], v[124:127], 0
v_mfma_f32_16x16x32_bf16 a[12:15], a[124:127], v[124:127], 0
buffer_load_dwordx4 v[228:231], v245, s[4:7], s64 offen offset:0 sc1
v_mfma_f32_16x16x32_bf16 a[32:35], a[128:131], v[124:127], 0
v_mfma_f32_16x16x32_bf16 a[52:55], a[132:135], v[124:127], 0
v_mfma_f32_16x16x32_bf16 v[48:51], a[120:123], v[128:131], 0
v_mfma_f32_16x16x32_bf16 a[16:19], a[124:127], v[128:131], 0
v_mfma_f32_16x16x32_bf16 a[36:39], a[128:131], v[128:131], 0
v_mfma_f32_16x16x32_bf16 a[56:59], a[132:135], v[128:131], 0
s_waitcnt vmcnt(20)
v_mfma_f32_16x16x32_bf16 v[32:35], a[136:139], v[132:135], v[32:35]
buffer_load_dwordx4 a[60:63], v246, s[4:7], s60 offen offset:0 sc1
v_mfma_f32_16x16x32_bf16 a[0:3], a[140:143], v[132:135], a[0:3]
v_mfma_f32_16x16x32_bf16 a[20:23], a[144:147], v[132:135], a[20:23]
v_mfma_f32_16x16x32_bf16 a[40:43], a[148:151], v[132:135], a[40:43]
buffer_load_dwordx4 a[64:67], v246, s[4:7], s61 offen offset:0 sc1
v_mfma_f32_16x16x32_bf16 v[36:39], a[136:139], v[136:139], v[36:39]
v_mfma_f32_16x16x32_bf16 a[4:7], a[140:143], v[136:139], a[4:7]
v_mfma_f32_16x16x32_bf16 a[24:27], a[144:147], v[136:139], a[24:27]
buffer_load_dwordx4 a[68:71], v246, s[4:7], s62 offen offset:0 sc1
v_mfma_f32_16x16x32_bf16 a[44:47], a[148:151], v[136:139], a[44:47]
v_mfma_f32_16x16x32_bf16 v[40:43], a[136:139], v[140:143], v[40:43]
v_mfma_f32_16x16x32_bf16 a[8:11], a[140:143], v[140:143], a[8:11]
v_mfma_f32_16x16x32_bf16 a[28:31], a[144:147], v[140:143], a[28:31]
buffer_load_dwordx4 a[72:75], v246, s[4:7], s63 offen offset:0 sc1
v_mfma_f32_16x16x32_bf16 a[48:51], a[148:151], v[140:143], a[48:51]
v_mfma_f32_16x16x32_bf16 v[44:47], a[136:139], v[144:147], v[44:47]
v_mfma_f32_16x16x32_bf16 a[12:15], a[140:143], v[144:147], a[12:15]
buffer_load_dwordx4 a[76:79], v246, s[4:7], s64 offen offset:0 sc1
v_mfma_f32_16x16x32_bf16 a[32:35], a[144:147], v[144:147], a[32:35]
v_mfma_f32_16x16x32_bf16 a[52:55], a[148:151], v[144:147], a[52:55]
v_mfma_f32_16x16x32_bf16 v[48:51], a[136:139], v[148:151], v[48:51]
v_mfma_f32_16x16x32_bf16 a[16:19], a[140:143], v[148:151], a[16:19]
v_mfma_f32_16x16x32_bf16 a[36:39], a[144:147], v[148:151], a[36:39]
v_mfma_f32_16x16x32_bf16 a[56:59], a[148:151], v[148:151], a[56:59]
s_waitcnt vmcnt(20)
v_mfma_f32_16x16x32_bf16 v[32:35], a[152:155], v[152:155], v[32:35]
buffer_load_dwordx4 a[80:83], v247, s[4:7], s60 offen offset:0 sc1
v_mfma_f32_16x16x32_bf16 a[0:3], a[156:159], v[152:155], a[0:3]
v_mfma_f32_16x16x32_bf16 a[20:23], a[160:163], v[152:155], a[20:23]
v_mfma_f32_16x16x32_bf16 a[40:43], a[164:167], v[152:155], a[40:43]
buffer_load_dwordx4 a[84:87], v247, s[4:7], s61 offen offset:0 sc1
v_mfma_f32_16x16x32_bf16 v[36:39], a[152:155], v[156:159], v[36:39]
v_mfma_f32_16x16x32_bf16 a[4:7], a[156:159], v[156:159], a[4:7]
v_mfma_f32_16x16x32_bf16 a[24:27], a[160:163], v[156:159], a[24:27]
buffer_load_dwordx4 a[88:91], v247, s[4:7], s62 offen offset:0 sc1
v_mfma_f32_16x16x32_bf16 a[44:47], a[164:167], v[156:159], a[44:47]
v_mfma_f32_16x16x32_bf16 v[40:43], a[152:155], v[160:163], v[40:43]
v_mfma_f32_16x16x32_bf16 a[8:11], a[156:159], v[160:163], a[8:11]
v_mfma_f32_16x16x32_bf16 a[28:31], a[160:163], v[160:163], a[28:31]
buffer_load_dwordx4 a[92:95], v247, s[4:7], s63 offen offset:0 sc1
v_mfma_f32_16x16x32_bf16 a[48:51], a[164:167], v[160:163], a[48:51]
v_mfma_f32_16x16x32_bf16 v[44:47], a[152:155], v[164:167], v[44:47]
v_mfma_f32_16x16x32_bf16 a[12:15], a[156:159], v[164:167], a[12:15]
buffer_load_dwordx4 a[96:99], v247, s[4:7], s64 offen offset:0 sc1
v_mfma_f32_16x16x32_bf16 a[32:35], a[160:163], v[164:167], a[32:35]
v_mfma_f32_16x16x32_bf16 a[52:55], a[164:167], v[164:167], a[52:55]
v_mfma_f32_16x16x32_bf16 v[48:51], a[152:155], v[168:171], v[48:51]
v_mfma_f32_16x16x32_bf16 a[16:19], a[156:159], v[168:171], a[16:19]
v_mfma_f32_16x16x32_bf16 a[36:39], a[160:163], v[168:171], a[36:39]
v_mfma_f32_16x16x32_bf16 a[56:59], a[164:167], v[168:171], a[56:59]
s_waitcnt vmcnt(20)
v_mfma_f32_16x16x32_bf16 v[32:35], a[168:171], v[172:175], v[32:35]
buffer_load_dwordx4 a[100:103], v248, s[4:7], s60 offen offset:0 sc1
v_mfma_f32_16x16x32_bf16 a[0:3], a[172:175], v[172:175], a[0:3]
v_mfma_f32_16x16x32_bf16 a[20:23], a[176:179], v[172:175], a[20:23]
v_mfma_f32_16x16x32_bf16 a[40:43], a[180:183], v[172:175], a[40:43]
buffer_load_dwordx4 a[104:107], v248, s[4:7], s61 offen offset:0 sc1
v_mfma_f32_16x16x32_bf16 v[36:39], a[168:171], v[176:179], v[36:39]
v_mfma_f32_16x16x32_bf16 a[4:7], a[172:175], v[176:179], a[4:7]
v_mfma_f32_16x16x32_bf16 a[24:27], a[176:179], v[176:179], a[24:27]
buffer_load_dwordx4 a[108:111], v248, s[4:7], s62 offen offset:0 sc1
v_mfma_f32_16x16x32_bf16 a[44:47], a[180:183], v[176:179], a[44:47]
v_mfma_f32_16x16x32_bf16 v[40:43], a[168:171], v[180:183], v[40:43]
v_mfma_f32_16x16x32_bf16 a[8:11], a[172:175], v[180:183], a[8:11]
v_mfma_f32_16x16x32_bf16 a[28:31], a[176:179], v[180:183], a[28:31]
buffer_load_dwordx4 a[112:115], v248, s[4:7], s63 offen offset:0 sc1
v_mfma_f32_16x16x32_bf16 a[48:51], a[180:183], v[180:183], a[48:51]
v_mfma_f32_16x16x32_bf16 v[44:47], a[168:171], v[184:187], v[44:47]
v_mfma_f32_16x16x32_bf16 a[12:15], a[172:175], v[184:187], a[12:15]
buffer_load_dwordx4 a[116:119], v248, s[4:7], s64 offen offset:0 sc1
v_mfma_f32_16x16x32_bf16 a[32:35], a[176:179], v[184:187], a[32:35]
v_mfma_f32_16x16x32_bf16 a[52:55], a[180:183], v[184:187], a[52:55]
v_mfma_f32_16x16x32_bf16 v[48:51], a[168:171], v[188:191], v[48:51]
v_mfma_f32_16x16x32_bf16 a[16:19], a[172:175], v[188:191], a[16:19]
v_mfma_f32_16x16x32_bf16 a[36:39], a[176:179], v[188:191], a[36:39]
v_mfma_f32_16x16x32_bf16 a[56:59], a[180:183], v[188:191], a[56:59]
s_waitcnt vmcnt(20)
v_mfma_f32_16x16x32_bf16 v[32:35], a[184:187], v[192:195], v[32:35]
s_add_u32 s60, s60, 0x5A000
v_mfma_f32_16x16x32_bf16 a[0:3], a[188:191], v[192:195], a[0:3]
v_mfma_f32_16x16x32_bf16 a[20:23], a[192:195], v[192:195], a[20:23]
s_add_u32 s61, s61, 0x5A000
v_mfma_f32_16x16x32_bf16 a[40:43], a[196:199], v[192:195], a[40:43]
v_mfma_f32_16x16x32_bf16 v[36:39], a[184:187], v[196:199], v[36:39]
s_add_u32 s62, s62, 0x5A000
v_mfma_f32_16x16x32_bf16 a[4:7], a[188:191], v[196:199], a[4:7]
v_mfma_f32_16x16x32_bf16 a[24:27], a[192:195], v[196:199], a[24:27]
s_add_u32 s63, s63, 0x5A000
v_mfma_f32_16x16x32_bf16 a[44:47], a[196:199], v[196:199], a[44:47]
v_mfma_f32_16x16x32_bf16 v[40:43], a[184:187], v[200:203], v[40:43]
s_add_u32 s64, s64, 0x5A000
v_mfma_f32_16x16x32_bf16 a[8:11], a[188:191], v[200:203], a[8:11]
v_mfma_f32_16x16x32_bf16 a[28:31], a[192:195], v[200:203], a[28:31]
s_add_u32 s79, s66, 0
s_cmp_ge_u32 s79, 9
s_cselect_b32 s33, 9, 0
s_sub_u32 s79, s79, s33
s_mul_i32 s79, s79, 73728
s_add_u32 s79, s79, s65
s_add_u32 m0, s31, 0
s_add_u32 s32, s79, 0
buffer_load_dwordx4 v4, s[12:15], s32 offen offset:0  lds
v_mfma_f32_16x16x32_bf16 a[48:51], a[196:199], v[200:203], a[48:51]
v_mfma_f32_16x16x32_bf16 v[44:47], a[184:187], v[204:207], v[44:47]
buffer_load_dwordx4 v5, s[12:15], s32 offen offset:1024  lds
v_mfma_f32_16x16x32_bf16 a[12:15], a[188:191], v[204:207], a[12:15]
v_mfma_f32_16x16x32_bf16 a[32:35], a[192:195], v[204:207], a[32:35]
buffer_load_dwordx4 v6, s[12:15], s32 offen offset:2048  lds
v_mfma_f32_16x16x32_bf16 a[52:55], a[196:199], v[204:207], a[52:55]
v_mfma_f32_16x16x32_bf16 v[48:51], a[184:187], v[208:211], v[48:51]
buffer_load_dwordx4 v7, s[12:15], s32 offen offset:3072  lds
v_mfma_f32_16x16x32_bf16 a[16:19], a[188:191], v[208:211], a[16:19]
v_mfma_f32_16x16x32_bf16 a[36:39], a[192:195], v[208:211], a[36:39]
v_mfma_f32_16x16x32_bf16 a[56:59], a[196:199], v[208:211], a[56:59]
s_waitcnt vmcnt(19)
v_mfma_f32_16x16x32_bf16 v[32:35], a[200:203], v[212:215], v[32:35]
s_add_u32 s79, s66, 1
s_cmp_ge_u32 s79, 9
s_cselect_b32 s33, 9, 0
s_sub_u32 s79, s79, s33
s_mul_i32 s79, s79, 73728
s_add_u32 s79, s79, s65
s_add_u32 m0, s31, 4096
s_add_u32 s32, s79, 0
buffer_load_dwordx4 v4, s[12:15], s32 offen offset:0  lds
v_mfma_f32_16x16x32_bf16 a[0:3], a[204:207], v[212:215], a[0:3]
v_mfma_f32_16x16x32_bf16 a[20:23], a[208:211], v[212:215], a[20:23]
v_mfma_f32_16x16x32_bf16 a[40:43], a[212:215], v[212:215], a[40:43]
v_mfma_f32_16x16x32_bf16 v[36:39], a[200:203], v[216:219], v[36:39]
buffer_load_dwordx4 v5, s[12:15], s32 offen offset:1024  lds
v_mfma_f32_16x16x32_bf16 a[4:7], a[204:207], v[216:219], a[4:7]
v_mfma_f32_16x16x32_bf16 a[24:27], a[208:211], v[216:219], a[24:27]
v_mfma_f32_16x16x32_bf16 a[44:47], a[212:215], v[216:219], a[44:47]
v_mfma_f32_16x16x32_bf16 v[40:43], a[200:203], v[220:223], v[40:43]
buffer_load_dwordx4 v6, s[12:15], s32 offen offset:2048  lds
v_mfma_f32_16x16x32_bf16 a[8:11], a[204:207], v[220:223], a[8:11]
v_mfma_f32_16x16x32_bf16 a[28:31], a[208:211], v[220:223], a[28:31]
v_mfma_f32_16x16x32_bf16 a[48:51], a[212:215], v[220:223], a[48:51]
v_mfma_f32_16x16x32_bf16 v[44:47], a[200:203], v[224:227], v[44:47]
buffer_load_dwordx4 v7, s[12:15], s32 offen offset:3072  lds
v_mfma_f32_16x16x32_bf16 a[12:15], a[204:207], v[224:227], a[12:15]
v_mfma_f32_16x16x32_bf16 a[32:35], a[208:211], v[224:227], a[32:35]
v_mfma_f32_16x16x32_bf16 a[52:55], a[212:215], v[224:227], a[52:55]
v_mfma_f32_16x16x32_bf16 v[48:51], a[200:203], v[228:231], v[48:51]
v_mfma_f32_16x16x32_bf16 a[16:19], a[204:207], v[228:231], a[16:19]
v_mfma_f32_16x16x32_bf16 a[36:39], a[208:211], v[228:231], a[36:39]
v_mfma_f32_16x16x32_bf16 a[56:59], a[212:215], v[228:231], a[56:59]
s_waitcnt vmcnt(18)
v_mfma_f32_16x16x32_bf16 v[32:35], a[216:219], a[60:63], v[32:35]
s_add_u32 s79, s66, 2
s_cmp_ge_u32 s79, 9
s_cselect_b32 s33, 9, 0
s_sub_u32 s79, s79, s33
s_mul_i32 s79, s79, 73728
s_add_u32 s79, s79, s65
s_add_u32 m0, s31, 8192
s_add_u32 s32, s79, 0
buffer_load_dwordx4 v4, s[12:15], s32 offen offset:0  lds
v_mfma_f32_16x16x32_bf16 a[0:3], a[220:223], a[60:63], a[0:3]
v_mfma_f32_16x16x32_bf16 a[20:23], a[224:227], a[60:63], a[20:23]
v_mfma_f32_16x16x32_bf16 a[40:43], a[228:231], a[60:63], a[40:43]
v_mfma_f32_16x16x32_bf16 v[36:39], a[216:219], a[64:67], v[36:39]
buffer_load_dwordx4 v5, s[12:15], s32 offen offset:1024  lds
v_mfma_f32_16x16x32_bf16 a[4:7], a[220:223], a[64:67], a[4:7]
v_mfma_f32_16x16x32_bf16 a[24:27], a[224:227], a[64:67], a[24:27]
v_mfma_f32_16x16x32_bf16 a[44:47], a[228:231], a[64:67], a[44:47]
v_mfma_f32_16x16x32_bf16 v[40:43], a[216:219], a[68:71], v[40:43]
buffer_load_dwordx4 v6, s[12:15], s32 offen offset:2048  lds
v_mfma_f32_16x16x32_bf16 a[8:11], a[220:223], a[68:71], a[8:11]
v_mfma_f32_16x16x32_bf16 a[28:31], a[224:227], a[68:71], a[28:31]
v_mfma_f32_16x16x32_bf16 a[48:51], a[228:231], a[68:71], a[48:51]
v_mfma_f32_16x16x32_bf16 v[44:47], a[216:219], a[72:75], v[44:47]
buffer_load_dwordx4 v7, s[12:15], s32 offen offset:3072  lds
v_mfma_f32_16x16x32_bf16 a[12:15], a[220:223], a[72:75], a[12:15]
v_mfma_f32_16x16x32_bf16 a[32:35], a[224:227], a[72:75], a[32:35]
v_mfma_f32_16x16x32_bf16 a[52:55], a[228:231], a[72:75], a[52:55]
v_mfma_f32_16x16x32_bf16 v[48:51], a[216:219], a[76:79], v[48:51]
v_mfma_f32_16x16x32_bf16 a[16:19], a[220:223], a[76:79], a[16:19]
v_mfma_f32_16x16x32_bf16 a[36:39], a[224:227], a[76:79], a[36:39]
v_mfma_f32_16x16x32_bf16 a[56:59], a[228:231], a[76:79], a[56:59]
s_waitcnt vmcnt(17)
v_mfma_f32_16x16x32_bf16 v[32:35], a[232:235], a[80:83], v[32:35]
s_add_u32 s79, s66, 3
s_cmp_ge_u32 s79, 9
s_cselect_b32 s33, 9, 0
s_sub_u32 s79, s79, s33
s_mul_i32 s79, s79, 73728
s_add_u32 s79, s79, s65
s_add_u32 m0, s31, 12288
s_add_u32 s32, s79, 0
buffer_load_dwordx4 v4, s[12:15], s32 offen offset:0  lds
v_mfma_f32_16x16x32_bf16 a[0:3], a[236:239], a[80:83], a[0:3]
v_mfma_f32_16x16x32_bf16 a[20:23], a[240:243], a[80:83], a[20:23]
v_mfma_f32_16x16x32_bf16 a[40:43], a[244:247], a[80:83], a[40:43]
v_mfma_f32_16x16x32_bf16 v[36:39], a[232:235], a[84:87], v[36:39]
buffer_load_dwordx4 v5, s[12:15], s32 offen offset:1024  lds
v_mfma_f32_16x16x32_bf16 a[4:7], a[236:239], a[84:87], a[4:7]
v_mfma_f32_16x16x32_bf16 a[24:27], a[240:243], a[84:87], a[24:27]
v_mfma_f32_16x16x32_bf16 a[44:47], a[244:247], a[84:87], a[44:47]
v_mfma_f32_16x16x32_bf16 v[40:43], a[232:235], a[88:91], v[40:43]
buffer_load_dwordx4 v6, s[12:15], s32 offen offset:2048  lds
v_mfma_f32_16x16x32_bf16 a[8:11], a[236:239], a[88:91], a[8:11]
v_mfma_f32_16x16x32_bf16 a[28:31], a[240:243], a[88:91], a[28:31]
v_mfma_f32_16x16x32_bf16 a[48:51], a[244:247], a[88:91], a[48:51]
v_mfma_f32_16x16x32_bf16 v[44:47], a[232:235], a[92:95], v[44:47]
buffer_load_dwordx4 v7, s[12:15], s32 offen offset:3072  lds
v_mfma_f32_16x16x32_bf16 a[12:15], a[236:239], a[92:95], a[12:15]
v_mfma_f32_16x16x32_bf16 a[32:35], a[240:243], a[92:95], a[32:35]
v_mfma_f32_16x16x32_bf16 a[52:55], a[244:247], a[92:95], a[52:55]
v_mfma_f32_16x16x32_bf16 v[48:51], a[232:235], a[96:99], v[48:51]
v_mfma_f32_16x16x32_bf16 a[16:19], a[236:239], a[96:99], a[16:19]
v_mfma_f32_16x16x32_bf16 a[36:39], a[240:243], a[96:99], a[36:39]
v_mfma_f32_16x16x32_bf16 a[56:59], a[244:247], a[96:99], a[56:59]
s_waitcnt vmcnt(16)
v_mfma_f32_16x16x32_bf16 v[32:35], a[248:251], a[100:103], v[32:35]
s_add_u32 s79, s66, 4
s_cmp_ge_u32 s79, 9
s_cselect_b32 s33, 9, 0
s_sub_u32 s79, s79, s33
s_mul_i32 s79, s79, 73728
s_add_u32 s79, s79, s65
s_add_u32 m0, s31, 16384
s_add_u32 s32, s79, 0
buffer_load_dwordx4 v4, s[12:15], s32 offen offset:0  lds
v_mfma_f32_16x16x32_bf16 a[0:3], a[252:255], a[100:103], a[0:3]
v_mfma_f32_16x16x32_bf16 a[20:23], v[232:235], a[100:103], a[20:23]
v_mfma_f32_16x16x32_bf16 a[40:43], v[236:239], a[100:103], a[40:43]
v_mfma_f32_16x16x32_bf16 v[36:39], a[248:251], a[104:107], v[36:39]
buffer_load_dwordx4 v5, s[12:15], s32 offen offset:1024  lds
v_mfma_f32_16x16x32_bf16 a[4:7], a[252:255], a[104:107], a[4:7]
v_mfma_f32_16x16x32_bf16 a[24:27], v[232:235], a[104:107], a[24:27]
v_mfma_f32_16x16x32_bf16 a[44:47], v[236:239], a[104:107], a[44:47]
v_mfma_f32_16x16x32_bf16 v[40:43], a[248:251], a[108:111], v[40:43]
buffer_load_dwordx4 v6, s[12:15], s32 offen offset:2048  lds
v_mfma_f32_16x16x32_bf16 a[8:11], a[252:255], a[108:111], a[8:11]
v_mfma_f32_16x16x32_bf16 a[28:31], v[232:235], a[108:111], a[28:31]
v_mfma_f32_16x16x32_bf16 a[48:51], v[236:239], a[108:111], a[48:51]
v_mfma_f32_16x16x32_bf16 v[44:47], a[248:251], a[112:115], v[44:47]
buffer_load_dwordx4 v7, s[12:15], s32 offen offset:3072  lds
v_mfma_f32_16x16x32_bf16 a[12:15], a[252:255], a[112:115], a[12:15]
v_mfma_f32_16x16x32_bf16 a[32:35], v[232:235], a[112:115], a[32:35]
v_mfma_f32_16x16x32_bf16 a[52:55], v[236:239], a[112:115], a[52:55]
v_mfma_f32_16x16x32_bf16 v[48:51], a[248:251], a[116:119], v[48:51]
v_mfma_f32_16x16x32_bf16 a[16:19], a[252:255], a[116:119], a[16:19]
v_mfma_f32_16x16x32_bf16 a[36:39], v[232:235], a[116:119], a[36:39]
v_mfma_f32_16x16x32_bf16 a[56:59], v[236:239], a[116:119], a[56:59]
s_add_u32 s31, s31, 20480
v_lshlrev_b32 v10, 4, v1
v_add_u32 v11, s31, v10
ds_write_b128 v11, a[0:3] offset:0
buffer_load_dwordx4 v[112:115], v240, s[4:7], s60 offen offset:0 sc1
buffer_load_dwordx4 v[116:119], v240, s[4:7], s61 offen offset:0 sc1
ds_write_b128 v11, a[4:7] offset:1024
buffer_load_dwordx4 v[120:123], v240, s[4:7], s62 offen offset:0 sc1
buffer_load_dwordx4 v[124:127], v240, s[4:7], s63 offen offset:0 sc1
ds_write_b128 v11, a[8:11] offset:2048
buffer_load_dwordx4 v[128:131], v240, s[4:7], s64 offen offset:0 sc1
ds_write_b128 v11, a[12:15] offset:3072
buffer_load_dwordx4 v[132:135], v241, s[4:7], s60 offen offset:0 sc1
ds_write_b128 v11, a[16:19] offset:4096
buffer_load_dwordx4 v[136:139], v241, s[4:7], s61 offen offset:0 sc1
ds_write_b128 v11, a[20:23] offset:5120
buffer_load_dwordx4 v[140:143], v241, s[4:7], s62 offen offset:0 sc1
buffer_load_dwordx4 v[144:147], v241, s[4:7], s63 offen offset:0 sc1
ds_write_b128 v11, a[24:27] offset:6144
buffer_load_dwordx4 v[148:151], v241, s[4:7], s64 offen offset:0 sc1
ds_write_b128 v11, a[28:31] offset:7168
buffer_load_dwordx4 v[152:155], v242, s[4:7], s60 offen offset:0 sc1
ds_write_b128 v11, a[32:35] offset:8192
buffer_load_dwordx4 v[156:159], v242, s[4:7], s61 offen offset:0 sc1
buffer_load_dwordx4 v[160:163], v242, s[4:7], s62 offen offset:0 sc1
ds_write_b128 v11, a[36:39] offset:9216
buffer_load_dwordx4 v[164:167], v242, s[4:7], s63 offen offset:0 sc1
ds_write_b128 v11, a[40:43] offset:10240
buffer_load_dwordx4 v[168:171], v242, s[4:7], s64 offen offset:0 sc1
ds_write_b128 v11, a[44:47] offset:11264
buffer_load_dwordx4 v[172:175], v243, s[4:7], s60 offen offset:0 sc1
buffer_load_dwordx4 v[176:179], v243, s[4:7], s61 offen offset:0 sc1
ds_write_b128 v11, a[48:51] offset:12288
buffer_load_dwordx4 v[180:183], v243, s[4:7], s62 offen offset:0 sc1
ds_write_b128 v11, a[52:55] offset:13312
buffer_load_dwordx4 v[184:187], v243, s[4:7], s63 offen offset:0 sc1
buffer_load_dwordx4 v[188:191], v243, s[4:7], s64 offen offset:0 sc1
ds_write_b128 v11, a[56:59] offset:14336
s_xor_b32 s33, s25, 1
s_mul_i32 s33, s33, 36864
s_add_u32 s33, s33, 20480
v_add_u32 v12, s33, v10
s_xor_b32 s33, s25, 2
s_mul_i32 s33, s33, 36864
s_add_u32 s33, s33, 20480
v_add_u32 v13, s33, v10
s_xor_b32 s33, s25, 3
s_mul_i32 s33, s33, 36864
s_add_u32 s33, s33, 20480
v_add_u32 v14, s33, v10
s_waitcnt lgkmcnt(0)
s_barrier
ds_read_b128 v[52:55], v12 offset:0
ds_read_b128 v[56:59], v12 offset:1024
ds_read_b128 v[60:63], v12 offset:2048
ds_read_b128 v[64:67], v12 offset:3072
ds_read_b128 v[68:71], v12 offset:4096
ds_read_b128 v[72:75], v13 offset:5120
ds_read_b128 v[76:79], v13 offset:6144
ds_read_b128 v[80:83], v13 offset:7168
ds_read_b128 v[84:87], v13 offset:8192
ds_read_b128 v[88:91], v13 offset:9216
ds_read_b128 v[92:95], v14 offset:10240
ds_read_b128 v[96:99], v14 offset:11264
ds_read_b128 v[100:103], v14 offset:12288
ds_read_b128 v[104:107], v14 offset:13312
ds_read_b128 v[108:111], v14 offset:14336
s_waitcnt lgkmcnt(10)
v_pk_add_f32 v[32:33], v[32:33], v[52:53]
v_pk_add_f32 v[34:35], v[34:35], v[54:55]
v_pk_add_f32 v[36:37], v[36:37], v[56:57]
v_pk_add_f32 v[38:39], v[38:39], v[58:59]
v_pk_add_f32 v[40:41], v[40:41], v[60:61]
v_pk_add_f32 v[42:43], v[42:43], v[62:63]
v_pk_add_f32 v[44:45], v[44:45], v[64:65]
v_pk_add_f32 v[46:47], v[46:47], v[66:67]
v_pk_add_f32 v[48:49], v[48:49], v[68:69]
v_pk_add_f32 v[50:51], v[50:51], v[70:71]
s_waitcnt lgkmcnt(5)
v_pk_add_f32 v[32:33], v[32:33], v[72:73]
v_pk_add_f32 v[34:35], v[34:35], v[74:75]
v_pk_add_f32 v[36:37], v[36:37], v[76:77]
v_pk_add_f32 v[38:39], v[38:39], v[78:79]
v_pk_add_f32 v[40:41], v[40:41], v[80:81]
v_pk_add_f32 v[42:43], v[42:43], v[82:83]
v_pk_add_f32 v[44:45], v[44:45], v[84:85]
v_pk_add_f32 v[46:47], v[46:47], v[86:87]
v_pk_add_f32 v[48:49], v[48:49], v[88:89]
v_pk_add_f32 v[50:51], v[50:51], v[90:91]
s_waitcnt lgkmcnt(0)
v_pk_add_f32 v[32:33], v[32:33], v[92:93]
v_pk_add_f32 v[34:35], v[34:35], v[94:95]
v_pk_add_f32 v[36:37], v[36:37], v[96:97]
v_pk_add_f32 v[38:39], v[38:39], v[98:99]
v_pk_add_f32 v[40:41], v[40:41], v[100:101]
v_pk_add_f32 v[42:43], v[42:43], v[102:103]
v_pk_add_f32 v[44:45], v[44:45], v[104:105]
v_pk_add_f32 v[46:47], v[46:47], v[106:107]
v_pk_add_f32 v[48:49], v[48:49], v[108:109]
v_pk_add_f32 v[50:51], v[50:51], v[110:111]
s_sub_u32 s31, s31, 20480
v_cvt_pk_bf16_f32 v96, v32, v33
v_cvt_pk_bf16_f32 v97, v34, v35
v_cvt_pk_bf16_f32 v98, v36, v37
v_cvt_pk_bf16_f32 v99, v38, v39
v_cvt_pk_bf16_f32 v100, v40, v41
v_cvt_pk_bf16_f32 v101, v42, v43
v_cvt_pk_bf16_f32 v102, v44, v45
v_cvt_pk_bf16_f32 v103, v46, v47
v_cvt_pk_bf16_f32 v104, v48, v49
v_cvt_pk_bf16_f32 v105, v50, v51
buffer_store_dwordx4 v[96:99], v10, s[4:7], s71 offen sc1
buffer_store_dwordx4 v[100:103], v10, s[4:7], s71 offen offset:1024 sc1
buffer_store_dwordx2 v[104:105], v9, s[4:7], s71 offen offset:2048 sc1
s_add_u32 s78, s77, 460
buffer_load_dwordx4 v[192:195], v244, s[4:7], s60 offen offset:0 sc1
buffer_load_dwordx4 v[196:199], v244, s[4:7], s61 offen offset:0 sc1
buffer_load_dwordx4 v[200:203], v244, s[4:7], s62 offen offset:0 sc1
buffer_load_dwordx4 v[204:207], v244, s[4:7], s63 offen offset:0 sc1
buffer_load_dwordx4 v[208:211], v244, s[4:7], s64 offen offset:0 sc1
s_waitcnt vmcnt(28)
ds_read_b64_tr_b16 a[120:121], v20 offset:0
ds_read_b64_tr_b16 a[122:123], v20 offset:2048
ds_read_b64_tr_b16 a[124:125], v21 offset:0
ds_read_b64_tr_b16 a[126:127], v21 offset:2048
ds_read_b64_tr_b16 a[128:129], v22 offset:0
ds_read_b64_tr_b16 a[130:131], v22 offset:2048
ds_read_b64_tr_b16 a[132:133], v23 offset:0
ds_read_b64_tr_b16 a[134:135], v23 offset:2048
ds_read_b64_tr_b16 a[136:137], v20 offset:4096
ds_read_b64_tr_b16 a[138:139], v20 offset:6144
ds_read_b64_tr_b16 a[140:141], v21 offset:4096
ds_read_b64_tr_b16 a[142:143], v21 offset:6144
ds_read_b64_tr_b16 a[144:145], v22 offset:4096
ds_read_b64_tr_b16 a[146:147], v22 offset:6144
ds_read_b64_tr_b16 a[148:149], v23 offset:4096
ds_read_b64_tr_b16 a[150:151], v23 offset:6144
ds_read_b64_tr_b16 a[152:153], v20 offset:8192
ds_read_b64_tr_b16 a[154:155], v20 offset:10240
ds_read_b64_tr_b16 a[156:157], v21 offset:8192
ds_read_b64_tr_b16 a[158:159], v21 offset:10240
ds_read_b64_tr_b16 a[160:161], v22 offset:8192
ds_read_b64_tr_b16 a[162:163], v22 offset:10240
ds_read_b64_tr_b16 a[164:165], v23 offset:8192
ds_read_b64_tr_b16 a[166:167], v23 offset:10240
ds_read_b64_tr_b16 a[168:169], v20 offset:12288
ds_read_b64_tr_b16 a[170:171], v20 offset:14336
ds_read_b64_tr_b16 a[172:173], v21 offset:12288
ds_read_b64_tr_b16 a[174:175], v21 offset:14336
ds_read_b64_tr_b16 a[176:177], v22 offset:12288
ds_read_b64_tr_b16 a[178:179], v22 offset:14336
ds_read_b64_tr_b16 a[180:181], v23 offset:12288
ds_read_b64_tr_b16 a[182:183], v23 offset:14336
ds_read_b64_tr_b16 a[184:185], v20 offset:16384
ds_read_b64_tr_b16 a[186:187], v20 offset:18432
ds_read_b64_tr_b16 a[188:189], v21 offset:16384
ds_read_b64_tr_b16 a[190:191], v21 offset:18432
ds_read_b64_tr_b16 a[192:193], v22 offset:16384
ds_read_b64_tr_b16 a[194:195], v22 offset:18432
ds_read_b64_tr_b16 a[196:197], v23 offset:16384
ds_read_b64_tr_b16 a[198:199], v23 offset:18432
s_add_u32 s71, s71, 0x5A000
s_waitcnt lgkmcnt(0)
s_waitcnt vmcnt(23)
v_mfma_f32_16x16x32_bf16 v[32:35], v[112:115], a[120:123], 0
buffer_load_dwordx4 v[212:215], v245, s[4:7], s60 offen offset:0 sc1
v_mfma_f32_16x16x32_bf16 a[0:3], v[112:115], a[124:127], 0
v_mfma_f32_16x16x32_bf16 a[20:23], v[112:115], a[128:131], 0
v_mfma_f32_16x16x32_bf16 a[40:43], v[112:115], a[132:135], 0
buffer_load_dwordx4 v[216:219], v245, s[4:7], s61 offen offset:0 sc1
v_mfma_f32_16x16x32_bf16 v[36:39], v[116:119], a[120:123], 0
v_mfma_f32_16x16x32_bf16 a[4:7], v[116:119], a[124:127], 0
v_mfma_f32_16x16x32_bf16 a[24:27], v[116:119], a[128:131], 0
buffer_load_dwordx4 v[220:223], v245, s[4:7], s62 offen offset:0 sc1
v_mfma_f32_16x16x32_bf16 a[44:47], v[116:119], a[132:135], 0
v_mfma_f32_16x16x32_bf16 v[40:43], v[120:123], a[120:123], 0
v_mfma_f32_16x16x32_bf16 a[8:11], v[120:123], a[124:127], 0
v_mfma_f32_16x16x32_bf16 a[28:31], v[120:123], a[128:131], 0
buffer_load_dwordx4 v[224:227], v245, s[4:7], s63 offen offset:0 sc1
v_mfma_f32_16x16x32_bf16 a[48:51], v[120:123], a[132:135], 0
v_mfma_f32_16x16x32_bf16 v[44:47], v[124:127], a[120:123], 0
v_mfma_f32_16x16x32_bf16 a[12:15], v[124:127], a[124:127], 0
buffer_load_dwordx4 v[228:231], v245, s[4:7], s64 offen offset:0 sc1
v_mfma_f32_16x16x32_bf16 a[32:35], v[124:127], a[128:131], 0
v_mfma_f32_16x16x32_bf16 a[52:55], v[124:127], a[132:135], 0
v_mfma_f32_16x16x32_bf16 v[48:51], v[128:131], a[120:123], 0
v_mfma_f32_16x16x32_bf16 a[16:19], v[128:131], a[124:127], 0
v_mfma_f32_16x16x32_bf16 a[36:39], v[128:131], a[128:131], 0
v_mfma_f32_16x16x32_bf16 a[56:59], v[128:131], a[132:135], 0
s_waitcnt vmcnt(23)
v_mfma_f32_16x16x32_bf16 v[32:35], v[132:135], a[136:139], v[32:35]
buffer_load_dwordx4 a[60:63], v246, s[4:7], s60 offen offset:0 sc1
v_mfma_f32_16x16x32_bf16 a[0:3], v[132:135], a[140:143], a[0:3]
v_mfma_f32_16x16x32_bf16 a[20:23], v[132:135], a[144:147], a[20:23]
v_mfma_f32_16x16x32_bf16 a[40:43], v[132:135], a[148:151], a[40:43]
buffer_load_dwordx4 a[64:67], v246, s[4:7], s61 offen offset:0 sc1
v_mfma_f32_16x16x32_bf16 v[36:39], v[136:139], a[136:139], v[36:39]
v_mfma_f32_16x16x32_bf16 a[4:7], v[136:139], a[140:143], a[4:7]
v_mfma_f32_16x16x32_bf16 a[24:27], v[136:139], a[144:147], a[24:27]
buffer_load_dwordx4 a[68:71], v246, s[4:7], s62 offen offset:0 sc1
v_mfma_f32_16x16x32_bf16 a[44:47], v[136:139], a[148:151], a[44:47]
v_mfma_f32_16x16x32_bf16 v[40:43], v[140:143], a[136:139], v[40:43]
v_mfma_f32_16x16x32_bf16 a[8:11], v[140:143], a[140:143], a[8:11]
v_mfma_f32_16x16x32_bf16 a[28:31], v[140:143], a[144:147], a[28:31]
buffer_load_dwordx4 a[72:75], v246, s[4:7], s63 offen offset:0 sc1
v_mfma_f32_16x16x32_bf16 a[48:51], v[140:143], a[148:151], a[48:51]
v_mfma_f32_16x16x32_bf16 v[44:47], v[144:147], a[136:139], v[44:47]
v_mfma_f32_16x16x32_bf16 a[12:15], v[144:147], a[140:143], a[12:15]
buffer_load_dwordx4 a[76:79], v246, s[4:7], s64 offen offset:0 sc1
v_mfma_f32_16x16x32_bf16 a[32:35], v[144:147], a[144:147], a[32:35]
v_mfma_f32_16x16x32_bf16 a[52:55], v[144:147], a[148:151], a[52:55]
v_mfma_f32_16x16x32_bf16 v[48:51], v[148:151], a[136:139], v[48:51]
v_mfma_f32_16x16x32_bf16 a[16:19], v[148:151], a[140:143], a[16:19]
v_mfma_f32_16x16x32_bf16 a[36:39], v[148:151], a[144:147], a[36:39]
v_mfma_f32_16x16x32_bf16 a[56:59], v[148:151], a[148:151], a[56:59]
s_waitcnt vmcnt(15)
s_barrier
s_lshl_b32 s32, s78, 7
s_add_u32 s32, s32, 131072
v_cmp_eq_u32 vcc, 0, v0
v_mov_b32 v16, 0x7fffffff
s_nop 0
v_cndmask_b32 v16, v16, 0, vcc
v_mov_b32 v17, s24
buffer_store_dword v17, v16, s[4:7], s32 offen sc1
s_waitcnt vmcnt(24)
v_mfma_f32_16x16x32_bf16 v[32:35], v[152:155], a[152:155], v[32:35]
s_add_u32 s79, s66, 5
s_cmp_ge_u32 s79, 9
s_cselect_b32 s33, 9, 0
s_sub_u32 s79, s79, s33
s_mul_i32 s79, s79, 73728
s_add_u32 s79, s79, s65
s_add_u32 m0, s31, 20480
s_add_u32 s32, s79, 0
buffer_load_dwordx4 v4, s[12:15], s32 offen offset:0  lds
v_mfma_f32_16x16x32_bf16 a[0:3], v[152:155], a[156:159], a[0:3]
buffer_load_dwordx4 v5, s[12:15], s32 offen offset:1024  lds
v_mfma_f32_16x16x32_bf16 a[20:23], v[152:155], a[160:163], a[20:23]
buffer_load_dwordx4 v6, s[12:15], s32 offen offset:2048  lds
v_mfma_f32_16x16x32_bf16 a[40:43], v[152:155], a[164:167], a[40:43]
buffer_load_dwordx4 v7, s[12:15], s32 offen offset:3072  lds
v_mfma_f32_16x16x32_bf16 v[36:39], v[156:159], a[152:155], v[36:39]
v_mfma_f32_16x16x32_bf16 a[4:7], v[156:159], a[156:159], a[4:7]
v_mfma_f32_16x16x32_bf16 a[24:27], v[156:159], a[160:163], a[24:27]
s_add_u32 s79, s66, 6
s_cmp_ge_u32 s79, 9
s_cselect_b32 s33, 9, 0
s_sub_u32 s79, s79, s33
s_mul_i32 s79, s79, 73728
s_add_u32 s79, s79, s65
s_add_u32 m0, s31, 24576
s_add_u32 s32, s79, 0
buffer_load_dwordx4 v4, s[12:15], s32 offen offset:0  lds
v_mfma_f32_16x16x32_bf16 a[44:47], v[156:159], a[164:167], a[44:47]
buffer_load_dwordx4 v5, s[12:15], s32 offen offset:1024  lds
v_mfma_f32_16x16x32_bf16 v[40:43], v[160:163], a[152:155], v[40:43]
buffer_load_dwordx4 v6, s[12:15], s32 offen offset:2048  lds
v_mfma_f32_16x16x32_bf16 a[8:11], v[160:163], a[156:159], a[8:11]
v_mfma_f32_16x16x32_bf16 a[28:31], v[160:163], a[160:163], a[28:31]
buffer_load_dwordx4 v7, s[12:15], s32 offen offset:3072  lds
v_mfma_f32_16x16x32_bf16 a[48:51], v[160:163], a[164:167], a[48:51]
v_mfma_f32_16x16x32_bf16 v[44:47], v[164:167], a[152:155], v[44:47]
buffer_load_dwordx4 a[80:83], v247, s[4:7], s60 offen offset:0 sc1
v_mfma_f32_16x16x32_bf16 a[12:15], v[164:167], a[156:159], a[12:15]
buffer_load_dwordx4 a[84:87], v247, s[4:7], s61 offen offset:0 sc1
v_mfma_f32_16x16x32_bf16 a[32:35], v[164:167], a[160:163], a[32:35]
v_mfma_f32_16x16x32_bf16 a[52:55], v[164:167], a[164:167], a[52:55]
buffer_load_dwordx4 a[88:91], v247, s[4:7], s62 offen offset:0 sc1
v_mfma_f32_16x16x32_bf16 v[48:51], v[168:171], a[152:155], v[48:51]
buffer_load_dwordx4 a[92:95], v247, s[4:7], s63 offen offset:0 sc1
v_mfma_f32_16x16x32_bf16 a[16:19], v[168:171], a[156:159], a[16:19]
buffer_load_dwordx4 a[96:99], v247, s[4:7], s64 offen offset:0 sc1
v_mfma_f32_16x16x32_bf16 a[36:39], v[168:171], a[160:163], a[36:39]
v_mfma_f32_16x16x32_bf16 a[56:59], v[168:171], a[164:167], a[56:59]
s_waitcnt vmcnt(32)
v_mfma_f32_16x16x32_bf16 v[32:35], v[172:175], a[168:171], v[32:35]
s_add_u32 s79, s66, 7
s_cmp_ge_u32 s79, 9
s_cselect_b32 s33, 9, 0
s_sub_u32 s79, s79, s33
s_mul_i32 s79, s79, 73728
s_add_u32 s79, s79, s65
s_add_u32 m0, s31, 28672
s_add_u32 s32, s79, 0
buffer_load_dwordx4 v4, s[12:15], s32 offen offset:0  lds
v_mfma_f32_16x16x32_bf16 a[0:3], v[172:175], a[172:175], a[0:3]
buffer_load_dwordx4 v5, s[12:15], s32 offen offset:1024  lds
v_mfma_f32_16x16x32_bf16 a[20:23], v[172:175], a[176:179], a[20:23]
buffer_load_dwordx4 v6, s[12:15], s32 offen offset:2048  lds
v_mfma_f32_16x16x32_bf16 a[40:43], v[172:175], a[180:183], a[40:43]
buffer_load_dwordx4 v7, s[12:15], s32 offen offset:3072  lds
v_mfma_f32_16x16x32_bf16 v[36:39], v[176:179], a[168:171], v[36:39]
v_mfma_f32_16x16x32_bf16 a[4:7], v[176:179], a[172:175], a[4:7]
v_mfma_f32_16x16x32_bf16 a[24:27], v[176:179], a[176:179], a[24:27]
s_add_u32 s79, s66, 8
s_cmp_ge_u32 s79, 9
s_cselect_b32 s33, 9, 0
s_sub_u32 s79, s79, s33
s_mul_i32 s79, s79, 73728
s_add_u32 s79, s79, s65
s_add_u32 m0, s31, 32768
s_add_u32 s32, s79, 0
buffer_load_dwordx4 v4, s[12:15], s32 offen offset:0  lds
v_mfma_f32_16x16x32_bf16 a[44:47], v[176:179], a[180:183], a[44:47]
buffer_load_dwordx4 v5, s[12:15], s32 offen offset:1024  lds
v_mfma_f32_16x16x32_bf16 v[40:43], v[180:183], a[168:171], v[40:43]
buffer_load_dwordx4 v6, s[12:15], s32 offen offset:2048  lds
v_mfma_f32_16x16x32_bf16 a[8:11], v[180:183], a[172:175], a[8:11]
v_mfma_f32_16x16x32_bf16 a[28:31], v[180:183], a[176:179], a[28:31]
buffer_load_dwordx4 v7, s[12:15], s32 offen offset:3072  lds
v_mfma_f32_16x16x32_bf16 a[48:51], v[180:183], a[180:183], a[48:51]
v_mfma_f32_16x16x32_bf16 v[44:47], v[184:187], a[168:171], v[44:47]
buffer_load_dwordx4 a[100:103], v248, s[4:7], s60 offen offset:0 sc1
v_mfma_f32_16x16x32_bf16 a[12:15], v[184:187], a[172:175], a[12:15]
buffer_load_dwordx4 a[104:107], v248, s[4:7], s61 offen offset:0 sc1
v_mfma_f32_16x16x32_bf16 a[32:35], v[184:187], a[176:179], a[32:35]
v_mfma_f32_16x16x32_bf16 a[52:55], v[184:187], a[180:183], a[52:55]
buffer_load_dwordx4 a[108:111], v248, s[4:7], s62 offen offset:0 sc1
v_mfma_f32_16x16x32_bf16 v[48:51], v[188:191], a[168:171], v[48:51]
buffer_load_dwordx4 a[112:115], v248, s[4:7], s63 offen offset:0 sc1
v_mfma_f32_16x16x32_bf16 a[16:19], v[188:191], a[172:175], a[16:19]
buffer_load_dwordx4 a[116:119], v248, s[4:7], s64 offen offset:0 sc1
v_mfma_f32_16x16x32_bf16 a[36:39], v[188:191], a[176:179], a[36:39]
v_mfma_f32_16x16x32_bf16 a[56:59], v[188:191], a[180:183], a[56:59]
s_waitcnt vmcnt(37)
v_mfma_f32_16x16x32_bf16 v[32:35], v[192:195], a[184:187], v[32:35]
v_mfma_f32_16x16x32_bf16 a[0:3], v[192:195], a[188:191], a[0:3]
v_mfma_f32_16x16x32_bf16 a[20:23], v[192:195], a[192:195], a[20:23]
v_mfma_f32_16x16x32_bf16 a[40:43], v[192:195], a[196:199], a[40:43]
v_mfma_f32_16x16x32_bf16 v[36:39], v[196:199], a[184:187], v[36:39]
v_mfma_f32_16x16x32_bf16 a[4:7], v[196:199], a[188:191], a[4:7]
v_mfma_f32_16x16x32_bf16 a[24:27], v[196:199], a[192:195], a[24:27]
v_mfma_f32_16x16x32_bf16 a[44:47], v[196:199], a[196:199], a[44:47]
v_mfma_f32_16x16x32_bf16 v[40:43], v[200:203], a[184:187], v[40:43]
s_waitcnt vmcnt(22)
v_mfma_f32_16x16x32_bf16 a[8:11], v[200:203], a[188:191], a[8:11]
ds_read_b64_tr_b16 a[200:201], v20 offset:20480
v_mfma_f32_16x16x32_bf16 a[28:31], v[200:203], a[192:195], a[28:31]
ds_read_b64_tr_b16 a[202:203], v20 offset:22528
v_mfma_f32_16x16x32_bf16 a[48:51], v[200:203], a[196:199], a[48:51]
v_mfma_f32_16x16x32_bf16 v[44:47], v[204:207], a[184:187], v[44:47]
ds_read_b64_tr_b16 a[204:205], v21 offset:20480
v_mfma_f32_16x16x32_bf16 a[12:15], v[204:207], a[188:191], a[12:15]
ds_read_b64_tr_b16 a[206:207], v21 offset:22528
v_mfma_f32_16x16x32_bf16 a[32:35], v[204:207], a[192:195], a[32:35]
ds_read_b64_tr_b16 a[208:209], v22 offset:20480
v_mfma_f32_16x16x32_bf16 a[52:55], v[204:207], a[196:199], a[52:55]
v_mfma_f32_16x16x32_bf16 v[48:51], v[208:211], a[184:187], v[48:51]
ds_read_b64_tr_b16 a[210:211], v22 offset:22528
v_mfma_f32_16x16x32_bf16 a[16:19], v[208:211], a[188:191], a[16:19]
ds_read_b64_tr_b16 a[212:213], v23 offset:20480
v_mfma_f32_16x16x32_bf16 a[36:39], v[208:211], a[192:195], a[36:39]
ds_read_b64_tr_b16 a[214:215], v23 offset:22528
v_mfma_f32_16x16x32_bf16 a[56:59], v[208:211], a[196:199], a[56:59]
s_waitcnt lgkmcnt(0)
s_waitcnt vmcnt(32)
v_mfma_f32_16x16x32_bf16 v[32:35], v[212:215], a[200:203], v[32:35]
v_mfma_f32_16x16x32_bf16 a[0:3], v[212:215], a[204:207], a[0:3]
v_mfma_f32_16x16x32_bf16 a[20:23], v[212:215], a[208:211], a[20:23]
v_mfma_f32_16x16x32_bf16 a[40:43], v[212:215], a[212:215], a[40:43]
v_mfma_f32_16x16x32_bf16 v[36:39], v[216:219], a[200:203], v[36:39]
v_mfma_f32_16x16x32_bf16 a[4:7], v[216:219], a[204:207], a[4:7]
v_mfma_f32_16x16x32_bf16 a[24:27], v[216:219], a[208:211], a[24:27]
v_mfma_f32_16x16x32_bf16 a[44:47], v[216:219], a[212:215], a[44:47]
v_mfma_f32_16x16x32_bf16 v[40:43], v[220:223], a[200:203], v[40:43]
s_waitcnt vmcnt(18)
v_mfma_f32_16x16x32_bf16 a[8:11], v[220:223], a[204:207], a[8:11]
ds_read_b64_tr_b16 a[216:217], v20 offset:24576
v_mfma_f32_16x16x32_bf16 a[28:31], v[220:223], a[208:211], a[28:31]
ds_read_b64_tr_b16 a[218:219], v20 offset:26624
v_mfma_f32_16x16x32_bf16 a[48:51], v[220:223], a[212:215], a[48:51]
v_mfma_f32_16x16x32_bf16 v[44:47], v[224:227], a[200:203], v[44:47]
ds_read_b64_tr_b16 a[220:221], v21 offset:24576
v_mfma_f32_16x16x32_bf16 a[12:15], v[224:227], a[204:207], a[12:15]
ds_read_b64_tr_b16 a[222:223], v21 offset:26624
v_mfma_f32_16x16x32_bf16 a[32:35], v[224:227], a[208:211], a[32:35]
ds_read_b64_tr_b16 a[224:225], v22 offset:24576
v_mfma_f32_16x16x32_bf16 a[52:55], v[224:227], a[212:215], a[52:55]
v_mfma_f32_16x16x32_bf16 v[48:51], v[228:231], a[200:203], v[48:51]
ds_read_b64_tr_b16 a[226:227], v22 offset:26624
v_mfma_f32_16x16x32_bf16 a[16:19], v[228:231], a[204:207], a[16:19]
ds_read_b64_tr_b16 a[228:229], v23 offset:24576
v_mfma_f32_16x16x32_bf16 a[36:39], v[228:231], a[208:211], a[36:39]
ds_read_b64_tr_b16 a[230:231], v23 offset:26624
v_mfma_f32_16x16x32_bf16 a[56:59], v[228:231], a[212:215], a[56:59]
s_waitcnt lgkmcnt(0)
s_waitcnt vmcnt(27)
v_mfma_f32_16x16x32_bf16 v[32:35], a[60:63], a[216:219], v[32:35]
v_mfma_f32_16x16x32_bf16 a[0:3], a[60:63], a[220:223], a[0:3]
v_mfma_f32_16x16x32_bf16 a[20:23], a[60:63], a[224:227], a[20:23]
v_mfma_f32_16x16x32_bf16 a[40:43], a[60:63], a[228:231], a[40:43]
v_mfma_f32_16x16x32_bf16 v[36:39], a[64:67], a[216:219], v[36:39]
v_mfma_f32_16x16x32_bf16 a[4:7], a[64:67], a[220:223], a[4:7]
v_mfma_f32_16x16x32_bf16 a[24:27], a[64:67], a[224:227], a[24:27]
v_mfma_f32_16x16x32_bf16 a[44:47], a[64:67], a[228:231], a[44:47]
v_mfma_f32_16x16x32_bf16 v[40:43], a[68:71], a[216:219], v[40:43]
s_waitcnt vmcnt(9)
v_mfma_f32_16x16x32_bf16 a[8:11], a[68:71], a[220:223], a[8:11]
ds_read_b64_tr_b16 a[232:233], v20 offset:28672
v_mfma_f32_16x16x32_bf16 a[28:31], a[68:71], a[224:227], a[28:31]
ds_read_b64_tr_b16 a[234:235], v20 offset:30720
v_mfma_f32_16x16x32_bf16 a[48:51], a[68:71], a[228:231], a[48:51]
v_mfma_f32_16x16x32_bf16 v[44:47], a[72:75], a[216:219], v[44:47]
ds_read_b64_tr_b16 a[236:237], v21 offset:28672
v_mfma_f32_16x16x32_bf16 a[12:15], a[72:75], a[220:223], a[12:15]
ds_read_b64_tr_b16 a[238:239], v21 offset:30720
v_mfma_f32_16x16x32_bf16 a[32:35], a[72:75], a[224:227], a[32:35]
ds_read_b64_tr_b16 a[240:241], v22 offset:28672
v_mfma_f32_16x16x32_bf16 a[52:55], a[72:75], a[228:231], a[52:55]
v_mfma_f32_16x16x32_bf16 v[48:51], a[76:79], a[216:219], v[48:51]
ds_read_b64_tr_b16 a[242:243], v22 offset:30720
v_mfma_f32_16x16x32_bf16 a[16:19], a[76:79], a[220:223], a[16:19]
ds_read_b64_tr_b16 a[244:245], v23 offset:28672
v_mfma_f32_16x16x32_bf16 a[36:39], a[76:79], a[224:227], a[36:39]
ds_read_b64_tr_b16 a[246:247], v23 offset:30720
v_mfma_f32_16x16x32_bf16 a[56:59], a[76:79], a[228:231], a[56:59]
s_waitcnt lgkmcnt(0)
s_waitcnt vmcnt(13)
v_mfma_f32_16x16x32_bf16 v[32:35], a[80:83], a[232:235], v[32:35]
v_mfma_f32_16x16x32_bf16 a[0:3], a[80:83], a[236:239], a[0:3]
v_mfma_f32_16x16x32_bf16 a[20:23], a[80:83], a[240:243], a[20:23]
v_mfma_f32_16x16x32_bf16 a[40:43], a[80:83], a[244:247], a[40:43]
v_mfma_f32_16x16x32_bf16 v[36:39], a[84:87], a[232:235], v[36:39]
v_mfma_f32_16x16x32_bf16 a[4:7], a[84:87], a[236:239], a[4:7]
v_mfma_f32_16x16x32_bf16 a[24:27], a[84:87], a[240:243], a[24:27]
v_mfma_f32_16x16x32_bf16 a[44:47], a[84:87], a[244:247], a[44:47]
v_mfma_f32_16x16x32_bf16 v[40:43], a[88:91], a[232:235], v[40:43]
s_waitcnt vmcnt(5)
v_mfma_f32_16x16x32_bf16 a[8:11], a[88:91], a[236:239], a[8:11]
ds_read_b64_tr_b16 a[248:249], v20 offset:32768
v_mfma_f32_16x16x32_bf16 a[28:31], a[88:91], a[240:243], a[28:31]
ds_read_b64_tr_b16 a[250:251], v20 offset:34816
v_mfma_f32_16x16x32_bf16 a[48:51], a[88:91], a[244:247], a[48:51]
v_mfma_f32_16x16x32_bf16 v[44:47], a[92:95], a[232:235], v[44:47]
ds_read_b64_tr_b16 a[252:253], v21 offset:32768
v_mfma_f32_16x16x32_bf16 a[12:15], a[92:95], a[236:239], a[12:15]
ds_read_b64_tr_b16 a[254:255], v21 offset:34816
v_mfma_f32_16x16x32_bf16 a[32:35], a[92:95], a[240:243], a[32:35]
ds_read_b64_tr_b16 v[232:233], v22 offset:32768
v_mfma_f32_16x16x32_bf16 a[52:55], a[92:95], a[244:247], a[52:55]
v_mfma_f32_16x16x32_bf16 v[48:51], a[96:99], a[232:235], v[48:51]
ds_read_b64_tr_b16 v[234:235], v22 offset:34816
v_mfma_f32_16x16x32_bf16 a[16:19], a[96:99], a[236:239], a[16:19]
ds_read_b64_tr_b16 v[236:237], v23 offset:32768
v_mfma_f32_16x16x32_bf16 a[36:39], a[96:99], a[240:243], a[36:39]
ds_read_b64_tr_b16 v[238:239], v23 offset:34816
v_mfma_f32_16x16x32_bf16 a[56:59], a[96:99], a[244:247], a[56:59]
s_waitcnt lgkmcnt(0)
s_waitcnt vmcnt(0)
v_mfma_f32_16x16x32_bf16 v[32:35], a[100:103], a[248:251], v[32:35]
v_mfma_f32_16x16x32_bf16 a[0:3], a[100:103], a[252:255], a[0:3]
v_mfma_f32_16x16x32_bf16 a[20:23], a[100:103], v[232:235], a[20:23]
v_mfma_f32_16x16x32_bf16 a[40:43], a[100:103], v[236:239], a[40:43]
v_mfma_f32_16x16x32_bf16 v[36:39], a[104:107], a[248:251], v[36:39]
v_mfma_f32_16x16x32_bf16 a[4:7], a[104:107], a[252:255], a[4:7]
v_mfma_f32_16x16x32_bf16 a[24:27], a[104:107], v[232:235], a[24:27]
v_mfma_f32_16x16x32_bf16 a[44:47], a[104:107], v[236:239], a[44:47]
v_mfma_f32_16x16x32_bf16 v[40:43], a[108:111], a[248:251], v[40:43]
v_mfma_f32_16x16x32_bf16 a[8:11], a[108:111], a[252:255], a[8:11]
v_mfma_f32_16x16x32_bf16 a[28:31], a[108:111], v[232:235], a[28:31]
v_mfma_f32_16x16x32_bf16 a[48:51], a[108:111], v[236:239], a[48:51]
v_mfma_f32_16x16x32_bf16 v[44:47], a[112:115], a[248:251], v[44:47]
v_mfma_f32_16x16x32_bf16 a[12:15], a[112:115], a[252:255], a[12:15]
v_mfma_f32_16x16x32_bf16 a[32:35], a[112:115], v[232:235], a[32:35]
v_mfma_f32_16x16x32_bf16 a[52:55], a[112:115], v[236:239], a[52:55]
v_mfma_f32_16x16x32_bf16 v[48:51], a[116:119], a[248:251], v[48:51]
v_mfma_f32_16x16x32_bf16 a[16:19], a[116:119], a[252:255], a[16:19]
v_mfma_f32_16x16x32_bf16 a[36:39], a[116:119], v[232:235], a[36:39]
v_mfma_f32_16x16x32_bf16 a[56:59], a[116:119], v[236:239], a[56:59]
s_barrier
s_add_u32 s31, s31, 20480
v_lshlrev_b32 v10, 4, v1
v_add_u32 v11, s31, v10
ds_write_b128 v11, a[0:3] offset:0
ds_write_b128 v11, a[4:7] offset:1024
ds_write_b128 v11, a[8:11] offset:2048
ds_write_b128 v11, a[12:15] offset:3072
ds_write_b128 v11, a[16:19] offset:4096
ds_write_b128 v11, a[20:23] offset:5120
ds_write_b128 v11, a[24:27] offset:6144
ds_write_b128 v11, a[28:31] offset:7168
ds_write_b128 v11, a[32:35] offset:8192
ds_write_b128 v11, a[36:39] offset:9216
ds_write_b128 v11, a[40:43] offset:10240
ds_write_b128 v11, a[44:47] offset:11264
ds_write_b128 v11, a[48:51] offset:12288
ds_write_b128 v11, a[52:55] offset:13312
ds_write_b128 v11, a[56:59] offset:14336
s_xor_b32 s33, s25, 1
s_mul_i32 s33, s33, 36864
s_add_u32 s33, s33, 20480
v_add_u32 v12, s33, v10
s_xor_b32 s33, s25, 2
s_mul_i32 s33, s33, 36864
s_add_u32 s33, s33, 20480
v_add_u32 v13, s33, v10
s_xor_b32 s33, s25, 3
s_mul_i32 s33, s33, 36864
s_add_u32 s33, s33, 20480
v_add_u32 v14, s33, v10
s_waitcnt lgkmcnt(0)
s_barrier
ds_read_b128 v[52:55], v12 offset:0
ds_read_b128 v[56:59], v12 offset:1024
ds_read_b128 v[60:63], v12 offset:2048
ds_read_b128 v[64:67], v12 offset:3072
ds_read_b128 v[68:71], v12 offset:4096
ds_read_b128 v[72:75], v13 offset:5120
ds_read_b128 v[76:79], v13 offset:6144
ds_read_b128 v[80:83], v13 offset:7168
ds_read_b128 v[84:87], v13 offset:8192
ds_read_b128 v[88:91], v13 offset:9216
ds_read_b128 v[92:95], v14 offset:10240
ds_read_b128 v[96:99], v14 offset:11264
ds_read_b128 v[100:103], v14 offset:12288
ds_read_b128 v[104:107], v14 offset:13312
ds_read_b128 v[108:111], v14 offset:14336
s_waitcnt lgkmcnt(10)
v_pk_add_f32 v[32:33], v[32:33], v[52:53]
v_pk_add_f32 v[34:35], v[34:35], v[54:55]
v_pk_add_f32 v[36:37], v[36:37], v[56:57]
v_pk_add_f32 v[38:39], v[38:39], v[58:59]
v_pk_add_f32 v[40:41], v[40:41], v[60:61]
v_pk_add_f32 v[42:43], v[42:43], v[62:63]
v_pk_add_f32 v[44:45], v[44:45], v[64:65]
v_pk_add_f32 v[46:47], v[46:47], v[66:67]
v_pk_add_f32 v[48:49], v[48:49], v[68:69]
v_pk_add_f32 v[50:51], v[50:51], v[70:71]
s_waitcnt lgkmcnt(5)
v_pk_add_f32 v[32:33], v[32:33], v[72:73]
v_pk_add_f32 v[34:35], v[34:35], v[74:75]
v_pk_add_f32 v[36:37], v[36:37], v[76:77]
v_pk_add_f32 v[38:39], v[38:39], v[78:79]
v_pk_add_f32 v[40:41], v[40:41], v[80:81]
v_pk_add_f32 v[42:43], v[42:43], v[82:83]
v_pk_add_f32 v[44:45], v[44:45], v[84:85]
v_pk_add_f32 v[46:47], v[46:47], v[86:87]
v_pk_add_f32 v[48:49], v[48:49], v[88:89]
v_pk_add_f32 v[50:51], v[50:51], v[90:91]
s_waitcnt lgkmcnt(0)
v_pk_add_f32 v[32:33], v[32:33], v[92:93]
v_pk_add_f32 v[34:35], v[34:35], v[94:95]
v_pk_add_f32 v[36:37], v[36:37], v[96:97]
v_pk_add_f32 v[38:39], v[38:39], v[98:99]
v_pk_add_f32 v[40:41], v[40:41], v[100:101]
v_pk_add_f32 v[42:43], v[42:43], v[102:103]
v_pk_add_f32 v[44:45], v[44:45], v[104:105]
v_pk_add_f32 v[46:47], v[46:47], v[106:107]
v_pk_add_f32 v[48:49], v[48:49], v[108:109]
v_pk_add_f32 v[50:51], v[50:51], v[110:111]
s_sub_u32 s31, s31, 20480
v_cvt_pk_bf16_f32 v96, v32, v33
v_cvt_pk_bf16_f32 v97, v34, v35
v_cvt_pk_bf16_f32 v98, v36, v37
v_cvt_pk_bf16_f32 v99, v38, v39
v_cvt_pk_bf16_f32 v100, v40, v41
v_cvt_pk_bf16_f32 v101, v42, v43
v_cvt_pk_bf16_f32 v102, v44, v45
v_cvt_pk_bf16_f32 v103, v46, v47
v_cvt_pk_bf16_f32 v104, v48, v49
v_cvt_pk_bf16_f32 v105, v50, v51
buffer_store_dwordx4 v[96:99], v10, s[4:7], s71 offen sc1
buffer_store_dwordx4 v[100:103], v10, s[4:7], s71 offen offset:1024 sc1
buffer_store_dwordx2 v[104:105], v9, s[4:7], s71 offen offset:2048 sc1
s_add_u32 s78, s77, 496
s_waitcnt vmcnt(0)
s_barrier
s_lshl_b32 s32, s78, 7
s_add_u32 s32, s32, 131072
v_cmp_eq_u32 vcc, 0, v0
v_mov_b32 v16, 0x7fffffff
s_nop 0
v_cndmask_b32 v16, v16, 0, vcc
v_mov_b32 v17, s24
buffer_store_dword v17, v16, s[4:7], s32 offen sc1
s_branch L_fin
L_help:
s_cmp_lg_u32 s77, 36
s_cbranch_scc1 L_fin
s_waitcnt vmcnt(0)
v_readfirstlane_b32 s24, v3
s_nop 0
s_mul_i32 s24, s24, 0x9E3779B1
s_add_u32 s24, s24, 0x7F4A7C15
v_mov_b32 v16, 163328
s_mov_b32 s33, 20000
poll_49:
buffer_load_dword v17, v16, s[4:7], 0 offen sc1
s_waitcnt vmcnt(0)
v_cmp_ne_u32 vcc, s24, v17
s_sub_u32 s33, s33, 1
s_cmp_eq_u32 s33, 0
s_cbranch_scc1 pe_50
s_nop 1
s_cbranch_vccnz poll_49
pe_50:
v_lshlrev_b32 v16, 7, v0
v_add_u32 v16, 131072, v16
s_mov_b32 s33, 20000
poll_51:
buffer_load_dword v17, v16, s[4:7], 0 offen sc1
s_waitcnt vmcnt(0)
v_cmp_ne_u32 vcc, s24, v17
s_sub_u32 s33, s33, 1
s_cmp_eq_u32 s33, 0
s_cbranch_scc1 pe_52
s_nop 1
s_cbranch_vccnz poll_51
pe_52:
v_add_u32 v16, 256, v0
v_min_u32 v16, 511, v16
v_lshlrev_b32 v16, 7, v16
v_add_u32 v16, 131072, v16
s_mov_b32 s33, 20000
poll_53:
buffer_load_dword v17, v16, s[4:7], 0 offen sc1
s_waitcnt vmcnt(0)
v_cmp_ne_u32 vcc, s24, v17
s_sub_u32 s33, s33, 1
s_cmp_eq_u32 s33, 0
s_cbranch_scc1 pe_54
s_nop 1
s_cbranch_vccnz poll_53
pe_54:
v_min_u32 v16, 19, v1
v_lshlrev_b32 v16, 7, v16
v_add_u32 v16, 196608, v16
s_mov_b32 s33, 20000
poll_55:
buffer_load_dword v17, v16, s[4:7], 0 offen sc1
s_waitcnt vmcnt(0)
v_cmp_ne_u32 vcc, s24, v17
s_sub_u32 s33, s33, 1
s_cmp_eq_u32 s33, 0
s_cbranch_scc1 pe_56
s_nop 1
s_cbranch_vccnz poll_55
pe_56:
s_mov_b32 s78, -128
s_waitcnt vmcnt(0)
s_barrier
s_lshl_b32 s32, s78, 7
s_add_u32 s32, s32, 131072
v_cmp_eq_u32 vcc, 0, v0
v_mov_b32 v16, 0x7fffffff
s_nop 0
v_cndmask_b32 v16, v16, 0, vcc
v_mov_b32 v17, s24
buffer_store_dword v17, v16, s[4:7], s32 offen sc1
L_fin:
L_end:
s_endpgm
.section .rodata,"a"
.p2align 6
.amdhsa_kernel standalone__pixart__diffusion_kernel
  .amdhsa_next_free_vgpr 512
  .amdhsa_next_free_sgpr 102
  .amdhsa_accum_offset 256
  .amdhsa_group_segment_fixed_size 0
  .amdhsa_kernarg_size 96
  .amdhsa_user_sgpr_count 2
  .amdhsa_user_sgpr_kernarg_segment_ptr 1
  .amdhsa_system_sgpr_workgroup_id_x 1
  .amdhsa_float_denorm_mode_32 3
.end_amdhsa_kernel
```
